```python
import torch

def _softmax(x, axis=-1):
    return torch.softmax(x, dim=axis)
def _gelu(x):
    return torch.nn.functional.gelu(x, approximate="tanh")
def _silu(x):
    return torch.nn.functional.silu(x)
def _sigmoid(x):
    return torch.sigmoid(x)
def _layernorm(x, axis=-1, eps=1e-5):
    m = x.mean(dim=axis, keepdim=True)
    v = x.var(dim=axis, keepdim=True, unbiased=False)
    return (x - m) / torch.sqrt(v + eps)
def _scatter_add(tgt, idx, src, axis=0):
    return tgt.clone().index_add_(axis, idx, src)
def _segment_sum(src, seg, n):
    out = torch.zeros((n,) + src.shape[1:], dtype=src.dtype)
    return out.index_add_(0, seg, src)
def _pad(x, pw):
    flat = tuple(v for pair in reversed(pw) for v in pair)
    return torch.nn.functional.pad(x, flat)

kernel_name = 'concat_heads__gqa_block_cached__gqa_block_cached__near_ridge'

def setup_inputs():

    _w = (lambda a: (lambda t: t.to(torch.bfloat16) if t.is_floating_point() else t)(torch.as_tensor(a)))
    def _A_setup():
        B, Sq, D = 16, 128, 640
        Hq, Hkv, Sk, Dh = 32, 32, 512, 192
        assert Hq % Hkv == 0, (Hq, Hkv)
        return {
            "x": _w((lambda *s: torch.randn(*s, dtype=torch.bfloat16) * 0.8)(B, Sq, D)),
            "k_cache": _w((lambda *s: torch.randn(*s, dtype=torch.bfloat16) * 0.8)(B, Hkv, Sk, Dh)),
            "v_cache": _w((lambda *s: torch.randn(*s, dtype=torch.bfloat16) * 0.05)(B, Hkv, Sk, Dh)),
            "wq": _w((lambda *s: torch.randn(*s, dtype=torch.bfloat16) * 0.8)(D, Hq * Dh) * (D ** -0.5)),
            "wo": _w((lambda *s: torch.randn(*s, dtype=torch.bfloat16) * 0.05)(Hq * Dh, D) * ((Hq * Dh) ** -0.5)),
        }
    _A_in = _A_setup()

    def _B_setup():
        B, Sq, D = 16, 128, 640
        Hq, Hkv, Sk, Dh = 32, 32, 512, 192
        assert Hq % Hkv == 0, (Hq, Hkv)
        return {
            "x": _w((lambda *s: torch.randn(*s, dtype=torch.bfloat16) * 0.8)(B, Sq, D)),
            "k_cache": _w((lambda *s: torch.randn(*s, dtype=torch.bfloat16) * 0.8)(B, Hkv, Sk, Dh)),
            "v_cache": _w((lambda *s: torch.randn(*s, dtype=torch.bfloat16) * 0.05)(B, Hkv, Sk, Dh)),
            "wq": _w((lambda *s: torch.randn(*s, dtype=torch.bfloat16) * 0.8)(D, Hq * Dh) * (D ** -0.5)),
            "wo": _w((lambda *s: torch.randn(*s, dtype=torch.bfloat16) * 0.05)(Hq * Dh, D) * ((Hq * Dh) ** -0.5)),
        }
    _B_in = _B_setup()

    return {
        "A_x": _A_in["x"],
        "A_k_cache": _A_in["k_cache"],
        "A_v_cache": _A_in["v_cache"],
        "A_wq": _A_in["wq"],
        "A_wo": _A_in["wo"],
        "B_x": _B_in["x"],
        "B_k_cache": _B_in["k_cache"],
        "B_v_cache": _B_in["v_cache"],
        "B_wq": _B_in["wq"],
        "B_wo": _B_in["wo"],
    }

def reference(A_x, A_k_cache, A_v_cache, A_wq, A_wo, B_x, B_k_cache, B_v_cache, B_wq, B_wo):
    def _A_ref(x, k_cache, v_cache, wq, wo):
        B, Sq, D = x.shape
        Hq, Dh = 32, 192
        Hkv = k_cache.shape[1]
        rep = Hq // Hkv
        q = (lambda x, *d: x.permute(*d))((x @ wq).reshape(B, Sq, Hq, Dh), 0, 2, 1, 3)
        k = (lambda x, n, axis: torch.repeat_interleave(x, n, dim=axis))(k_cache, rep, axis=1)
        v = (lambda x, n, axis: torch.repeat_interleave(x, n, dim=axis))(v_cache, rep, axis=1)
        scores = torch.einsum("bhqd,bhkd->bhqk", q, k) * (Dh ** -0.5)
        p = _softmax(scores, axis=-1)
        o = torch.einsum("bhqk,bhkd->bhqd", p, v)
        return (lambda x, *d: x.permute(*d))(o, 0, 2, 1, 3).reshape(B, Sq, Hq * Dh) @ wo

    def _B_ref(x, k_cache, v_cache, wq, wo):
        B, Sq, D = x.shape
        Hq, Dh = 32, 192
        Hkv = k_cache.shape[1]
        rep = Hq // Hkv
        q = (lambda x, *d: x.permute(*d))((x @ wq).reshape(B, Sq, Hq, Dh), 0, 2, 1, 3)
        k = (lambda x, n, axis: torch.repeat_interleave(x, n, dim=axis))(k_cache, rep, axis=1)
        v = (lambda x, n, axis: torch.repeat_interleave(x, n, dim=axis))(v_cache, rep, axis=1)
        scores = torch.einsum("bhqd,bhkd->bhqk", q, k) * (Dh ** -0.5)
        p = _softmax(scores, axis=-1)
        o = torch.einsum("bhqk,bhkd->bhqd", p, v)
        return (lambda x, *d: x.permute(*d))(o, 0, 2, 1, 3).reshape(B, Sq, Hq * Dh) @ wo

    a = _A_ref(A_x, A_k_cache, A_v_cache, A_wq, A_wo)
    b = _B_ref(B_x, B_k_cache, B_v_cache, B_wq, B_wo)
    return torch.concatenate([a, b], axis=-1)
```

```asm
; @launch kernel=attn_kernel grid=(256,1,1) block=(512,1,1) lds=163840
.amdgcn_target "amdgcn-amd-amdhsa--gfx950"
.text
.globl attn_kernel
.p2align 8
.type attn_kernel,@function
attn_kernel:
    s_cmp_ge_u32 s2, 256
    s_cbranch_scc1 attn_END
    s_and_b32 s3, s2, 7
    s_lshr_b32 s4, s2, 3
    s_lshr_b32 s63, s3, 2
    s_bfe_u32 s5, s3, 0x10001
    s_lshl_b32 s5, s5, 3
    s_and_b32 s6, s4, 7
    s_add_u32 s61, s5, s6
    s_and_b32 s5, s3, 1
    s_lshl_b32 s5, s5, 4
    s_lshr_b32 s6, s4, 3
    s_add_u32 s62, s5, s6
    s_mul_i32 s4, s63, 40
    s_add_u32 s4, s0, s4
    s_addc_u32 s5, s1, 0
    s_load_dwordx8 s[8:15], s[4:5], 0
    s_load_dwordx2 s[16:17], s[4:5], 32
    s_load_dwordx2 s[18:19], s[0:1], 80
    s_load_dwordx2 s[20:21], s[0:1], 96
    s_load_dwordx2 s[80:81], s[0:1], 88
    v_lshrrev_b32 v1, 6, v0
    v_and_b32 v0, 63, v0
    v_readfirstlane_b32 s3, v1
    s_nop 1
    s_and_b32 s22, s3, 3
    s_lshr_b32 s23, s3, 2
    s_lshl_b32 s3, s63, 4
    s_add_u32 s3, s3, s61
    s_lshl_b32 s3, s3, 5
    s_add_u32 s64, s3, s62
    s_waitcnt lgkmcnt(0)
    s_cmp_eq_u32 s23, 1
    s_cbranch_scc1 attn_GSTART
    v_and_b32 v56, 31, v0
    v_lshrrev_b32 v57, 5, v0
    v_bfe_u32 v64, v0, 1, 3
    v_mul_u32_u24 v65, 384, v56
    v_add_u32 v66, 0, v57
    v_xor_b32 v66, v66, v64
    v_lshl_add_u32 v2, v66, 4, v65
    v_add_u32 v66, 2, v57
    v_xor_b32 v66, v66, v64
    v_lshl_add_u32 v3, v66, 4, v65
    v_add_u32 v66, 4, v57
    v_xor_b32 v66, v66, v64
    v_lshl_add_u32 v4, v66, 4, v65
    v_add_u32 v66, 6, v57
    v_xor_b32 v66, v66, v64
    v_lshl_add_u32 v5, v66, 4, v65
    v_lshrrev_b32 v56, 5, v0
    v_bfe_u32 v57, v0, 4, 1
    v_and_b32 v58, 3, v0
    v_bfe_u32 v59, v0, 2, 2
    v_bfe_u32 v60, v0, 3, 1
    v_lshrrev_b32 v61, 1, v58
    v_and_b32 v62, 1, v58
    v_lshl_add_u32 v63, v56, 2, v59
    v_mul_u32_u24 v63, 384, v63
    v_lshl_add_u32 v63, v62, 3, v63
    v_lshl_add_u32 v63, v61, 4, v63
    v_lshl_add_u32 v63, v57, 5, v63
    v_xor_b32 v64, 0, v60
    v_lshl_add_u32 v6, v64, 6, v63
    v_xor_b32 v64, 1, v60
    v_lshl_add_u32 v7, v64, 6, v63
    s_mul_i32 s51, s22, 192
    v_add_u32 v56, s51, v0
    s_mov_b32 s52, 2731
    v_mul_lo_u32 v57, v56, s52
    v_lshrrev_b32 v57, 16, v57
    v_mul_u32_u24 v58, 24, v57
    v_sub_u32 v58, v56, v58
    v_bfe_u32 v60, v57, 1, 3
    v_xor_b32 v60, v60, v58
    v_mul_u32_u24 v61, 384, v57
    v_lshl_add_u32 v12, v60, 4, v61
    v_bfe_u32 v60, v57, 1, 1
    v_lshlrev_b32 v60, 2, v60
    v_xor_b32 v60, v60, v58
    v_mul_u32_u24 v61, 384, v57
    v_lshl_add_u32 v15, v60, 4, v61
    v_add_u32 v56, s51, v0
    v_add_u32 v56, 64, v56
    s_mov_b32 s52, 2731
    v_mul_lo_u32 v57, v56, s52
    v_lshrrev_b32 v57, 16, v57
    v_mul_u32_u24 v58, 24, v57
    v_sub_u32 v58, v56, v58
    v_bfe_u32 v60, v57, 1, 3
    v_xor_b32 v60, v60, v58
    v_mul_u32_u24 v61, 384, v57
    v_lshl_add_u32 v13, v60, 4, v61
    v_subrev_u32 v13, 1024, v13
    v_bfe_u32 v60, v57, 1, 1
    v_lshlrev_b32 v60, 2, v60
    v_xor_b32 v60, v60, v58
    v_mul_u32_u24 v61, 384, v57
    v_lshl_add_u32 v16, v60, 4, v61
    v_subrev_u32 v16, 1024, v16
    v_add_u32 v56, s51, v0
    v_add_u32 v56, 128, v56
    s_mov_b32 s52, 2731
    v_mul_lo_u32 v57, v56, s52
    v_lshrrev_b32 v57, 16, v57
    v_mul_u32_u24 v58, 24, v57
    v_sub_u32 v58, v56, v58
    v_bfe_u32 v60, v57, 1, 3
    v_xor_b32 v60, v60, v58
    v_mul_u32_u24 v61, 384, v57
    v_lshl_add_u32 v14, v60, 4, v61
    v_subrev_u32 v14, 2048, v14
    v_bfe_u32 v60, v57, 1, 1
    v_lshlrev_b32 v60, 2, v60
    v_xor_b32 v60, v60, v58
    v_mul_u32_u24 v61, 384, v57
    v_lshl_add_u32 v17, v60, 4, v61
    v_subrev_u32 v17, 2048, v17
    v_bfe_u32 v56, v0, 4, 1
    v_lshlrev_b32 v56, 10, v56
    v_lshrrev_b32 v57, 5, v0
    v_lshl_add_u32 v56, v57, 8, v56
    v_and_b32 v57, 15, v0
    v_lshl_add_u32 v23, v57, 4, v56
    v_lshlrev_b32 v23, 4, v0
    s_mul_i32 s51, s22, 12288
    s_add_u32 s52, s51, 61440
    v_lshlrev_b32 v20, 4, v0
    v_add_u32 v20, s52, v20
    s_mov_b32 s24, s10
    s_mov_b32 s25, s11
    s_mov_b32 s26, 100663296
    s_mov_b32 s27, 0x00020000
    s_mov_b32 s28, s12
    s_mov_b32 s29, s13
    s_mov_b32 s30, 100663296
    s_mov_b32 s31, 0x00020000
    s_mov_b32 s36, s20
    s_mov_b32 s37, s21
    s_add_u32 s36, s36, 67108864
    s_addc_u32 s37, s37, 0
    s_mov_b32 s38, 52428800
    s_mov_b32 s39, 0x00020000
    s_lshl_b32 s52, s61, 5
    s_add_u32 s52, s52, s62
    s_mul_i32 s48, s52, 196608
    s_add_u32 s49, s48, 786432
    s_mul_i32 s67, s22, 3072
    s_mov_b32 s59, s67
    s_add_u32 s68, s67, 61440
    s_mov_b32 s66, 0
    s_mul_i32 s58, s64, 49152
    s_add_u32 s58, s58, s51
    s_mov_b32 s50, 0
    s_mov_b64 s[54:55], 0
    s_add_u32 s51, s48, 0
    s_mov_b32 m0, s59
    s_nop 0
    buffer_load_dwordx4 v12, s[24:27], s51 offen offset:0 nt lds
    buffer_load_dwordx4 v13, s[24:27], s51 offen offset:1024 nt lds
    buffer_load_dwordx4 v14, s[24:27], s51 offen offset:2048 nt lds
    s_add_u32 s59, s59, 12288
    s_cmp_eq_u32 s59, s68
    s_cselect_b32 s59, s67, s59
    s_add_u32 s51, s48, 12288
    s_mov_b32 m0, s59
    s_nop 0
    buffer_load_dwordx4 v12, s[24:27], s51 offen offset:0 nt lds
    buffer_load_dwordx4 v13, s[24:27], s51 offen offset:1024 nt lds
    buffer_load_dwordx4 v14, s[24:27], s51 offen offset:2048 nt lds
    s_add_u32 s59, s59, 12288
    s_cmp_eq_u32 s59, s68
    s_cselect_b32 s59, s67, s59
    s_add_u32 s51, s48, 0
    s_mov_b32 m0, s59
    s_nop 0
    buffer_load_dwordx4 v15, s[28:31], s51 offen offset:0 nt lds
    buffer_load_dwordx4 v16, s[28:31], s51 offen offset:1024 nt lds
    buffer_load_dwordx4 v17, s[28:31], s51 offen offset:2048 nt lds
    s_add_u32 s59, s59, 12288
    s_cmp_eq_u32 s59, s68
    s_cselect_b32 s59, s67, s59
    s_add_u32 s51, s48, 24576
    s_mov_b32 m0, s59
    s_nop 0
    buffer_load_dwordx4 v12, s[24:27], s51 offen offset:0 nt lds
    buffer_load_dwordx4 v13, s[24:27], s51 offen offset:1024 nt lds
    buffer_load_dwordx4 v14, s[24:27], s51 offen offset:2048 nt lds
    s_add_u32 s59, s59, 12288
    s_cmp_eq_u32 s59, s68
    s_cselect_b32 s59, s67, s59
    s_cmp_lg_u32 s22, 0
    s_cbranch_scc1 attn_NOHS
    s_lshl_b32 s51, s63, 3
    s_lshr_b32 s52, s61, 1
    s_add_u32 s51, s51, s52
    s_lshl_b32 s51, s51, 1
    s_lshr_b32 s52, s62, 4
    s_add_u32 s51, s51, s52
    s_lshl_b32 s51, s51, 1
    s_bfe_u32 s52, s62, 0x10001
    s_add_u32 s51, s51, s52
    s_and_b32 s52, s61, 1
    s_lshl_b32 s52, s52, 1
    s_and_b32 s53, s62, 1
    s_add_u32 s52, s52, s53
    s_lshl_b32 s53, s51, 2
    v_mov_b32 v58, s53
    s_lshl_b32 s51, s51, 7
    s_lshl_b32 s52, s52, 2
    s_add_u32 s51, s51, s52
    v_mov_b32 v56, s51
    v_mov_b32 v57, 0
    v_mov_b32 v59, 0x100
    s_mov_b32 s32, s20
    s_mov_b32 s33, s21
    s_add_u32 s32, s32, 201326592
    s_addc_u32 s33, s33, 0
    s_mov_b32 s34, 8192
    s_mov_b32 s35, 0x00020000
    s_mov_b32 s84, s80
    s_mov_b32 s85, s81
    s_mov_b32 s86, 256
    s_mov_b32 s87, 0x00020000
    s_mov_b64 exec, 1
    buffer_store_dword v57, v56, s[32:35], 0 offen sc1
    s_waitcnt vmcnt(0)
    buffer_atomic_add v59, v58, s[84:87], 0 offen
    s_mov_b64 exec, -1
attn_NOHS:
    s_barrier
    s_barrier
    s_barrier
    s_barrier
    s_barrier
    s_barrier
    s_barrier
    s_barrier
    s_barrier
    s_barrier
    s_barrier
    s_barrier
    s_barrier
    s_barrier
    s_barrier
    s_barrier
    s_barrier
    s_barrier
    s_barrier
    s_barrier
    s_barrier
    s_barrier
    s_barrier
    s_barrier
    s_barrier
    s_barrier
    s_barrier
    s_barrier
    s_barrier
    s_barrier
    s_barrier
    s_barrier
    ds_read_b128 a[96:99], v20 offset:0
    ds_read_b128 a[100:103], v20 offset:1024
    ds_read_b128 a[104:107], v20 offset:2048
    ds_read_b128 a[108:111], v20 offset:3072
    ds_read_b128 a[112:115], v20 offset:4096
    ds_read_b128 a[116:119], v20 offset:5120
    ds_read_b128 a[120:123], v20 offset:6144
    ds_read_b128 a[124:127], v20 offset:7168
    ds_read_b128 a[128:131], v20 offset:8192
    ds_read_b128 a[132:135], v20 offset:9216
    ds_read_b128 a[136:139], v20 offset:10240
    ds_read_b128 a[140:143], v20 offset:11264
    s_waitcnt vmcnt(0)
attn_ALOOP:
    s_nop 7
    s_nop 7
    v_add_u32 v8, s66, v2
    v_add_u32 v9, s66, v3
    v_add_u32 v10, s66, v4
    v_add_u32 v11, s66, v5
    s_add_u32 s66, s66, 12288
    s_cmp_eq_u32 s66, 61440
    s_cselect_b32 s66, 0, s66
    s_waitcnt vmcnt(21)
    s_barrier
    ds_read_b128 a[144:147], v8 offset:0
    ds_read_b128 a[148:151], v9 offset:0
    ds_read_b128 a[152:155], v10 offset:0
    ds_read_b128 a[156:159], v11 offset:0
    ds_read_b128 a[160:163], v8 offset:128
    s_waitcnt lgkmcnt(4)
    v_mfma_f32_32x32x16_bf16 v[56:71], a[144:147], a[96:99], 0
    s_add_u32 s51, s48, 12288
    s_mov_b32 m0, s59
    s_nop 0
    buffer_load_dwordx4 v15, s[28:31], s51 offen offset:0 nt lds
    ds_read_b128 a[164:167], v9 offset:128
    s_waitcnt lgkmcnt(4)
    v_mfma_f32_32x32x16_bf16 v[56:71], a[148:151], a[100:103], v[56:71]
    ds_read_b128 a[144:147], v10 offset:128
    s_waitcnt lgkmcnt(4)
    v_mfma_f32_32x32x16_bf16 v[56:71], a[152:155], a[104:107], v[56:71]
    ds_read_b128 a[148:151], v11 offset:128
    s_waitcnt lgkmcnt(4)
    v_mfma_f32_32x32x16_bf16 v[56:71], a[156:159], a[108:111], v[56:71]
    ds_read_b128 a[152:155], v8 offset:256
    s_waitcnt lgkmcnt(4)
    v_mfma_f32_32x32x16_bf16 v[56:71], a[160:163], a[112:115], v[56:71]
    buffer_load_dwordx4 v16, s[28:31], s51 offen offset:1024 nt lds
    ds_read_b128 a[156:159], v9 offset:256
    s_waitcnt lgkmcnt(4)
    v_mfma_f32_32x32x16_bf16 v[56:71], a[164:167], a[116:119], v[56:71]
    ds_read_b128 a[160:163], v10 offset:256
    s_waitcnt lgkmcnt(4)
    v_mfma_f32_32x32x16_bf16 v[56:71], a[144:147], a[120:123], v[56:71]
    ds_read_b128 a[164:167], v11 offset:256
    s_waitcnt lgkmcnt(4)
    v_mfma_f32_32x32x16_bf16 v[56:71], a[148:151], a[124:127], v[56:71]
    s_waitcnt lgkmcnt(3)
    v_mfma_f32_32x32x16_bf16 v[56:71], a[152:155], a[128:131], v[56:71]
    buffer_load_dwordx4 v17, s[28:31], s51 offen offset:2048 nt lds
    s_add_u32 s59, s59, 12288
    s_cmp_eq_u32 s59, s68
    s_cselect_b32 s59, s67, s59
    s_waitcnt lgkmcnt(2)
    v_mfma_f32_32x32x16_bf16 v[56:71], a[156:159], a[132:135], v[56:71]
    s_waitcnt lgkmcnt(1)
    v_mfma_f32_32x32x16_bf16 v[56:71], a[160:163], a[136:139], v[56:71]
    s_waitcnt lgkmcnt(0)
    v_mfma_f32_32x32x16_bf16 v[56:71], a[164:167], a[140:143], v[56:71]
    s_nop 7
    s_nop 3
    v_max3_f32 v26, v56, v57, v58
    v_max3_f32 v26, v26, v59, v60
    v_max3_f32 v26, v26, v61, v62
    v_max3_f32 v26, v26, v63, v64
    v_max3_f32 v26, v26, v65, v66
    v_max3_f32 v26, v26, v67, v68
    v_max3_f32 v26, v26, v69, v70
    v_max_f32 v26, v26, v71
    v_mov_b32 v27, v26
    s_nop 1
    v_permlane32_swap_b32 v26, v27
    v_max_f32 v26, v26, v27
    v_sub_f32 v40, 0, v26
    v_sub_f32 v41, 0, v26
    v_sub_f32 v42, 0, v26
    v_sub_f32 v43, 0, v26
    v_sub_f32 v44, 0, v26
    v_sub_f32 v45, 0, v26
    v_sub_f32 v46, 0, v26
    v_sub_f32 v47, 0, v26
    v_sub_f32 v48, 0, v26
    v_sub_f32 v49, 0, v26
    v_sub_f32 v50, 0, v26
    v_sub_f32 v51, 0, v26
    v_sub_f32 v52, 0, v26
    v_sub_f32 v53, 0, v26
    v_sub_f32 v54, 0, v26
    v_sub_f32 v55, 0, v26
    v_mov_b32 v24, 0
    v_add_u32 v8, s66, v2
    v_add_u32 v9, s66, v3
    v_add_u32 v10, s66, v4
    v_add_u32 v11, s66, v5
    s_add_u32 s66, s66, 12288
    s_cmp_eq_u32 s66, 61440
    s_cselect_b32 s66, 0, s66
    s_waitcnt vmcnt(21)
    s_barrier
    ds_read_b128 a[144:147], v8 offset:0
    ds_read_b128 a[148:151], v9 offset:0
    ds_read_b128 a[152:155], v10 offset:0
    ds_read_b128 a[156:159], v11 offset:0
    ds_read_b128 a[160:163], v8 offset:128
    s_waitcnt lgkmcnt(4)
    v_mfma_f32_32x32x16_bf16 v[72:87], a[144:147], a[96:99], v[40:55]
    v_add_f32 v56, v56, v40
    v_add_f32 v57, v57, v40
    v_add_f32 v58, v58, v40
    v_add_f32 v59, v59, v40
    v_add_f32 v60, v60, v40
    ds_read_b128 a[164:167], v9 offset:128
    s_waitcnt lgkmcnt(4)
    v_mfma_f32_32x32x16_bf16 v[72:87], a[148:151], a[100:103], v[72:87]
    v_add_f32 v61, v61, v40
    v_add_f32 v62, v62, v40
    v_add_f32 v63, v63, v40
    v_add_f32 v64, v64, v40
    v_add_f32 v65, v65, v40
    ds_read_b128 a[144:147], v10 offset:128
    s_waitcnt lgkmcnt(4)
    v_mfma_f32_32x32x16_bf16 v[72:87], a[152:155], a[104:107], v[72:87]
    v_add_f32 v66, v66, v40
    v_add_f32 v67, v67, v40
    v_add_f32 v68, v68, v40
    v_add_f32 v69, v69, v40
    s_add_u32 s51, s48, 36864
    s_mov_b32 m0, s59
    s_nop 0
    buffer_load_dwordx4 v12, s[24:27], s51 offen offset:0 nt lds
    ds_read_b128 a[148:151], v11 offset:128
    s_waitcnt lgkmcnt(4)
    v_mfma_f32_32x32x16_bf16 v[72:87], a[156:159], a[108:111], v[72:87]
    v_add_f32 v70, v70, v40
    v_add_f32 v71, v71, v40
    v_exp_f32 v56, v56
    v_exp_f32 v57, v57
    v_exp_f32 v58, v58
    ds_read_b128 a[152:155], v8 offset:256
    s_waitcnt lgkmcnt(4)
    v_mfma_f32_32x32x16_bf16 v[72:87], a[160:163], a[112:115], v[72:87]
    v_exp_f32 v59, v59
    v_exp_f32 v60, v60
    v_exp_f32 v61, v61
    v_exp_f32 v62, v62
    ds_read_b128 a[156:159], v9 offset:256
    s_waitcnt lgkmcnt(4)
    v_mfma_f32_32x32x16_bf16 v[72:87], a[164:167], a[116:119], v[72:87]
    v_exp_f32 v63, v63
    v_cvt_pk_bf16_f32 v32, v56, v57
    v_cvt_pk_bf16_f32 v33, v58, v59
    v_cvt_pk_bf16_f32 v34, v60, v61
    buffer_load_dwordx4 v13, s[24:27], s51 offen offset:1024 nt lds
    ds_read_b128 a[160:163], v10 offset:256
    s_waitcnt lgkmcnt(4)
    v_mfma_f32_32x32x16_bf16 v[72:87], a[144:147], a[120:123], v[72:87]
    v_cvt_pk_bf16_f32 v35, v62, v63
    v_exp_f32 v64, v64
    v_exp_f32 v65, v65
    v_exp_f32 v66, v66
    v_exp_f32 v67, v67
    ds_read_b128 a[164:167], v11 offset:256
    s_waitcnt lgkmcnt(4)
    v_mfma_f32_32x32x16_bf16 v[72:87], a[148:151], a[124:127], v[72:87]
    v_exp_f32 v68, v68
    v_exp_f32 v69, v69
    v_exp_f32 v70, v70
    v_exp_f32 v71, v71
    v_cvt_pk_bf16_f32 v36, v64, v65
    s_waitcnt lgkmcnt(3)
    v_mfma_f32_32x32x16_bf16 v[72:87], a[152:155], a[128:131], v[72:87]
    v_cvt_pk_bf16_f32 v37, v66, v67
    v_cvt_pk_bf16_f32 v38, v68, v69
    v_cvt_pk_bf16_f32 v39, v70, v71
    buffer_load_dwordx4 v14, s[24:27], s51 offen offset:2048 nt lds
    s_add_u32 s59, s59, 12288
    s_cmp_eq_u32 s59, s68
    s_cselect_b32 s59, s67, s59
    v_add_u32 v8, s66, v6
    v_add_u32 v9, s66, v7
    s_add_u32 s66, s66, 12288
    s_cmp_eq_u32 s66, 61440
    s_cselect_b32 s66, 0, s66
    s_waitcnt lgkmcnt(0)
    s_waitcnt vmcnt(21)
    s_barrier
    ds_read_b64_tr_b16 a[144:145], v8 offset:0
    ds_read_b64_tr_b16 a[146:147], v8 offset:3072
    ds_read_b64_tr_b16 a[148:149], v9 offset:0
    ds_read_b64_tr_b16 a[150:151], v9 offset:3072
    v_mfma_f32_32x32x16_bf16 v[72:87], a[156:159], a[132:135], v[72:87]
    ds_read_b64_tr_b16 a[152:153], v8 offset:128
    ds_read_b64_tr_b16 a[154:155], v8 offset:3200
    v_mfma_f32_32x32x16_bf16 v[72:87], a[160:163], a[136:139], v[72:87]
    ds_read_b64_tr_b16 a[156:157], v9 offset:128
    ds_read_b64_tr_b16 a[158:159], v9 offset:3200
    v_mfma_f32_32x32x16_bf16 v[72:87], a[164:167], a[140:143], v[72:87]
    ds_read_b64_tr_b16 a[160:161], v8 offset:256
    ds_read_b64_tr_b16 a[162:163], v8 offset:3328
    s_waitcnt lgkmcnt(8)
    v_mfma_f32_32x32x16_bf16 a[0:15], a[144:147], v[32:35], 0
    v_add_f32 v24, v24, v56
    v_add_f32 v24, v24, v57
    v_add_f32 v24, v24, v58
    v_add_f32 v24, v24, v59
    ds_read_b64_tr_b16 a[164:165], v9 offset:256
    ds_read_b64_tr_b16 a[166:167], v9 offset:3328
    s_waitcnt lgkmcnt(8)
    v_mfma_f32_32x32x16_bf16 a[16:31], a[148:151], v[32:35], 0
    v_add_f32 v24, v24, v60
    v_add_f32 v24, v24, v61
    v_add_f32 v24, v24, v62
    ds_read_b64_tr_b16 a[144:145], v8 offset:6144
    ds_read_b64_tr_b16 a[146:147], v8 offset:9216
    s_waitcnt lgkmcnt(8)
    v_mfma_f32_32x32x16_bf16 a[32:47], a[152:155], v[32:35], 0
    v_add_f32 v24, v24, v63
    v_add_f32 v24, v24, v64
    s_add_u32 s51, s48, 24576
    s_mov_b32 m0, s59
    s_nop 0
    buffer_load_dwordx4 v15, s[28:31], s51 offen offset:0 nt lds
    ds_read_b64_tr_b16 a[148:149], v9 offset:6144
    ds_read_b64_tr_b16 a[150:151], v9 offset:9216
    s_waitcnt lgkmcnt(8)
    v_mfma_f32_32x32x16_bf16 a[48:63], a[156:159], v[32:35], 0
    v_add_f32 v24, v24, v65
    v_add_f32 v24, v24, v66
    v_add_f32 v24, v24, v67
    ds_read_b64_tr_b16 a[152:153], v8 offset:6272
    ds_read_b64_tr_b16 a[154:155], v8 offset:9344
    s_waitcnt lgkmcnt(8)
    v_mfma_f32_32x32x16_bf16 a[64:79], a[160:163], v[32:35], 0
    v_add_f32 v24, v24, v68
    v_add_f32 v24, v24, v69
    v_add_f32 v24, v24, v70
    v_add_f32 v24, v24, v71
    ds_read_b64_tr_b16 a[156:157], v9 offset:6272
    ds_read_b64_tr_b16 a[158:159], v9 offset:9344
    s_waitcnt lgkmcnt(8)
    v_mfma_f32_32x32x16_bf16 a[80:95], a[164:167], v[32:35], 0
    v_max3_f32 v26, v72, v73, v74
    v_max3_f32 v26, v26, v75, v76
    buffer_load_dwordx4 v16, s[28:31], s51 offen offset:1024 nt lds
    ds_read_b64_tr_b16 a[160:161], v8 offset:6400
    ds_read_b64_tr_b16 a[162:163], v8 offset:9472
    s_waitcnt lgkmcnt(8)
    v_mfma_f32_32x32x16_bf16 a[0:15], a[144:147], v[36:39], a[0:15]
    v_max3_f32 v26, v26, v77, v78
    v_max3_f32 v26, v26, v79, v80
    v_max3_f32 v26, v26, v81, v82
    ds_read_b64_tr_b16 a[164:165], v9 offset:6400
    ds_read_b64_tr_b16 a[166:167], v9 offset:9472
    s_waitcnt lgkmcnt(8)
    v_mfma_f32_32x32x16_bf16 a[16:31], a[148:151], v[36:39], a[16:31]
    v_max3_f32 v26, v26, v83, v84
    v_max3_f32 v26, v26, v85, v86
    v_max_f32 v26, v26, v87
    s_waitcnt lgkmcnt(6)
    v_mfma_f32_32x32x16_bf16 a[32:47], a[152:155], v[36:39], a[32:47]
    v_cmp_lt_f32 vcc, 0x41000000, v26
    s_nop 1
    s_mov_b64 s[54:55], vcc
    buffer_load_dwordx4 v17, s[28:31], s51 offen offset:2048 nt lds
    s_add_u32 s59, s59, 12288
    s_cmp_eq_u32 s59, s68
    s_cselect_b32 s59, s67, s59
    v_add_u32 v8, s66, v2
    v_add_u32 v9, s66, v3
    v_add_u32 v10, s66, v4
    v_add_u32 v11, s66, v5
    s_add_u32 s66, s66, 12288
    s_cmp_eq_u32 s66, 61440
    s_cselect_b32 s66, 0, s66
    s_waitcnt lgkmcnt(0)
    s_waitcnt vmcnt(21)
    s_barrier
    ds_read_b128 a[144:147], v8 offset:0
    ds_read_b128 a[148:151], v9 offset:0
    v_mfma_f32_32x32x16_bf16 a[48:63], a[156:159], v[36:39], a[48:63]
    ds_read_b128 a[152:155], v10 offset:0
    v_mfma_f32_32x32x16_bf16 a[64:79], a[160:163], v[36:39], a[64:79]
    ds_read_b128 a[156:159], v11 offset:0
    v_mfma_f32_32x32x16_bf16 a[80:95], a[164:167], v[36:39], a[80:95]
    ds_read_b128 a[160:163], v8 offset:128
    s_mov_b32 s56, 0
    s_cmp_lg_u64 s[54:55], 0
    s_cbranch_scc1 attn_SLOW1
attn_RET0:
    s_waitcnt lgkmcnt(4)
    v_mfma_f32_32x32x16_bf16 v[56:71], a[144:147], a[96:99], v[40:55]
    v_exp_f32 v72, v72
    v_exp_f32 v73, v73
    v_exp_f32 v74, v74
    ds_read_b128 a[164:167], v9 offset:128
    s_waitcnt lgkmcnt(4)
    v_mfma_f32_32x32x16_bf16 v[56:71], a[148:151], a[100:103], v[56:71]
    v_exp_f32 v75, v75
    v_exp_f32 v76, v76
    v_exp_f32 v77, v77
    ds_read_b128 a[144:147], v10 offset:128
    s_waitcnt lgkmcnt(4)
    v_mfma_f32_32x32x16_bf16 v[56:71], a[152:155], a[104:107], v[56:71]
    v_exp_f32 v78, v78
    v_exp_f32 v79, v79
    s_add_u32 s51, s48, 49152
    s_mov_b32 m0, s59
    s_nop 0
    buffer_load_dwordx4 v12, s[24:27], s51 offen offset:0 nt lds
    ds_read_b128 a[148:151], v11 offset:128
    s_waitcnt lgkmcnt(4)
    v_mfma_f32_32x32x16_bf16 v[56:71], a[156:159], a[108:111], v[56:71]
    v_cvt_pk_bf16_f32 v32, v72, v73
    v_cvt_pk_bf16_f32 v33, v74, v75
    v_cvt_pk_bf16_f32 v34, v76, v77
    ds_read_b128 a[152:155], v8 offset:256
    s_waitcnt lgkmcnt(4)
    v_mfma_f32_32x32x16_bf16 v[56:71], a[160:163], a[112:115], v[56:71]
    v_cvt_pk_bf16_f32 v35, v78, v79
    v_exp_f32 v80, v80
    v_exp_f32 v81, v81
    ds_read_b128 a[156:159], v9 offset:256
    s_waitcnt lgkmcnt(4)
    v_mfma_f32_32x32x16_bf16 v[56:71], a[164:167], a[116:119], v[56:71]
    v_exp_f32 v82, v82
    v_exp_f32 v83, v83
    buffer_load_dwordx4 v13, s[24:27], s51 offen offset:1024 nt lds
    ds_read_b128 a[160:163], v10 offset:256
    s_waitcnt lgkmcnt(4)
    v_mfma_f32_32x32x16_bf16 v[56:71], a[144:147], a[120:123], v[56:71]
    v_exp_f32 v84, v84
    v_exp_f32 v85, v85
    v_exp_f32 v86, v86
    ds_read_b128 a[164:167], v11 offset:256
    s_waitcnt lgkmcnt(4)
    v_mfma_f32_32x32x16_bf16 v[56:71], a[148:151], a[124:127], v[56:71]
    v_exp_f32 v87, v87
    v_cvt_pk_bf16_f32 v36, v80, v81
    v_cvt_pk_bf16_f32 v37, v82, v83
    s_waitcnt lgkmcnt(3)
    v_mfma_f32_32x32x16_bf16 v[56:71], a[152:155], a[128:131], v[56:71]
    v_cvt_pk_bf16_f32 v38, v84, v85
    v_cvt_pk_bf16_f32 v39, v86, v87
    buffer_load_dwordx4 v14, s[24:27], s51 offen offset:2048 nt lds
    s_add_u32 s59, s59, 12288
    s_cmp_eq_u32 s59, s68
    s_cselect_b32 s59, s67, s59
    v_add_u32 v8, s66, v6
    v_add_u32 v9, s66, v7
    s_add_u32 s66, s66, 12288
    s_cmp_eq_u32 s66, 61440
    s_cselect_b32 s66, 0, s66
    s_waitcnt lgkmcnt(0)
    s_waitcnt vmcnt(9)
    s_barrier
    ds_read_b64_tr_b16 a[144:145], v8 offset:0
    ds_read_b64_tr_b16 a[146:147], v8 offset:3072
    ds_read_b64_tr_b16 a[148:149], v9 offset:0
    ds_read_b64_tr_b16 a[150:151], v9 offset:3072
    v_mfma_f32_32x32x16_bf16 v[56:71], a[156:159], a[132:135], v[56:71]
    ds_read_b64_tr_b16 a[152:153], v8 offset:128
    ds_read_b64_tr_b16 a[154:155], v8 offset:3200
    v_mfma_f32_32x32x16_bf16 v[56:71], a[160:163], a[136:139], v[56:71]
    ds_read_b64_tr_b16 a[156:157], v9 offset:128
    ds_read_b64_tr_b16 a[158:159], v9 offset:3200
    v_mfma_f32_32x32x16_bf16 v[56:71], a[164:167], a[140:143], v[56:71]
    ds_read_b64_tr_b16 a[160:161], v8 offset:256
    ds_read_b64_tr_b16 a[162:163], v8 offset:3328
    s_waitcnt lgkmcnt(8)
    v_mfma_f32_32x32x16_bf16 a[0:15], a[144:147], v[32:35], a[0:15]
    v_add_f32 v24, v24, v72
    v_add_f32 v24, v24, v73
    v_add_f32 v24, v24, v74
    v_add_f32 v24, v24, v75
    ds_read_b64_tr_b16 a[164:165], v9 offset:256
    ds_read_b64_tr_b16 a[166:167], v9 offset:3328
    s_waitcnt lgkmcnt(8)
    v_mfma_f32_32x32x16_bf16 a[16:31], a[148:151], v[32:35], a[16:31]
    v_add_f32 v24, v24, v76
    v_add_f32 v24, v24, v77
    v_add_f32 v24, v24, v78
    ds_read_b64_tr_b16 a[144:145], v8 offset:6144
    ds_read_b64_tr_b16 a[146:147], v8 offset:9216
    s_waitcnt lgkmcnt(8)
    v_mfma_f32_32x32x16_bf16 a[32:47], a[152:155], v[32:35], a[32:47]
    v_add_f32 v24, v24, v79
    v_add_f32 v24, v24, v80
    s_add_u32 s51, s48, 36864
    s_mov_b32 m0, s59
    s_nop 0
    buffer_load_dwordx4 v15, s[28:31], s51 offen offset:0 nt lds
    ds_read_b64_tr_b16 a[148:149], v9 offset:6144
    ds_read_b64_tr_b16 a[150:151], v9 offset:9216
    s_waitcnt lgkmcnt(8)
    v_mfma_f32_32x32x16_bf16 a[48:63], a[156:159], v[32:35], a[48:63]
    v_add_f32 v24, v24, v81
    v_add_f32 v24, v24, v82
    v_add_f32 v24, v24, v83
    ds_read_b64_tr_b16 a[152:153], v8 offset:6272
    ds_read_b64_tr_b16 a[154:155], v8 offset:9344
    s_waitcnt lgkmcnt(8)
    v_mfma_f32_32x32x16_bf16 a[64:79], a[160:163], v[32:35], a[64:79]
    v_add_f32 v24, v24, v84
    v_add_f32 v24, v24, v85
    v_add_f32 v24, v24, v86
    v_add_f32 v24, v24, v87
    ds_read_b64_tr_b16 a[156:157], v9 offset:6272
    ds_read_b64_tr_b16 a[158:159], v9 offset:9344
    s_waitcnt lgkmcnt(8)
    v_mfma_f32_32x32x16_bf16 a[80:95], a[164:167], v[32:35], a[80:95]
    v_max3_f32 v26, v56, v57, v58
    v_max3_f32 v26, v26, v59, v60
    buffer_load_dwordx4 v16, s[28:31], s51 offen offset:1024 nt lds
    ds_read_b64_tr_b16 a[160:161], v8 offset:6400
    ds_read_b64_tr_b16 a[162:163], v8 offset:9472
    s_waitcnt lgkmcnt(8)
    v_mfma_f32_32x32x16_bf16 a[0:15], a[144:147], v[36:39], a[0:15]
    v_max3_f32 v26, v26, v61, v62
    v_max3_f32 v26, v26, v63, v64
    v_max3_f32 v26, v26, v65, v66
    ds_read_b64_tr_b16 a[164:165], v9 offset:6400
    ds_read_b64_tr_b16 a[166:167], v9 offset:9472
    s_waitcnt lgkmcnt(8)
    v_mfma_f32_32x32x16_bf16 a[16:31], a[148:151], v[36:39], a[16:31]
    v_max3_f32 v26, v26, v67, v68
    v_max3_f32 v26, v26, v69, v70
    v_max_f32 v26, v26, v71
    s_waitcnt lgkmcnt(6)
    v_mfma_f32_32x32x16_bf16 a[32:47], a[152:155], v[36:39], a[32:47]
    v_cmp_lt_f32 vcc, 0x41000000, v26
    s_nop 1
    s_mov_b64 s[54:55], vcc
    buffer_load_dwordx4 v17, s[28:31], s51 offen offset:2048 nt lds
    s_add_u32 s59, s59, 12288
    s_cmp_eq_u32 s59, s68
    s_cselect_b32 s59, s67, s59
    v_add_u32 v8, s66, v2
    v_add_u32 v9, s66, v3
    v_add_u32 v10, s66, v4
    v_add_u32 v11, s66, v5
    s_add_u32 s66, s66, 12288
    s_cmp_eq_u32 s66, 61440
    s_cselect_b32 s66, 0, s66
    s_waitcnt lgkmcnt(0)
    s_waitcnt vmcnt(9)
    s_barrier
    ds_read_b128 a[144:147], v8 offset:0
    ds_read_b128 a[148:151], v9 offset:0
    v_mfma_f32_32x32x16_bf16 a[48:63], a[156:159], v[36:39], a[48:63]
    ds_read_b128 a[152:155], v10 offset:0
    v_mfma_f32_32x32x16_bf16 a[64:79], a[160:163], v[36:39], a[64:79]
    ds_read_b128 a[156:159], v11 offset:0
    v_mfma_f32_32x32x16_bf16 a[80:95], a[164:167], v[36:39], a[80:95]
    ds_read_b128 a[160:163], v8 offset:128
    s_mov_b32 s56, 1
    s_cmp_lg_u64 s[54:55], 0
    s_cbranch_scc1 attn_SLOW0
attn_RET1:
    s_waitcnt lgkmcnt(4)
    v_mfma_f32_32x32x16_bf16 v[72:87], a[144:147], a[96:99], v[40:55]
    v_exp_f32 v56, v56
    v_exp_f32 v57, v57
    v_exp_f32 v58, v58
    ds_read_b128 a[164:167], v9 offset:128
    s_waitcnt lgkmcnt(4)
    v_mfma_f32_32x32x16_bf16 v[72:87], a[148:151], a[100:103], v[72:87]
    v_exp_f32 v59, v59
    v_exp_f32 v60, v60
    v_exp_f32 v61, v61
    ds_read_b128 a[144:147], v10 offset:128
    s_waitcnt lgkmcnt(4)
    v_mfma_f32_32x32x16_bf16 v[72:87], a[152:155], a[104:107], v[72:87]
    v_exp_f32 v62, v62
    v_exp_f32 v63, v63
    s_add_u32 s51, s48, 61440
    s_mov_b32 m0, s59
    s_nop 0
    buffer_load_dwordx4 v12, s[24:27], s51 offen offset:0 nt lds
    ds_read_b128 a[148:151], v11 offset:128
    s_waitcnt lgkmcnt(4)
    v_mfma_f32_32x32x16_bf16 v[72:87], a[156:159], a[108:111], v[72:87]
    v_cvt_pk_bf16_f32 v32, v56, v57
    v_cvt_pk_bf16_f32 v33, v58, v59
    v_cvt_pk_bf16_f32 v34, v60, v61
    ds_read_b128 a[152:155], v8 offset:256
    s_waitcnt lgkmcnt(4)
    v_mfma_f32_32x32x16_bf16 v[72:87], a[160:163], a[112:115], v[72:87]
    v_cvt_pk_bf16_f32 v35, v62, v63
    v_exp_f32 v64, v64
    v_exp_f32 v65, v65
    ds_read_b128 a[156:159], v9 offset:256
    s_waitcnt lgkmcnt(4)
    v_mfma_f32_32x32x16_bf16 v[72:87], a[164:167], a[116:119], v[72:87]
    v_exp_f32 v66, v66
    v_exp_f32 v67, v67
    buffer_load_dwordx4 v13, s[24:27], s51 offen offset:1024 nt lds
    ds_read_b128 a[160:163], v10 offset:256
    s_waitcnt lgkmcnt(4)
    v_mfma_f32_32x32x16_bf16 v[72:87], a[144:147], a[120:123], v[72:87]
    v_exp_f32 v68, v68
    v_exp_f32 v69, v69
    v_exp_f32 v70, v70
    ds_read_b128 a[164:167], v11 offset:256
    s_waitcnt lgkmcnt(4)
    v_mfma_f32_32x32x16_bf16 v[72:87], a[148:151], a[124:127], v[72:87]
    v_exp_f32 v71, v71
    v_cvt_pk_bf16_f32 v36, v64, v65
    v_cvt_pk_bf16_f32 v37, v66, v67
    s_waitcnt lgkmcnt(3)
    v_mfma_f32_32x32x16_bf16 v[72:87], a[152:155], a[128:131], v[72:87]
    v_cvt_pk_bf16_f32 v38, v68, v69
    v_cvt_pk_bf16_f32 v39, v70, v71
    buffer_load_dwordx4 v14, s[24:27], s51 offen offset:2048 nt lds
    s_add_u32 s59, s59, 12288
    s_cmp_eq_u32 s59, s68
    s_cselect_b32 s59, s67, s59
    v_add_u32 v8, s66, v6
    v_add_u32 v9, s66, v7
    s_add_u32 s66, s66, 12288
    s_cmp_eq_u32 s66, 61440
    s_cselect_b32 s66, 0, s66
    s_waitcnt lgkmcnt(0)
    s_waitcnt vmcnt(9)
    s_barrier
    ds_read_b64_tr_b16 a[144:145], v8 offset:0
    ds_read_b64_tr_b16 a[146:147], v8 offset:3072
    ds_read_b64_tr_b16 a[148:149], v9 offset:0
    ds_read_b64_tr_b16 a[150:151], v9 offset:3072
    v_mfma_f32_32x32x16_bf16 v[72:87], a[156:159], a[132:135], v[72:87]
    ds_read_b64_tr_b16 a[152:153], v8 offset:128
    ds_read_b64_tr_b16 a[154:155], v8 offset:3200
    v_mfma_f32_32x32x16_bf16 v[72:87], a[160:163], a[136:139], v[72:87]
    ds_read_b64_tr_b16 a[156:157], v9 offset:128
    ds_read_b64_tr_b16 a[158:159], v9 offset:3200
    v_mfma_f32_32x32x16_bf16 v[72:87], a[164:167], a[140:143], v[72:87]
    ds_read_b64_tr_b16 a[160:161], v8 offset:256
    ds_read_b64_tr_b16 a[162:163], v8 offset:3328
    s_waitcnt lgkmcnt(8)
    v_mfma_f32_32x32x16_bf16 a[0:15], a[144:147], v[32:35], a[0:15]
    v_add_f32 v24, v24, v56
    v_add_f32 v24, v24, v57
    v_add_f32 v24, v24, v58
    v_add_f32 v24, v24, v59
    ds_read_b64_tr_b16 a[164:165], v9 offset:256
    ds_read_b64_tr_b16 a[166:167], v9 offset:3328
    s_waitcnt lgkmcnt(8)
    v_mfma_f32_32x32x16_bf16 a[16:31], a[148:151], v[32:35], a[16:31]
    v_add_f32 v24, v24, v60
    v_add_f32 v24, v24, v61
    v_add_f32 v24, v24, v62
    ds_read_b64_tr_b16 a[144:145], v8 offset:6144
    ds_read_b64_tr_b16 a[146:147], v8 offset:9216
    s_waitcnt lgkmcnt(8)
    v_mfma_f32_32x32x16_bf16 a[32:47], a[152:155], v[32:35], a[32:47]
    v_add_f32 v24, v24, v63
    v_add_f32 v24, v24, v64
    s_add_u32 s51, s48, 49152
    s_mov_b32 m0, s59
    s_nop 0
    buffer_load_dwordx4 v15, s[28:31], s51 offen offset:0 nt lds
    ds_read_b64_tr_b16 a[148:149], v9 offset:6144
    ds_read_b64_tr_b16 a[150:151], v9 offset:9216
    s_waitcnt lgkmcnt(8)
    v_mfma_f32_32x32x16_bf16 a[48:63], a[156:159], v[32:35], a[48:63]
    v_add_f32 v24, v24, v65
    v_add_f32 v24, v24, v66
    v_add_f32 v24, v24, v67
    ds_read_b64_tr_b16 a[152:153], v8 offset:6272
    ds_read_b64_tr_b16 a[154:155], v8 offset:9344
    s_waitcnt lgkmcnt(8)
    v_mfma_f32_32x32x16_bf16 a[64:79], a[160:163], v[32:35], a[64:79]
    v_add_f32 v24, v24, v68
    v_add_f32 v24, v24, v69
    v_add_f32 v24, v24, v70
    v_add_f32 v24, v24, v71
    ds_read_b64_tr_b16 a[156:157], v9 offset:6272
    ds_read_b64_tr_b16 a[158:159], v9 offset:9344
    s_waitcnt lgkmcnt(8)
    v_mfma_f32_32x32x16_bf16 a[80:95], a[164:167], v[32:35], a[80:95]
    v_max3_f32 v26, v72, v73, v74
    v_max3_f32 v26, v26, v75, v76
    buffer_load_dwordx4 v16, s[28:31], s51 offen offset:1024 nt lds
    ds_read_b64_tr_b16 a[160:161], v8 offset:6400
    ds_read_b64_tr_b16 a[162:163], v8 offset:9472
    s_waitcnt lgkmcnt(8)
    v_mfma_f32_32x32x16_bf16 a[0:15], a[144:147], v[36:39], a[0:15]
    v_max3_f32 v26, v26, v77, v78
    v_max3_f32 v26, v26, v79, v80
    v_max3_f32 v26, v26, v81, v82
    ds_read_b64_tr_b16 a[164:165], v9 offset:6400
    ds_read_b64_tr_b16 a[166:167], v9 offset:9472
    s_waitcnt lgkmcnt(8)
    v_mfma_f32_32x32x16_bf16 a[16:31], a[148:151], v[36:39], a[16:31]
    v_max3_f32 v26, v26, v83, v84
    v_max3_f32 v26, v26, v85, v86
    v_max_f32 v26, v26, v87
    s_waitcnt lgkmcnt(6)
    v_mfma_f32_32x32x16_bf16 a[32:47], a[152:155], v[36:39], a[32:47]
    v_cmp_lt_f32 vcc, 0x41000000, v26
    s_nop 1
    s_mov_b64 s[54:55], vcc
    buffer_load_dwordx4 v17, s[28:31], s51 offen offset:2048 nt lds
    s_add_u32 s59, s59, 12288
    s_cmp_eq_u32 s59, s68
    s_cselect_b32 s59, s67, s59
    v_add_u32 v8, s66, v2
    v_add_u32 v9, s66, v3
    v_add_u32 v10, s66, v4
    v_add_u32 v11, s66, v5
    s_add_u32 s66, s66, 12288
    s_cmp_eq_u32 s66, 61440
    s_cselect_b32 s66, 0, s66
    s_waitcnt lgkmcnt(0)
    s_waitcnt vmcnt(9)
    s_barrier
    ds_read_b128 a[144:147], v8 offset:0
    ds_read_b128 a[148:151], v9 offset:0
    v_mfma_f32_32x32x16_bf16 a[48:63], a[156:159], v[36:39], a[48:63]
    ds_read_b128 a[152:155], v10 offset:0
    v_mfma_f32_32x32x16_bf16 a[64:79], a[160:163], v[36:39], a[64:79]
    ds_read_b128 a[156:159], v11 offset:0
    v_mfma_f32_32x32x16_bf16 a[80:95], a[164:167], v[36:39], a[80:95]
    ds_read_b128 a[160:163], v8 offset:128
    s_mov_b32 s56, 2
    s_cmp_lg_u64 s[54:55], 0
    s_cbranch_scc1 attn_SLOW1
attn_RET2:
    s_waitcnt lgkmcnt(4)
    v_mfma_f32_32x32x16_bf16 v[56:71], a[144:147], a[96:99], v[40:55]
    v_exp_f32 v72, v72
    v_exp_f32 v73, v73
    v_exp_f32 v74, v74
    ds_read_b128 a[164:167], v9 offset:128
    s_waitcnt lgkmcnt(4)
    v_mfma_f32_32x32x16_bf16 v[56:71], a[148:151], a[100:103], v[56:71]
    v_exp_f32 v75, v75
    v_exp_f32 v76, v76
    v_exp_f32 v77, v77
    ds_read_b128 a[144:147], v10 offset:128
    s_waitcnt lgkmcnt(4)
    v_mfma_f32_32x32x16_bf16 v[56:71], a[152:155], a[104:107], v[56:71]
    v_exp_f32 v78, v78
    v_exp_f32 v79, v79
    s_add_u32 s51, s48, 73728
    s_mov_b32 m0, s59
    s_nop 0
    buffer_load_dwordx4 v12, s[24:27], s51 offen offset:0 nt lds
    ds_read_b128 a[148:151], v11 offset:128
    s_waitcnt lgkmcnt(4)
    v_mfma_f32_32x32x16_bf16 v[56:71], a[156:159], a[108:111], v[56:71]
    v_cvt_pk_bf16_f32 v32, v72, v73
    v_cvt_pk_bf16_f32 v33, v74, v75
    v_cvt_pk_bf16_f32 v34, v76, v77
    ds_read_b128 a[152:155], v8 offset:256
    s_waitcnt lgkmcnt(4)
    v_mfma_f32_32x32x16_bf16 v[56:71], a[160:163], a[112:115], v[56:71]
    v_cvt_pk_bf16_f32 v35, v78, v79
    v_exp_f32 v80, v80
    v_exp_f32 v81, v81
    ds_read_b128 a[156:159], v9 offset:256
    s_waitcnt lgkmcnt(4)
    v_mfma_f32_32x32x16_bf16 v[56:71], a[164:167], a[116:119], v[56:71]
    v_exp_f32 v82, v82
    v_exp_f32 v83, v83
    buffer_load_dwordx4 v13, s[24:27], s51 offen offset:1024 nt lds
    ds_read_b128 a[160:163], v10 offset:256
    s_waitcnt lgkmcnt(4)
    v_mfma_f32_32x32x16_bf16 v[56:71], a[144:147], a[120:123], v[56:71]
    v_exp_f32 v84, v84
    v_exp_f32 v85, v85
    v_exp_f32 v86, v86
    ds_read_b128 a[164:167], v11 offset:256
    s_waitcnt lgkmcnt(4)
    v_mfma_f32_32x32x16_bf16 v[56:71], a[148:151], a[124:127], v[56:71]
    v_exp_f32 v87, v87
    v_cvt_pk_bf16_f32 v36, v80, v81
    v_cvt_pk_bf16_f32 v37, v82, v83
    s_waitcnt lgkmcnt(3)
    v_mfma_f32_32x32x16_bf16 v[56:71], a[152:155], a[128:131], v[56:71]
    v_cvt_pk_bf16_f32 v38, v84, v85
    v_cvt_pk_bf16_f32 v39, v86, v87
    buffer_load_dwordx4 v14, s[24:27], s51 offen offset:2048 nt lds
    s_add_u32 s59, s59, 12288
    s_cmp_eq_u32 s59, s68
    s_cselect_b32 s59, s67, s59
    v_add_u32 v8, s66, v6
    v_add_u32 v9, s66, v7
    s_add_u32 s66, s66, 12288
    s_cmp_eq_u32 s66, 61440
    s_cselect_b32 s66, 0, s66
    s_waitcnt lgkmcnt(0)
    s_waitcnt vmcnt(9)
    s_barrier
    ds_read_b64_tr_b16 a[144:145], v8 offset:0
    ds_read_b64_tr_b16 a[146:147], v8 offset:3072
    ds_read_b64_tr_b16 a[148:149], v9 offset:0
    ds_read_b64_tr_b16 a[150:151], v9 offset:3072
    v_mfma_f32_32x32x16_bf16 v[56:71], a[156:159], a[132:135], v[56:71]
    ds_read_b64_tr_b16 a[152:153], v8 offset:128
    ds_read_b64_tr_b16 a[154:155], v8 offset:3200
    v_mfma_f32_32x32x16_bf16 v[56:71], a[160:163], a[136:139], v[56:71]
    ds_read_b64_tr_b16 a[156:157], v9 offset:128
    ds_read_b64_tr_b16 a[158:159], v9 offset:3200
    v_mfma_f32_32x32x16_bf16 v[56:71], a[164:167], a[140:143], v[56:71]
    ds_read_b64_tr_b16 a[160:161], v8 offset:256
    ds_read_b64_tr_b16 a[162:163], v8 offset:3328
    s_waitcnt lgkmcnt(8)
    v_mfma_f32_32x32x16_bf16 a[0:15], a[144:147], v[32:35], a[0:15]
    v_add_f32 v24, v24, v72
    v_add_f32 v24, v24, v73
    v_add_f32 v24, v24, v74
    v_add_f32 v24, v24, v75
    ds_read_b64_tr_b16 a[164:165], v9 offset:256
    ds_read_b64_tr_b16 a[166:167], v9 offset:3328
    s_waitcnt lgkmcnt(8)
    v_mfma_f32_32x32x16_bf16 a[16:31], a[148:151], v[32:35], a[16:31]
    v_add_f32 v24, v24, v76
    v_add_f32 v24, v24, v77
    v_add_f32 v24, v24, v78
    ds_read_b64_tr_b16 a[144:145], v8 offset:6144
    ds_read_b64_tr_b16 a[146:147], v8 offset:9216
    s_waitcnt lgkmcnt(8)
    v_mfma_f32_32x32x16_bf16 a[32:47], a[152:155], v[32:35], a[32:47]
    s_add_u32 s51, s48, 61440
    s_mov_b32 m0, s59
    s_nop 0
    buffer_load_dwordx4 v15, s[28:31], s51 offen offset:0 nt lds
    v_add_f32 v24, v24, v79
    v_add_f32 v24, v24, v80
    ds_read_b64_tr_b16 a[148:149], v9 offset:6144
    ds_read_b64_tr_b16 a[150:151], v9 offset:9216
    s_waitcnt lgkmcnt(8)
    v_mfma_f32_32x32x16_bf16 a[48:63], a[156:159], v[32:35], a[48:63]
    v_add_f32 v24, v24, v81
    v_add_f32 v24, v24, v82
    v_add_f32 v24, v24, v83
    v_add_f32 v24, v24, v84
    ds_read_b64_tr_b16 a[152:153], v8 offset:6272
    ds_read_b64_tr_b16 a[154:155], v8 offset:9344
    s_waitcnt lgkmcnt(8)
    v_mfma_f32_32x32x16_bf16 a[64:79], a[160:163], v[32:35], a[64:79]
    buffer_load_dwordx4 v16, s[28:31], s51 offen offset:1024 nt lds
    v_add_f32 v24, v24, v85
    v_add_f32 v24, v24, v86
    ds_read_b64_tr_b16 a[156:157], v9 offset:6272
    ds_read_b64_tr_b16 a[158:159], v9 offset:9344
    s_waitcnt lgkmcnt(8)
    v_mfma_f32_32x32x16_bf16 a[80:95], a[164:167], v[32:35], a[80:95]
    v_add_f32 v24, v24, v87
    v_max3_f32 v26, v56, v57, v58
    v_max3_f32 v26, v26, v59, v60
    ds_read_b64_tr_b16 a[160:161], v8 offset:6400
    ds_read_b64_tr_b16 a[162:163], v8 offset:9472
    s_waitcnt lgkmcnt(8)
    v_mfma_f32_32x32x16_bf16 a[0:15], a[144:147], v[36:39], a[0:15]
    v_max3_f32 v26, v26, v61, v62
    v_max3_f32 v26, v26, v63, v64
    buffer_load_dwordx4 v17, s[28:31], s51 offen offset:2048 nt lds
    s_add_u32 s59, s59, 12288
    s_cmp_eq_u32 s59, s68
    s_cselect_b32 s59, s67, s59
    v_max3_f32 v26, v26, v65, v66
    ds_read_b64_tr_b16 a[164:165], v9 offset:6400
    ds_read_b64_tr_b16 a[166:167], v9 offset:9472
    s_waitcnt lgkmcnt(8)
    v_mfma_f32_32x32x16_bf16 a[16:31], a[148:151], v[36:39], a[16:31]
    v_max3_f32 v26, v26, v67, v68
    v_max3_f32 v26, v26, v69, v70
    v_max_f32 v26, v26, v71
    s_waitcnt lgkmcnt(6)
    v_mfma_f32_32x32x16_bf16 a[32:47], a[152:155], v[36:39], a[32:47]
    v_cmp_lt_f32 vcc, 0x41000000, v26
    s_nop 1
    s_mov_b64 s[54:55], vcc
    s_cmp_eq_u32 s50, 3
    s_cselect_b32 s49, 0x7f000000, s49
    v_add_u32 v8, s66, v2
    v_add_u32 v9, s66, v3
    v_add_u32 v10, s66, v4
    v_add_u32 v11, s66, v5
    s_add_u32 s66, s66, 12288
    s_cmp_eq_u32 s66, 61440
    s_cselect_b32 s66, 0, s66
    s_waitcnt lgkmcnt(0)
    s_waitcnt vmcnt(9)
    s_barrier
    ds_read_b128 a[144:147], v8 offset:0
    ds_read_b128 a[148:151], v9 offset:0
    v_mfma_f32_32x32x16_bf16 a[48:63], a[156:159], v[36:39], a[48:63]
    ds_read_b128 a[152:155], v10 offset:0
    v_mfma_f32_32x32x16_bf16 a[64:79], a[160:163], v[36:39], a[64:79]
    ds_read_b128 a[156:159], v11 offset:0
    v_mfma_f32_32x32x16_bf16 a[80:95], a[164:167], v[36:39], a[80:95]
    ds_read_b128 a[160:163], v8 offset:128
    s_mov_b32 s56, 3
    s_cmp_lg_u64 s[54:55], 0
    s_cbranch_scc1 attn_SLOW0
attn_RET3:
    s_waitcnt lgkmcnt(4)
    v_mfma_f32_32x32x16_bf16 v[72:87], a[144:147], a[96:99], v[40:55]
    v_exp_f32 v56, v56
    v_exp_f32 v57, v57
    v_exp_f32 v58, v58
    ds_read_b128 a[164:167], v9 offset:128
    s_waitcnt lgkmcnt(4)
    v_mfma_f32_32x32x16_bf16 v[72:87], a[148:151], a[100:103], v[72:87]
    v_exp_f32 v59, v59
    v_exp_f32 v60, v60
    v_exp_f32 v61, v61
    ds_read_b128 a[144:147], v10 offset:128
    s_waitcnt lgkmcnt(4)
    v_mfma_f32_32x32x16_bf16 v[72:87], a[152:155], a[104:107], v[72:87]
    v_exp_f32 v62, v62
    v_exp_f32 v63, v63
    s_add_u32 s51, s48, 86016
    s_mov_b32 m0, s59
    s_nop 0
    buffer_load_dwordx4 v12, s[24:27], s51 offen offset:0 nt lds
    ds_read_b128 a[148:151], v11 offset:128
    s_waitcnt lgkmcnt(4)
    v_mfma_f32_32x32x16_bf16 v[72:87], a[156:159], a[108:111], v[72:87]
    v_cvt_pk_bf16_f32 v32, v56, v57
    v_cvt_pk_bf16_f32 v33, v58, v59
    v_cvt_pk_bf16_f32 v34, v60, v61
    ds_read_b128 a[152:155], v8 offset:256
    s_waitcnt lgkmcnt(4)
    v_mfma_f32_32x32x16_bf16 v[72:87], a[160:163], a[112:115], v[72:87]
    v_cvt_pk_bf16_f32 v35, v62, v63
    v_exp_f32 v64, v64
    v_exp_f32 v65, v65
    ds_read_b128 a[156:159], v9 offset:256
    s_waitcnt lgkmcnt(4)
    v_mfma_f32_32x32x16_bf16 v[72:87], a[164:167], a[116:119], v[72:87]
    v_exp_f32 v66, v66
    v_exp_f32 v67, v67
    buffer_load_dwordx4 v13, s[24:27], s51 offen offset:1024 nt lds
    ds_read_b128 a[160:163], v10 offset:256
    s_waitcnt lgkmcnt(4)
    v_mfma_f32_32x32x16_bf16 v[72:87], a[144:147], a[120:123], v[72:87]
    v_exp_f32 v68, v68
    v_exp_f32 v69, v69
    v_exp_f32 v70, v70
    ds_read_b128 a[164:167], v11 offset:256
    s_waitcnt lgkmcnt(4)
    v_mfma_f32_32x32x16_bf16 v[72:87], a[148:151], a[124:127], v[72:87]
    v_exp_f32 v71, v71
    v_cvt_pk_bf16_f32 v36, v64, v65
    v_cvt_pk_bf16_f32 v37, v66, v67
    s_waitcnt lgkmcnt(3)
    v_mfma_f32_32x32x16_bf16 v[72:87], a[152:155], a[128:131], v[72:87]
    v_cvt_pk_bf16_f32 v38, v68, v69
    v_cvt_pk_bf16_f32 v39, v70, v71
    buffer_load_dwordx4 v14, s[24:27], s51 offen offset:2048 nt lds
    s_add_u32 s59, s59, 12288
    s_cmp_eq_u32 s59, s68
    s_cselect_b32 s59, s67, s59
    v_add_u32 v8, s66, v6
    v_add_u32 v9, s66, v7
    s_add_u32 s66, s66, 12288
    s_cmp_eq_u32 s66, 61440
    s_cselect_b32 s66, 0, s66
    s_waitcnt lgkmcnt(0)
    s_waitcnt vmcnt(9)
    s_barrier
    ds_read_b64_tr_b16 a[144:145], v8 offset:0
    ds_read_b64_tr_b16 a[146:147], v8 offset:3072
    ds_read_b64_tr_b16 a[148:149], v9 offset:0
    ds_read_b64_tr_b16 a[150:151], v9 offset:3072
    v_mfma_f32_32x32x16_bf16 v[72:87], a[156:159], a[132:135], v[72:87]
    ds_read_b64_tr_b16 a[152:153], v8 offset:128
    ds_read_b64_tr_b16 a[154:155], v8 offset:3200
    v_mfma_f32_32x32x16_bf16 v[72:87], a[160:163], a[136:139], v[72:87]
    ds_read_b64_tr_b16 a[156:157], v9 offset:128
    ds_read_b64_tr_b16 a[158:159], v9 offset:3200
    v_mfma_f32_32x32x16_bf16 v[72:87], a[164:167], a[140:143], v[72:87]
    ds_read_b64_tr_b16 a[160:161], v8 offset:256
    ds_read_b64_tr_b16 a[162:163], v8 offset:3328
    s_waitcnt lgkmcnt(8)
    v_mfma_f32_32x32x16_bf16 a[0:15], a[144:147], v[32:35], a[0:15]
    v_add_f32 v24, v24, v56
    v_add_f32 v24, v24, v57
    v_add_f32 v24, v24, v58
    v_add_f32 v24, v24, v59
    ds_read_b64_tr_b16 a[164:165], v9 offset:256
    ds_read_b64_tr_b16 a[166:167], v9 offset:3328
    s_waitcnt lgkmcnt(8)
    v_mfma_f32_32x32x16_bf16 a[16:31], a[148:151], v[32:35], a[16:31]
    v_add_f32 v24, v24, v60
    v_add_f32 v24, v24, v61
    v_add_f32 v24, v24, v62
    ds_read_b64_tr_b16 a[144:145], v8 offset:6144
    ds_read_b64_tr_b16 a[146:147], v8 offset:9216
    s_waitcnt lgkmcnt(8)
    v_mfma_f32_32x32x16_bf16 a[32:47], a[152:155], v[32:35], a[32:47]
    v_add_f32 v24, v24, v63
    v_add_f32 v24, v24, v64
    s_add_u32 s51, s48, 73728
    s_mov_b32 m0, s59
    s_nop 0
    buffer_load_dwordx4 v15, s[28:31], s51 offen offset:0 nt lds
    ds_read_b64_tr_b16 a[148:149], v9 offset:6144
    ds_read_b64_tr_b16 a[150:151], v9 offset:9216
    s_waitcnt lgkmcnt(8)
    v_mfma_f32_32x32x16_bf16 a[48:63], a[156:159], v[32:35], a[48:63]
    v_add_f32 v24, v24, v65
    v_add_f32 v24, v24, v66
    v_add_f32 v24, v24, v67
    ds_read_b64_tr_b16 a[152:153], v8 offset:6272
    ds_read_b64_tr_b16 a[154:155], v8 offset:9344
    s_waitcnt lgkmcnt(8)
    v_mfma_f32_32x32x16_bf16 a[64:79], a[160:163], v[32:35], a[64:79]
    v_add_f32 v24, v24, v68
    v_add_f32 v24, v24, v69
    v_add_f32 v24, v24, v70
    v_add_f32 v24, v24, v71
    ds_read_b64_tr_b16 a[156:157], v9 offset:6272
    ds_read_b64_tr_b16 a[158:159], v9 offset:9344
    s_waitcnt lgkmcnt(8)
    v_mfma_f32_32x32x16_bf16 a[80:95], a[164:167], v[32:35], a[80:95]
    v_max3_f32 v26, v72, v73, v74
    v_max3_f32 v26, v26, v75, v76
    buffer_load_dwordx4 v16, s[28:31], s51 offen offset:1024 nt lds
    ds_read_b64_tr_b16 a[160:161], v8 offset:6400
    ds_read_b64_tr_b16 a[162:163], v8 offset:9472
    s_waitcnt lgkmcnt(8)
    v_mfma_f32_32x32x16_bf16 a[0:15], a[144:147], v[36:39], a[0:15]
    v_max3_f32 v26, v26, v77, v78
    v_max3_f32 v26, v26, v79, v80
    v_max3_f32 v26, v26, v81, v82
    ds_read_b64_tr_b16 a[164:165], v9 offset:6400
    ds_read_b64_tr_b16 a[166:167], v9 offset:9472
    s_waitcnt lgkmcnt(8)
    v_mfma_f32_32x32x16_bf16 a[16:31], a[148:151], v[36:39], a[16:31]
    v_max3_f32 v26, v26, v83, v84
    v_max3_f32 v26, v26, v85, v86
    v_max_f32 v26, v26, v87
    s_waitcnt lgkmcnt(6)
    v_mfma_f32_32x32x16_bf16 a[32:47], a[152:155], v[36:39], a[32:47]
    v_cmp_lt_f32 vcc, 0x41000000, v26
    s_nop 1
    s_mov_b64 s[54:55], vcc
    buffer_load_dwordx4 v17, s[28:31], s51 offen offset:2048 nt lds
    s_add_u32 s59, s59, 12288
    s_cmp_eq_u32 s59, s68
    s_cselect_b32 s59, s67, s59
    v_add_u32 v8, s66, v2
    v_add_u32 v9, s66, v3
    v_add_u32 v10, s66, v4
    v_add_u32 v11, s66, v5
    s_add_u32 s66, s66, 12288
    s_cmp_eq_u32 s66, 61440
    s_cselect_b32 s66, 0, s66
    s_waitcnt lgkmcnt(0)
    s_waitcnt vmcnt(9)
    s_barrier
    ds_read_b128 a[144:147], v8 offset:0
    ds_read_b128 a[148:151], v9 offset:0
    v_mfma_f32_32x32x16_bf16 a[48:63], a[156:159], v[36:39], a[48:63]
    ds_read_b128 a[152:155], v10 offset:0
    v_mfma_f32_32x32x16_bf16 a[64:79], a[160:163], v[36:39], a[64:79]
    ds_read_b128 a[156:159], v11 offset:0
    v_mfma_f32_32x32x16_bf16 a[80:95], a[164:167], v[36:39], a[80:95]
    ds_read_b128 a[160:163], v8 offset:128
    s_mov_b32 s56, 4
    s_cmp_lg_u64 s[54:55], 0
    s_cbranch_scc1 attn_SLOW1
attn_RET4:
    s_waitcnt lgkmcnt(4)
    v_mfma_f32_32x32x16_bf16 v[56:71], a[144:147], a[96:99], v[40:55]
    v_exp_f32 v72, v72
    v_exp_f32 v73, v73
    v_exp_f32 v74, v74
    ds_read_b128 a[164:167], v9 offset:128
    s_waitcnt lgkmcnt(4)
    v_mfma_f32_32x32x16_bf16 v[56:71], a[148:151], a[100:103], v[56:71]
    v_exp_f32 v75, v75
    v_exp_f32 v76, v76
    v_exp_f32 v77, v77
    ds_read_b128 a[144:147], v10 offset:128
    s_waitcnt lgkmcnt(4)
    v_mfma_f32_32x32x16_bf16 v[56:71], a[152:155], a[104:107], v[56:71]
    v_exp_f32 v78, v78
    v_exp_f32 v79, v79
    s_add_u32 s51, s48, 98304
    s_mov_b32 m0, s59
    s_nop 0
    buffer_load_dwordx4 v12, s[24:27], s51 offen offset:0 nt lds
    ds_read_b128 a[148:151], v11 offset:128
    s_waitcnt lgkmcnt(4)
    v_mfma_f32_32x32x16_bf16 v[56:71], a[156:159], a[108:111], v[56:71]
    v_cvt_pk_bf16_f32 v32, v72, v73
    v_cvt_pk_bf16_f32 v33, v74, v75
    v_cvt_pk_bf16_f32 v34, v76, v77
    ds_read_b128 a[152:155], v8 offset:256
    s_waitcnt lgkmcnt(4)
    v_mfma_f32_32x32x16_bf16 v[56:71], a[160:163], a[112:115], v[56:71]
    v_cvt_pk_bf16_f32 v35, v78, v79
    v_exp_f32 v80, v80
    v_exp_f32 v81, v81
    ds_read_b128 a[156:159], v9 offset:256
    s_waitcnt lgkmcnt(4)
    v_mfma_f32_32x32x16_bf16 v[56:71], a[164:167], a[116:119], v[56:71]
    v_exp_f32 v82, v82
    v_exp_f32 v83, v83
    buffer_load_dwordx4 v13, s[24:27], s51 offen offset:1024 nt lds
    ds_read_b128 a[160:163], v10 offset:256
    s_waitcnt lgkmcnt(4)
    v_mfma_f32_32x32x16_bf16 v[56:71], a[144:147], a[120:123], v[56:71]
    v_exp_f32 v84, v84
    v_exp_f32 v85, v85
    v_exp_f32 v86, v86
    ds_read_b128 a[164:167], v11 offset:256
    s_waitcnt lgkmcnt(4)
    v_mfma_f32_32x32x16_bf16 v[56:71], a[148:151], a[124:127], v[56:71]
    v_exp_f32 v87, v87
    v_cvt_pk_bf16_f32 v36, v80, v81
    v_cvt_pk_bf16_f32 v37, v82, v83
    s_waitcnt lgkmcnt(3)
    v_mfma_f32_32x32x16_bf16 v[56:71], a[152:155], a[128:131], v[56:71]
    v_cvt_pk_bf16_f32 v38, v84, v85
    v_cvt_pk_bf16_f32 v39, v86, v87
    buffer_load_dwordx4 v14, s[24:27], s51 offen offset:2048 nt lds
    s_add_u32 s59, s59, 12288
    s_cmp_eq_u32 s59, s68
    s_cselect_b32 s59, s67, s59
    v_add_u32 v8, s66, v6
    v_add_u32 v9, s66, v7
    s_add_u32 s66, s66, 12288
    s_cmp_eq_u32 s66, 61440
    s_cselect_b32 s66, 0, s66
    s_waitcnt lgkmcnt(0)
    s_waitcnt vmcnt(9)
    s_barrier
    ds_read_b64_tr_b16 a[144:145], v8 offset:0
    ds_read_b64_tr_b16 a[146:147], v8 offset:3072
    ds_read_b64_tr_b16 a[148:149], v9 offset:0
    ds_read_b64_tr_b16 a[150:151], v9 offset:3072
    v_mfma_f32_32x32x16_bf16 v[56:71], a[156:159], a[132:135], v[56:71]
    ds_read_b64_tr_b16 a[152:153], v8 offset:128
    ds_read_b64_tr_b16 a[154:155], v8 offset:3200
    v_mfma_f32_32x32x16_bf16 v[56:71], a[160:163], a[136:139], v[56:71]
    ds_read_b64_tr_b16 a[156:157], v9 offset:128
    ds_read_b64_tr_b16 a[158:159], v9 offset:3200
    v_mfma_f32_32x32x16_bf16 v[56:71], a[164:167], a[140:143], v[56:71]
    ds_read_b64_tr_b16 a[160:161], v8 offset:256
    ds_read_b64_tr_b16 a[162:163], v8 offset:3328
    s_waitcnt lgkmcnt(8)
    v_mfma_f32_32x32x16_bf16 a[0:15], a[144:147], v[32:35], a[0:15]
    v_add_f32 v24, v24, v72
    v_add_f32 v24, v24, v73
    v_add_f32 v24, v24, v74
    v_add_f32 v24, v24, v75
    ds_read_b64_tr_b16 a[164:165], v9 offset:256
    ds_read_b64_tr_b16 a[166:167], v9 offset:3328
    s_waitcnt lgkmcnt(8)
    v_mfma_f32_32x32x16_bf16 a[16:31], a[148:151], v[32:35], a[16:31]
    v_add_f32 v24, v24, v76
    v_add_f32 v24, v24, v77
    v_add_f32 v24, v24, v78
    ds_read_b64_tr_b16 a[144:145], v8 offset:6144
    ds_read_b64_tr_b16 a[146:147], v8 offset:9216
    s_waitcnt lgkmcnt(8)
    v_mfma_f32_32x32x16_bf16 a[32:47], a[152:155], v[32:35], a[32:47]
    v_add_f32 v24, v24, v79
    v_add_f32 v24, v24, v80
    s_add_u32 s51, s48, 86016
    s_mov_b32 m0, s59
    s_nop 0
    buffer_load_dwordx4 v15, s[28:31], s51 offen offset:0 nt lds
    ds_read_b64_tr_b16 a[148:149], v9 offset:6144
    ds_read_b64_tr_b16 a[150:151], v9 offset:9216
    s_waitcnt lgkmcnt(8)
    v_mfma_f32_32x32x16_bf16 a[48:63], a[156:159], v[32:35], a[48:63]
    v_add_f32 v24, v24, v81
    v_add_f32 v24, v24, v82
    v_add_f32 v24, v24, v83
    ds_read_b64_tr_b16 a[152:153], v8 offset:6272
    ds_read_b64_tr_b16 a[154:155], v8 offset:9344
    s_waitcnt lgkmcnt(8)
    v_mfma_f32_32x32x16_bf16 a[64:79], a[160:163], v[32:35], a[64:79]
    v_add_f32 v24, v24, v84
    v_add_f32 v24, v24, v85
    v_add_f32 v24, v24, v86
    v_add_f32 v24, v24, v87
    ds_read_b64_tr_b16 a[156:157], v9 offset:6272
    ds_read_b64_tr_b16 a[158:159], v9 offset:9344
    s_waitcnt lgkmcnt(8)
    v_mfma_f32_32x32x16_bf16 a[80:95], a[164:167], v[32:35], a[80:95]
    v_max3_f32 v26, v56, v57, v58
    v_max3_f32 v26, v26, v59, v60
    buffer_load_dwordx4 v16, s[28:31], s51 offen offset:1024 nt lds
    ds_read_b64_tr_b16 a[160:161], v8 offset:6400
    ds_read_b64_tr_b16 a[162:163], v8 offset:9472
    s_waitcnt lgkmcnt(8)
    v_mfma_f32_32x32x16_bf16 a[0:15], a[144:147], v[36:39], a[0:15]
    v_max3_f32 v26, v26, v61, v62
    v_max3_f32 v26, v26, v63, v64
    v_max3_f32 v26, v26, v65, v66
    ds_read_b64_tr_b16 a[164:165], v9 offset:6400
    ds_read_b64_tr_b16 a[166:167], v9 offset:9472
    s_waitcnt lgkmcnt(8)
    v_mfma_f32_32x32x16_bf16 a[16:31], a[148:151], v[36:39], a[16:31]
    v_max3_f32 v26, v26, v67, v68
    v_max3_f32 v26, v26, v69, v70
    v_max_f32 v26, v26, v71
    s_waitcnt lgkmcnt(6)
    v_mfma_f32_32x32x16_bf16 a[32:47], a[152:155], v[36:39], a[32:47]
    v_cmp_lt_f32 vcc, 0x41000000, v26
    s_nop 1
    s_mov_b64 s[54:55], vcc
    buffer_load_dwordx4 v17, s[28:31], s51 offen offset:2048 nt lds
    s_add_u32 s59, s59, 12288
    s_cmp_eq_u32 s59, s68
    s_cselect_b32 s59, s67, s59
    v_add_u32 v8, s66, v2
    v_add_u32 v9, s66, v3
    v_add_u32 v10, s66, v4
    v_add_u32 v11, s66, v5
    s_add_u32 s66, s66, 12288
    s_cmp_eq_u32 s66, 61440
    s_cselect_b32 s66, 0, s66
    s_waitcnt lgkmcnt(0)
    s_waitcnt vmcnt(9)
    s_barrier
    ds_read_b128 a[144:147], v8 offset:0
    ds_read_b128 a[148:151], v9 offset:0
    v_mfma_f32_32x32x16_bf16 a[48:63], a[156:159], v[36:39], a[48:63]
    ds_read_b128 a[152:155], v10 offset:0
    v_mfma_f32_32x32x16_bf16 a[64:79], a[160:163], v[36:39], a[64:79]
    ds_read_b128 a[156:159], v11 offset:0
    v_mfma_f32_32x32x16_bf16 a[80:95], a[164:167], v[36:39], a[80:95]
    ds_read_b128 a[160:163], v8 offset:128
    s_mov_b32 s56, 5
    s_cmp_lg_u64 s[54:55], 0
    s_cbranch_scc1 attn_SLOW0
attn_RET5:
    s_waitcnt lgkmcnt(4)
    v_mfma_f32_32x32x16_bf16 v[72:87], a[144:147], a[96:99], v[40:55]
    v_exp_f32 v56, v56
    v_exp_f32 v57, v57
    v_exp_f32 v58, v58
    ds_read_b128 a[164:167], v9 offset:128
    s_waitcnt lgkmcnt(4)
    v_mfma_f32_32x32x16_bf16 v[72:87], a[148:151], a[100:103], v[72:87]
    v_exp_f32 v59, v59
    v_exp_f32 v60, v60
    v_exp_f32 v61, v61
    ds_read_b128 a[144:147], v10 offset:128
    s_waitcnt lgkmcnt(4)
    v_mfma_f32_32x32x16_bf16 v[72:87], a[152:155], a[104:107], v[72:87]
    v_exp_f32 v62, v62
    v_exp_f32 v63, v63
    s_add_u32 s51, s48, 110592
    s_mov_b32 m0, s59
    s_nop 0
    buffer_load_dwordx4 v12, s[24:27], s51 offen offset:0 nt lds
    ds_read_b128 a[148:151], v11 offset:128
    s_waitcnt lgkmcnt(4)
    v_mfma_f32_32x32x16_bf16 v[72:87], a[156:159], a[108:111], v[72:87]
    v_cvt_pk_bf16_f32 v32, v56, v57
    v_cvt_pk_bf16_f32 v33, v58, v59
    v_cvt_pk_bf16_f32 v34, v60, v61
    ds_read_b128 a[152:155], v8 offset:256
    s_waitcnt lgkmcnt(4)
    v_mfma_f32_32x32x16_bf16 v[72:87], a[160:163], a[112:115], v[72:87]
    v_cvt_pk_bf16_f32 v35, v62, v63
    v_exp_f32 v64, v64
    v_exp_f32 v65, v65
    ds_read_b128 a[156:159], v9 offset:256
    s_waitcnt lgkmcnt(4)
    v_mfma_f32_32x32x16_bf16 v[72:87], a[164:167], a[116:119], v[72:87]
    v_exp_f32 v66, v66
    v_exp_f32 v67, v67
    buffer_load_dwordx4 v13, s[24:27], s51 offen offset:1024 nt lds
    ds_read_b128 a[160:163], v10 offset:256
    s_waitcnt lgkmcnt(4)
    v_mfma_f32_32x32x16_bf16 v[72:87], a[144:147], a[120:123], v[72:87]
    v_exp_f32 v68, v68
    v_exp_f32 v69, v69
    v_exp_f32 v70, v70
    ds_read_b128 a[164:167], v11 offset:256
    s_waitcnt lgkmcnt(4)
    v_mfma_f32_32x32x16_bf16 v[72:87], a[148:151], a[124:127], v[72:87]
    v_exp_f32 v71, v71
    v_cvt_pk_bf16_f32 v36, v64, v65
    v_cvt_pk_bf16_f32 v37, v66, v67
    s_waitcnt lgkmcnt(3)
    v_mfma_f32_32x32x16_bf16 v[72:87], a[152:155], a[128:131], v[72:87]
    v_cvt_pk_bf16_f32 v38, v68, v69
    v_cvt_pk_bf16_f32 v39, v70, v71
    buffer_load_dwordx4 v14, s[24:27], s51 offen offset:2048 nt lds
    s_add_u32 s59, s59, 12288
    s_cmp_eq_u32 s59, s68
    s_cselect_b32 s59, s67, s59
    v_add_u32 v8, s66, v6
    v_add_u32 v9, s66, v7
    s_add_u32 s66, s66, 12288
    s_cmp_eq_u32 s66, 61440
    s_cselect_b32 s66, 0, s66
    s_waitcnt lgkmcnt(0)
    s_waitcnt vmcnt(9)
    s_barrier
    ds_read_b64_tr_b16 a[144:145], v8 offset:0
    ds_read_b64_tr_b16 a[146:147], v8 offset:3072
    ds_read_b64_tr_b16 a[148:149], v9 offset:0
    ds_read_b64_tr_b16 a[150:151], v9 offset:3072
    v_mfma_f32_32x32x16_bf16 v[72:87], a[156:159], a[132:135], v[72:87]
    ds_read_b64_tr_b16 a[152:153], v8 offset:128
    ds_read_b64_tr_b16 a[154:155], v8 offset:3200
    v_mfma_f32_32x32x16_bf16 v[72:87], a[160:163], a[136:139], v[72:87]
    ds_read_b64_tr_b16 a[156:157], v9 offset:128
    ds_read_b64_tr_b16 a[158:159], v9 offset:3200
    v_mfma_f32_32x32x16_bf16 v[72:87], a[164:167], a[140:143], v[72:87]
    ds_read_b64_tr_b16 a[160:161], v8 offset:256
    ds_read_b64_tr_b16 a[162:163], v8 offset:3328
    s_waitcnt lgkmcnt(8)
    v_mfma_f32_32x32x16_bf16 a[0:15], a[144:147], v[32:35], a[0:15]
    v_add_f32 v24, v24, v56
    v_add_f32 v24, v24, v57
    v_add_f32 v24, v24, v58
    v_add_f32 v24, v24, v59
    ds_read_b64_tr_b16 a[164:165], v9 offset:256
    ds_read_b64_tr_b16 a[166:167], v9 offset:3328
    s_waitcnt lgkmcnt(8)
    v_mfma_f32_32x32x16_bf16 a[16:31], a[148:151], v[32:35], a[16:31]
    v_add_f32 v24, v24, v60
    v_add_f32 v24, v24, v61
    v_add_f32 v24, v24, v62
    ds_read_b64_tr_b16 a[144:145], v8 offset:6144
    ds_read_b64_tr_b16 a[146:147], v8 offset:9216
    s_waitcnt lgkmcnt(8)
    v_mfma_f32_32x32x16_bf16 a[32:47], a[152:155], v[32:35], a[32:47]
    v_add_f32 v24, v24, v63
    v_add_f32 v24, v24, v64
    s_add_u32 s51, s48, 98304
    s_mov_b32 m0, s59
    s_nop 0
    buffer_load_dwordx4 v15, s[28:31], s51 offen offset:0 nt lds
    ds_read_b64_tr_b16 a[148:149], v9 offset:6144
    ds_read_b64_tr_b16 a[150:151], v9 offset:9216
    s_waitcnt lgkmcnt(8)
    v_mfma_f32_32x32x16_bf16 a[48:63], a[156:159], v[32:35], a[48:63]
    v_add_f32 v24, v24, v65
    v_add_f32 v24, v24, v66
    v_add_f32 v24, v24, v67
    ds_read_b64_tr_b16 a[152:153], v8 offset:6272
    ds_read_b64_tr_b16 a[154:155], v8 offset:9344
    s_waitcnt lgkmcnt(8)
    v_mfma_f32_32x32x16_bf16 a[64:79], a[160:163], v[32:35], a[64:79]
    v_add_f32 v24, v24, v68
    v_add_f32 v24, v24, v69
    v_add_f32 v24, v24, v70
    v_add_f32 v24, v24, v71
    ds_read_b64_tr_b16 a[156:157], v9 offset:6272
    ds_read_b64_tr_b16 a[158:159], v9 offset:9344
    s_waitcnt lgkmcnt(8)
    v_mfma_f32_32x32x16_bf16 a[80:95], a[164:167], v[32:35], a[80:95]
    v_max3_f32 v26, v72, v73, v74
    v_max3_f32 v26, v26, v75, v76
    buffer_load_dwordx4 v16, s[28:31], s51 offen offset:1024 nt lds
    ds_read_b64_tr_b16 a[160:161], v8 offset:6400
    ds_read_b64_tr_b16 a[162:163], v8 offset:9472
    s_waitcnt lgkmcnt(8)
    v_mfma_f32_32x32x16_bf16 a[0:15], a[144:147], v[36:39], a[0:15]
    v_max3_f32 v26, v26, v77, v78
    v_max3_f32 v26, v26, v79, v80
    v_max3_f32 v26, v26, v81, v82
    ds_read_b64_tr_b16 a[164:165], v9 offset:6400
    ds_read_b64_tr_b16 a[166:167], v9 offset:9472
    s_waitcnt lgkmcnt(8)
    v_mfma_f32_32x32x16_bf16 a[16:31], a[148:151], v[36:39], a[16:31]
    v_max3_f32 v26, v26, v83, v84
    v_max3_f32 v26, v26, v85, v86
    v_max_f32 v26, v26, v87
    s_waitcnt lgkmcnt(6)
    v_mfma_f32_32x32x16_bf16 a[32:47], a[152:155], v[36:39], a[32:47]
    v_cmp_lt_f32 vcc, 0x41000000, v26
    s_nop 1
    s_mov_b64 s[54:55], vcc
    buffer_load_dwordx4 v17, s[28:31], s51 offen offset:2048 nt lds
    s_add_u32 s59, s59, 12288
    s_cmp_eq_u32 s59, s68
    s_cselect_b32 s59, s67, s59
    v_add_u32 v8, s66, v2
    v_add_u32 v9, s66, v3
    v_add_u32 v10, s66, v4
    v_add_u32 v11, s66, v5
    s_add_u32 s66, s66, 12288
    s_cmp_eq_u32 s66, 61440
    s_cselect_b32 s66, 0, s66
    s_waitcnt lgkmcnt(0)
    s_waitcnt vmcnt(9)
    s_barrier
    ds_read_b128 a[144:147], v8 offset:0
    ds_read_b128 a[148:151], v9 offset:0
    v_mfma_f32_32x32x16_bf16 a[48:63], a[156:159], v[36:39], a[48:63]
    ds_read_b128 a[152:155], v10 offset:0
    v_mfma_f32_32x32x16_bf16 a[64:79], a[160:163], v[36:39], a[64:79]
    ds_read_b128 a[156:159], v11 offset:0
    v_mfma_f32_32x32x16_bf16 a[80:95], a[164:167], v[36:39], a[80:95]
    ds_read_b128 a[160:163], v8 offset:128
    s_mov_b32 s56, 6
    s_cmp_lg_u64 s[54:55], 0
    s_cbranch_scc1 attn_SLOW1
attn_RET6:
    s_waitcnt lgkmcnt(4)
    v_mfma_f32_32x32x16_bf16 v[56:71], a[144:147], a[96:99], v[40:55]
    v_exp_f32 v72, v72
    v_exp_f32 v73, v73
    v_exp_f32 v74, v74
    ds_read_b128 a[164:167], v9 offset:128
    s_waitcnt lgkmcnt(4)
    v_mfma_f32_32x32x16_bf16 v[56:71], a[148:151], a[100:103], v[56:71]
    v_exp_f32 v75, v75
    v_exp_f32 v76, v76
    v_exp_f32 v77, v77
    ds_read_b128 a[144:147], v10 offset:128
    s_waitcnt lgkmcnt(4)
    v_mfma_f32_32x32x16_bf16 v[56:71], a[152:155], a[104:107], v[56:71]
    v_exp_f32 v78, v78
    v_exp_f32 v79, v79
    s_add_u32 s51, s48, 122880
    s_mov_b32 m0, s59
    s_nop 0
    buffer_load_dwordx4 v12, s[24:27], s51 offen offset:0 nt lds
    ds_read_b128 a[148:151], v11 offset:128
    s_waitcnt lgkmcnt(4)
    v_mfma_f32_32x32x16_bf16 v[56:71], a[156:159], a[108:111], v[56:71]
    v_cvt_pk_bf16_f32 v32, v72, v73
    v_cvt_pk_bf16_f32 v33, v74, v75
    v_cvt_pk_bf16_f32 v34, v76, v77
    ds_read_b128 a[152:155], v8 offset:256
    s_waitcnt lgkmcnt(4)
    v_mfma_f32_32x32x16_bf16 v[56:71], a[160:163], a[112:115], v[56:71]
    v_cvt_pk_bf16_f32 v35, v78, v79
    v_exp_f32 v80, v80
    v_exp_f32 v81, v81
    ds_read_b128 a[156:159], v9 offset:256
    s_waitcnt lgkmcnt(4)
    v_mfma_f32_32x32x16_bf16 v[56:71], a[164:167], a[116:119], v[56:71]
    v_exp_f32 v82, v82
    v_exp_f32 v83, v83
    buffer_load_dwordx4 v13, s[24:27], s51 offen offset:1024 nt lds
    ds_read_b128 a[160:163], v10 offset:256
    s_waitcnt lgkmcnt(4)
    v_mfma_f32_32x32x16_bf16 v[56:71], a[144:147], a[120:123], v[56:71]
    v_exp_f32 v84, v84
    v_exp_f32 v85, v85
    v_exp_f32 v86, v86
    ds_read_b128 a[164:167], v11 offset:256
    s_waitcnt lgkmcnt(4)
    v_mfma_f32_32x32x16_bf16 v[56:71], a[148:151], a[124:127], v[56:71]
    v_exp_f32 v87, v87
    v_cvt_pk_bf16_f32 v36, v80, v81
    v_cvt_pk_bf16_f32 v37, v82, v83
    s_waitcnt lgkmcnt(3)
    v_mfma_f32_32x32x16_bf16 v[56:71], a[152:155], a[128:131], v[56:71]
    v_cvt_pk_bf16_f32 v38, v84, v85
    v_cvt_pk_bf16_f32 v39, v86, v87
    buffer_load_dwordx4 v14, s[24:27], s51 offen offset:2048 nt lds
    s_add_u32 s59, s59, 12288
    s_cmp_eq_u32 s59, s68
    s_cselect_b32 s59, s67, s59
    v_add_u32 v8, s66, v6
    v_add_u32 v9, s66, v7
    s_add_u32 s66, s66, 12288
    s_cmp_eq_u32 s66, 61440
    s_cselect_b32 s66, 0, s66
    s_waitcnt lgkmcnt(0)
    s_waitcnt vmcnt(9)
    s_barrier
    ds_read_b64_tr_b16 a[144:145], v8 offset:0
    ds_read_b64_tr_b16 a[146:147], v8 offset:3072
    ds_read_b64_tr_b16 a[148:149], v9 offset:0
    ds_read_b64_tr_b16 a[150:151], v9 offset:3072
    v_mfma_f32_32x32x16_bf16 v[56:71], a[156:159], a[132:135], v[56:71]
    ds_read_b64_tr_b16 a[152:153], v8 offset:128
    ds_read_b64_tr_b16 a[154:155], v8 offset:3200
    v_mfma_f32_32x32x16_bf16 v[56:71], a[160:163], a[136:139], v[56:71]
    ds_read_b64_tr_b16 a[156:157], v9 offset:128
    ds_read_b64_tr_b16 a[158:159], v9 offset:3200
    v_mfma_f32_32x32x16_bf16 v[56:71], a[164:167], a[140:143], v[56:71]
    ds_read_b64_tr_b16 a[160:161], v8 offset:256
    ds_read_b64_tr_b16 a[162:163], v8 offset:3328
    s_waitcnt lgkmcnt(8)
    v_mfma_f32_32x32x16_bf16 a[0:15], a[144:147], v[32:35], a[0:15]
    v_add_f32 v24, v24, v72
    v_add_f32 v24, v24, v73
    v_add_f32 v24, v24, v74
    v_add_f32 v24, v24, v75
    ds_read_b64_tr_b16 a[164:165], v9 offset:256
    ds_read_b64_tr_b16 a[166:167], v9 offset:3328
    s_waitcnt lgkmcnt(8)
    v_mfma_f32_32x32x16_bf16 a[16:31], a[148:151], v[32:35], a[16:31]
    v_add_f32 v24, v24, v76
    v_add_f32 v24, v24, v77
    v_add_f32 v24, v24, v78
    ds_read_b64_tr_b16 a[144:145], v8 offset:6144
    ds_read_b64_tr_b16 a[146:147], v8 offset:9216
    s_waitcnt lgkmcnt(8)
    v_mfma_f32_32x32x16_bf16 a[32:47], a[152:155], v[32:35], a[32:47]
    v_add_f32 v24, v24, v79
    v_add_f32 v24, v24, v80
    s_add_u32 s51, s48, 110592
    s_mov_b32 m0, s59
    s_nop 0
    buffer_load_dwordx4 v15, s[28:31], s51 offen offset:0 nt lds
    ds_read_b64_tr_b16 a[148:149], v9 offset:6144
    ds_read_b64_tr_b16 a[150:151], v9 offset:9216
    s_waitcnt lgkmcnt(8)
    v_mfma_f32_32x32x16_bf16 a[48:63], a[156:159], v[32:35], a[48:63]
    v_add_f32 v24, v24, v81
    v_add_f32 v24, v24, v82
    v_add_f32 v24, v24, v83
    ds_read_b64_tr_b16 a[152:153], v8 offset:6272
    ds_read_b64_tr_b16 a[154:155], v8 offset:9344
    s_waitcnt lgkmcnt(8)
    v_mfma_f32_32x32x16_bf16 a[64:79], a[160:163], v[32:35], a[64:79]
    v_add_f32 v24, v24, v84
    v_add_f32 v24, v24, v85
    v_add_f32 v24, v24, v86
    v_add_f32 v24, v24, v87
    ds_read_b64_tr_b16 a[156:157], v9 offset:6272
    ds_read_b64_tr_b16 a[158:159], v9 offset:9344
    s_waitcnt lgkmcnt(8)
    v_mfma_f32_32x32x16_bf16 a[80:95], a[164:167], v[32:35], a[80:95]
    v_max3_f32 v26, v56, v57, v58
    v_max3_f32 v26, v26, v59, v60
    buffer_load_dwordx4 v16, s[28:31], s51 offen offset:1024 nt lds
    ds_read_b64_tr_b16 a[160:161], v8 offset:6400
    ds_read_b64_tr_b16 a[162:163], v8 offset:9472
    s_waitcnt lgkmcnt(8)
    v_mfma_f32_32x32x16_bf16 a[0:15], a[144:147], v[36:39], a[0:15]
    v_max3_f32 v26, v26, v61, v62
    v_max3_f32 v26, v26, v63, v64
    v_max3_f32 v26, v26, v65, v66
    ds_read_b64_tr_b16 a[164:165], v9 offset:6400
    ds_read_b64_tr_b16 a[166:167], v9 offset:9472
    s_waitcnt lgkmcnt(8)
    v_mfma_f32_32x32x16_bf16 a[16:31], a[148:151], v[36:39], a[16:31]
    v_max3_f32 v26, v26, v67, v68
    v_max3_f32 v26, v26, v69, v70
    v_max_f32 v26, v26, v71
    s_waitcnt lgkmcnt(6)
    v_mfma_f32_32x32x16_bf16 a[32:47], a[152:155], v[36:39], a[32:47]
    v_cmp_lt_f32 vcc, 0x41000000, v26
    s_nop 1
    s_mov_b64 s[54:55], vcc
    buffer_load_dwordx4 v17, s[28:31], s51 offen offset:2048 nt lds
    s_add_u32 s59, s59, 12288
    s_cmp_eq_u32 s59, s68
    s_cselect_b32 s59, s67, s59
    v_add_u32 v8, s66, v2
    v_add_u32 v9, s66, v3
    v_add_u32 v10, s66, v4
    v_add_u32 v11, s66, v5
    s_add_u32 s66, s66, 12288
    s_cmp_eq_u32 s66, 61440
    s_cselect_b32 s66, 0, s66
    s_waitcnt lgkmcnt(0)
    s_waitcnt vmcnt(9)
    s_barrier
    ds_read_b128 a[144:147], v8 offset:0
    ds_read_b128 a[148:151], v9 offset:0
    v_mfma_f32_32x32x16_bf16 a[48:63], a[156:159], v[36:39], a[48:63]
    ds_read_b128 a[152:155], v10 offset:0
    v_mfma_f32_32x32x16_bf16 a[64:79], a[160:163], v[36:39], a[64:79]
    ds_read_b128 a[156:159], v11 offset:0
    v_mfma_f32_32x32x16_bf16 a[80:95], a[164:167], v[36:39], a[80:95]
    ds_read_b128 a[160:163], v8 offset:128
    s_mov_b32 s56, 7
    s_cmp_lg_u64 s[54:55], 0
    s_cbranch_scc1 attn_SLOW0
attn_RET7:
    s_waitcnt lgkmcnt(4)
    v_mfma_f32_32x32x16_bf16 v[72:87], a[144:147], a[96:99], v[40:55]
    v_exp_f32 v56, v56
    v_exp_f32 v57, v57
    v_exp_f32 v58, v58
    ds_read_b128 a[164:167], v9 offset:128
    s_waitcnt lgkmcnt(4)
    v_mfma_f32_32x32x16_bf16 v[72:87], a[148:151], a[100:103], v[72:87]
    v_exp_f32 v59, v59
    v_exp_f32 v60, v60
    v_exp_f32 v61, v61
    ds_read_b128 a[144:147], v10 offset:128
    s_waitcnt lgkmcnt(4)
    v_mfma_f32_32x32x16_bf16 v[72:87], a[152:155], a[104:107], v[72:87]
    v_exp_f32 v62, v62
    v_exp_f32 v63, v63
    s_add_u32 s51, s48, 135168
    s_mov_b32 m0, s59
    s_nop 0
    buffer_load_dwordx4 v12, s[24:27], s51 offen offset:0 nt lds
    ds_read_b128 a[148:151], v11 offset:128
    s_waitcnt lgkmcnt(4)
    v_mfma_f32_32x32x16_bf16 v[72:87], a[156:159], a[108:111], v[72:87]
    v_cvt_pk_bf16_f32 v32, v56, v57
    v_cvt_pk_bf16_f32 v33, v58, v59
    v_cvt_pk_bf16_f32 v34, v60, v61
    ds_read_b128 a[152:155], v8 offset:256
    s_waitcnt lgkmcnt(4)
    v_mfma_f32_32x32x16_bf16 v[72:87], a[160:163], a[112:115], v[72:87]
    v_cvt_pk_bf16_f32 v35, v62, v63
    v_exp_f32 v64, v64
    v_exp_f32 v65, v65
    ds_read_b128 a[156:159], v9 offset:256
    s_waitcnt lgkmcnt(4)
    v_mfma_f32_32x32x16_bf16 v[72:87], a[164:167], a[116:119], v[72:87]
    v_exp_f32 v66, v66
    v_exp_f32 v67, v67
    buffer_load_dwordx4 v13, s[24:27], s51 offen offset:1024 nt lds
    ds_read_b128 a[160:163], v10 offset:256
    s_waitcnt lgkmcnt(4)
    v_mfma_f32_32x32x16_bf16 v[72:87], a[144:147], a[120:123], v[72:87]
    v_exp_f32 v68, v68
    v_exp_f32 v69, v69
    v_exp_f32 v70, v70
    ds_read_b128 a[164:167], v11 offset:256
    s_waitcnt lgkmcnt(4)
    v_mfma_f32_32x32x16_bf16 v[72:87], a[148:151], a[124:127], v[72:87]
    v_exp_f32 v71, v71
    v_cvt_pk_bf16_f32 v36, v64, v65
    v_cvt_pk_bf16_f32 v37, v66, v67
    s_waitcnt lgkmcnt(3)
    v_mfma_f32_32x32x16_bf16 v[72:87], a[152:155], a[128:131], v[72:87]
    v_cvt_pk_bf16_f32 v38, v68, v69
    v_cvt_pk_bf16_f32 v39, v70, v71
    buffer_load_dwordx4 v14, s[24:27], s51 offen offset:2048 nt lds
    s_add_u32 s59, s59, 12288
    s_cmp_eq_u32 s59, s68
    s_cselect_b32 s59, s67, s59
    v_add_u32 v8, s66, v6
    v_add_u32 v9, s66, v7
    s_add_u32 s66, s66, 12288
    s_cmp_eq_u32 s66, 61440
    s_cselect_b32 s66, 0, s66
    s_waitcnt lgkmcnt(0)
    s_waitcnt vmcnt(9)
    s_barrier
    ds_read_b64_tr_b16 a[144:145], v8 offset:0
    ds_read_b64_tr_b16 a[146:147], v8 offset:3072
    ds_read_b64_tr_b16 a[148:149], v9 offset:0
    ds_read_b64_tr_b16 a[150:151], v9 offset:3072
    v_mfma_f32_32x32x16_bf16 v[72:87], a[156:159], a[132:135], v[72:87]
    ds_read_b64_tr_b16 a[152:153], v8 offset:128
    ds_read_b64_tr_b16 a[154:155], v8 offset:3200
    v_mfma_f32_32x32x16_bf16 v[72:87], a[160:163], a[136:139], v[72:87]
    ds_read_b64_tr_b16 a[156:157], v9 offset:128
    ds_read_b64_tr_b16 a[158:159], v9 offset:3200
    v_mfma_f32_32x32x16_bf16 v[72:87], a[164:167], a[140:143], v[72:87]
    ds_read_b64_tr_b16 a[160:161], v8 offset:256
    ds_read_b64_tr_b16 a[162:163], v8 offset:3328
    s_waitcnt lgkmcnt(8)
    v_mfma_f32_32x32x16_bf16 a[0:15], a[144:147], v[32:35], a[0:15]
    v_add_f32 v24, v24, v56
    v_add_f32 v24, v24, v57
    v_add_f32 v24, v24, v58
    v_add_f32 v24, v24, v59
    ds_read_b64_tr_b16 a[164:165], v9 offset:256
    ds_read_b64_tr_b16 a[166:167], v9 offset:3328
    s_waitcnt lgkmcnt(8)
    v_mfma_f32_32x32x16_bf16 a[16:31], a[148:151], v[32:35], a[16:31]
    v_add_f32 v24, v24, v60
    v_add_f32 v24, v24, v61
    v_add_f32 v24, v24, v62
    ds_read_b64_tr_b16 a[144:145], v8 offset:6144
    ds_read_b64_tr_b16 a[146:147], v8 offset:9216
    s_waitcnt lgkmcnt(8)
    v_mfma_f32_32x32x16_bf16 a[32:47], a[152:155], v[32:35], a[32:47]
    v_add_f32 v24, v24, v63
    v_add_f32 v24, v24, v64
    s_add_u32 s51, s48, 122880
    s_mov_b32 m0, s59
    s_nop 0
    buffer_load_dwordx4 v15, s[28:31], s51 offen offset:0 nt lds
    ds_read_b64_tr_b16 a[148:149], v9 offset:6144
    ds_read_b64_tr_b16 a[150:151], v9 offset:9216
    s_waitcnt lgkmcnt(8)
    v_mfma_f32_32x32x16_bf16 a[48:63], a[156:159], v[32:35], a[48:63]
    v_add_f32 v24, v24, v65
    v_add_f32 v24, v24, v66
    v_add_f32 v24, v24, v67
    ds_read_b64_tr_b16 a[152:153], v8 offset:6272
    ds_read_b64_tr_b16 a[154:155], v8 offset:9344
    s_waitcnt lgkmcnt(8)
    v_mfma_f32_32x32x16_bf16 a[64:79], a[160:163], v[32:35], a[64:79]
    v_add_f32 v24, v24, v68
    v_add_f32 v24, v24, v69
    v_add_f32 v24, v24, v70
    v_add_f32 v24, v24, v71
    ds_read_b64_tr_b16 a[156:157], v9 offset:6272
    ds_read_b64_tr_b16 a[158:159], v9 offset:9344
    s_waitcnt lgkmcnt(8)
    v_mfma_f32_32x32x16_bf16 a[80:95], a[164:167], v[32:35], a[80:95]
    v_max3_f32 v26, v72, v73, v74
    v_max3_f32 v26, v26, v75, v76
    buffer_load_dwordx4 v16, s[28:31], s51 offen offset:1024 nt lds
    ds_read_b64_tr_b16 a[160:161], v8 offset:6400
    ds_read_b64_tr_b16 a[162:163], v8 offset:9472
    s_waitcnt lgkmcnt(8)
    v_mfma_f32_32x32x16_bf16 a[0:15], a[144:147], v[36:39], a[0:15]
    v_max3_f32 v26, v26, v77, v78
    v_max3_f32 v26, v26, v79, v80
    v_max3_f32 v26, v26, v81, v82
    ds_read_b64_tr_b16 a[164:165], v9 offset:6400
    ds_read_b64_tr_b16 a[166:167], v9 offset:9472
    s_waitcnt lgkmcnt(8)
    v_mfma_f32_32x32x16_bf16 a[16:31], a[148:151], v[36:39], a[16:31]
    v_max3_f32 v26, v26, v83, v84
    v_max3_f32 v26, v26, v85, v86
    v_max_f32 v26, v26, v87
    s_waitcnt lgkmcnt(6)
    v_mfma_f32_32x32x16_bf16 a[32:47], a[152:155], v[36:39], a[32:47]
    v_cmp_lt_f32 vcc, 0x41000000, v26
    s_nop 1
    s_mov_b64 s[54:55], vcc
    buffer_load_dwordx4 v17, s[28:31], s51 offen offset:2048 nt lds
    s_add_u32 s59, s59, 12288
    s_cmp_eq_u32 s59, s68
    s_cselect_b32 s59, s67, s59
    v_add_u32 v8, s66, v2
    v_add_u32 v9, s66, v3
    v_add_u32 v10, s66, v4
    v_add_u32 v11, s66, v5
    s_add_u32 s66, s66, 12288
    s_cmp_eq_u32 s66, 61440
    s_cselect_b32 s66, 0, s66
    s_waitcnt lgkmcnt(0)
    s_waitcnt vmcnt(9)
    s_barrier
    ds_read_b128 a[144:147], v8 offset:0
    ds_read_b128 a[148:151], v9 offset:0
    v_mfma_f32_32x32x16_bf16 a[48:63], a[156:159], v[36:39], a[48:63]
    ds_read_b128 a[152:155], v10 offset:0
    v_mfma_f32_32x32x16_bf16 a[64:79], a[160:163], v[36:39], a[64:79]
    ds_read_b128 a[156:159], v11 offset:0
    v_mfma_f32_32x32x16_bf16 a[80:95], a[164:167], v[36:39], a[80:95]
    ds_read_b128 a[160:163], v8 offset:128
    s_mov_b32 s56, 8
    s_cmp_lg_u64 s[54:55], 0
    s_cbranch_scc1 attn_SLOW1
attn_RET8:
    s_waitcnt lgkmcnt(4)
    v_mfma_f32_32x32x16_bf16 v[56:71], a[144:147], a[96:99], v[40:55]
    v_exp_f32 v72, v72
    v_exp_f32 v73, v73
    v_exp_f32 v74, v74
    ds_read_b128 a[164:167], v9 offset:128
    s_waitcnt lgkmcnt(4)
    v_mfma_f32_32x32x16_bf16 v[56:71], a[148:151], a[100:103], v[56:71]
    v_exp_f32 v75, v75
    v_exp_f32 v76, v76
    v_exp_f32 v77, v77
    ds_read_b128 a[144:147], v10 offset:128
    s_waitcnt lgkmcnt(4)
    v_mfma_f32_32x32x16_bf16 v[56:71], a[152:155], a[104:107], v[56:71]
    v_exp_f32 v78, v78
    v_exp_f32 v79, v79
    s_add_u32 s51, s48, 147456
    s_mov_b32 m0, s59
    s_nop 0
    buffer_load_dwordx4 v12, s[24:27], s51 offen offset:0 nt lds
    ds_read_b128 a[148:151], v11 offset:128
    s_waitcnt lgkmcnt(4)
    v_mfma_f32_32x32x16_bf16 v[56:71], a[156:159], a[108:111], v[56:71]
    v_cvt_pk_bf16_f32 v32, v72, v73
    v_cvt_pk_bf16_f32 v33, v74, v75
    v_cvt_pk_bf16_f32 v34, v76, v77
    ds_read_b128 a[152:155], v8 offset:256
    s_waitcnt lgkmcnt(4)
    v_mfma_f32_32x32x16_bf16 v[56:71], a[160:163], a[112:115], v[56:71]
    v_cvt_pk_bf16_f32 v35, v78, v79
    v_exp_f32 v80, v80
    v_exp_f32 v81, v81
    ds_read_b128 a[156:159], v9 offset:256
    s_waitcnt lgkmcnt(4)
    v_mfma_f32_32x32x16_bf16 v[56:71], a[164:167], a[116:119], v[56:71]
    v_exp_f32 v82, v82
    v_exp_f32 v83, v83
    buffer_load_dwordx4 v13, s[24:27], s51 offen offset:1024 nt lds
    ds_read_b128 a[160:163], v10 offset:256
    s_waitcnt lgkmcnt(4)
    v_mfma_f32_32x32x16_bf16 v[56:71], a[144:147], a[120:123], v[56:71]
    v_exp_f32 v84, v84
    v_exp_f32 v85, v85
    v_exp_f32 v86, v86
    ds_read_b128 a[164:167], v11 offset:256
    s_waitcnt lgkmcnt(4)
    v_mfma_f32_32x32x16_bf16 v[56:71], a[148:151], a[124:127], v[56:71]
    v_exp_f32 v87, v87
    v_cvt_pk_bf16_f32 v36, v80, v81
    v_cvt_pk_bf16_f32 v37, v82, v83
    s_waitcnt lgkmcnt(3)
    v_mfma_f32_32x32x16_bf16 v[56:71], a[152:155], a[128:131], v[56:71]
    v_cvt_pk_bf16_f32 v38, v84, v85
    v_cvt_pk_bf16_f32 v39, v86, v87
    buffer_load_dwordx4 v14, s[24:27], s51 offen offset:2048 nt lds
    s_add_u32 s59, s59, 12288
    s_cmp_eq_u32 s59, s68
    s_cselect_b32 s59, s67, s59
    v_add_u32 v8, s66, v6
    v_add_u32 v9, s66, v7
    s_add_u32 s66, s66, 12288
    s_cmp_eq_u32 s66, 61440
    s_cselect_b32 s66, 0, s66
    s_waitcnt lgkmcnt(0)
    s_waitcnt vmcnt(9)
    s_barrier
    ds_read_b64_tr_b16 a[144:145], v8 offset:0
    ds_read_b64_tr_b16 a[146:147], v8 offset:3072
    ds_read_b64_tr_b16 a[148:149], v9 offset:0
    ds_read_b64_tr_b16 a[150:151], v9 offset:3072
    v_mfma_f32_32x32x16_bf16 v[56:71], a[156:159], a[132:135], v[56:71]
    ds_read_b64_tr_b16 a[152:153], v8 offset:128
    ds_read_b64_tr_b16 a[154:155], v8 offset:3200
    v_mfma_f32_32x32x16_bf16 v[56:71], a[160:163], a[136:139], v[56:71]
    ds_read_b64_tr_b16 a[156:157], v9 offset:128
    ds_read_b64_tr_b16 a[158:159], v9 offset:3200
    v_mfma_f32_32x32x16_bf16 v[56:71], a[164:167], a[140:143], v[56:71]
    ds_read_b64_tr_b16 a[160:161], v8 offset:256
    ds_read_b64_tr_b16 a[162:163], v8 offset:3328
    s_waitcnt lgkmcnt(8)
    v_mfma_f32_32x32x16_bf16 a[0:15], a[144:147], v[32:35], a[0:15]
    v_add_f32 v24, v24, v72
    v_add_f32 v24, v24, v73
    v_add_f32 v24, v24, v74
    v_add_f32 v24, v24, v75
    ds_read_b64_tr_b16 a[164:165], v9 offset:256
    ds_read_b64_tr_b16 a[166:167], v9 offset:3328
    s_waitcnt lgkmcnt(8)
    v_mfma_f32_32x32x16_bf16 a[16:31], a[148:151], v[32:35], a[16:31]
    v_add_f32 v24, v24, v76
    v_add_f32 v24, v24, v77
    v_add_f32 v24, v24, v78
    ds_read_b64_tr_b16 a[144:145], v8 offset:6144
    ds_read_b64_tr_b16 a[146:147], v8 offset:9216
    s_waitcnt lgkmcnt(8)
    v_mfma_f32_32x32x16_bf16 a[32:47], a[152:155], v[32:35], a[32:47]
    v_add_f32 v24, v24, v79
    v_add_f32 v24, v24, v80
    s_add_u32 s51, s48, 135168
    s_mov_b32 m0, s59
    s_nop 0
    buffer_load_dwordx4 v15, s[28:31], s51 offen offset:0 nt lds
    ds_read_b64_tr_b16 a[148:149], v9 offset:6144
    ds_read_b64_tr_b16 a[150:151], v9 offset:9216
    s_waitcnt lgkmcnt(8)
    v_mfma_f32_32x32x16_bf16 a[48:63], a[156:159], v[32:35], a[48:63]
    v_add_f32 v24, v24, v81
    v_add_f32 v24, v24, v82
    v_add_f32 v24, v24, v83
    ds_read_b64_tr_b16 a[152:153], v8 offset:6272
    ds_read_b64_tr_b16 a[154:155], v8 offset:9344
    s_waitcnt lgkmcnt(8)
    v_mfma_f32_32x32x16_bf16 a[64:79], a[160:163], v[32:35], a[64:79]
    v_add_f32 v24, v24, v84
    v_add_f32 v24, v24, v85
    v_add_f32 v24, v24, v86
    v_add_f32 v24, v24, v87
    ds_read_b64_tr_b16 a[156:157], v9 offset:6272
    ds_read_b64_tr_b16 a[158:159], v9 offset:9344
    s_waitcnt lgkmcnt(8)
    v_mfma_f32_32x32x16_bf16 a[80:95], a[164:167], v[32:35], a[80:95]
    v_max3_f32 v26, v56, v57, v58
    v_max3_f32 v26, v26, v59, v60
    buffer_load_dwordx4 v16, s[28:31], s51 offen offset:1024 nt lds
    ds_read_b64_tr_b16 a[160:161], v8 offset:6400
    ds_read_b64_tr_b16 a[162:163], v8 offset:9472
    s_waitcnt lgkmcnt(8)
    v_mfma_f32_32x32x16_bf16 a[0:15], a[144:147], v[36:39], a[0:15]
    v_max3_f32 v26, v26, v61, v62
    v_max3_f32 v26, v26, v63, v64
    v_max3_f32 v26, v26, v65, v66
    ds_read_b64_tr_b16 a[164:165], v9 offset:6400
    ds_read_b64_tr_b16 a[166:167], v9 offset:9472
    s_waitcnt lgkmcnt(8)
    v_mfma_f32_32x32x16_bf16 a[16:31], a[148:151], v[36:39], a[16:31]
    v_max3_f32 v26, v26, v67, v68
    v_max3_f32 v26, v26, v69, v70
    v_max_f32 v26, v26, v71
    s_waitcnt lgkmcnt(6)
    v_mfma_f32_32x32x16_bf16 a[32:47], a[152:155], v[36:39], a[32:47]
    v_cmp_lt_f32 vcc, 0x41000000, v26
    s_nop 1
    s_mov_b64 s[54:55], vcc
    buffer_load_dwordx4 v17, s[28:31], s51 offen offset:2048 nt lds
    s_add_u32 s59, s59, 12288
    s_cmp_eq_u32 s59, s68
    s_cselect_b32 s59, s67, s59
    v_add_u32 v8, s66, v2
    v_add_u32 v9, s66, v3
    v_add_u32 v10, s66, v4
    v_add_u32 v11, s66, v5
    s_add_u32 s66, s66, 12288
    s_cmp_eq_u32 s66, 61440
    s_cselect_b32 s66, 0, s66
    s_waitcnt lgkmcnt(0)
    s_waitcnt vmcnt(9)
    s_barrier
    ds_read_b128 a[144:147], v8 offset:0
    ds_read_b128 a[148:151], v9 offset:0
    v_mfma_f32_32x32x16_bf16 a[48:63], a[156:159], v[36:39], a[48:63]
    ds_read_b128 a[152:155], v10 offset:0
    v_mfma_f32_32x32x16_bf16 a[64:79], a[160:163], v[36:39], a[64:79]
    ds_read_b128 a[156:159], v11 offset:0
    v_mfma_f32_32x32x16_bf16 a[80:95], a[164:167], v[36:39], a[80:95]
    ds_read_b128 a[160:163], v8 offset:128
    s_mov_b32 s56, 9
    s_cmp_lg_u64 s[54:55], 0
    s_cbranch_scc1 attn_SLOW0
attn_RET9:
    s_waitcnt lgkmcnt(4)
    v_mfma_f32_32x32x16_bf16 v[72:87], a[144:147], a[96:99], v[40:55]
    v_exp_f32 v56, v56
    v_exp_f32 v57, v57
    v_exp_f32 v58, v58
    ds_read_b128 a[164:167], v9 offset:128
    s_waitcnt lgkmcnt(4)
    v_mfma_f32_32x32x16_bf16 v[72:87], a[148:151], a[100:103], v[72:87]
    v_exp_f32 v59, v59
    v_exp_f32 v60, v60
    v_exp_f32 v61, v61
    ds_read_b128 a[144:147], v10 offset:128
    s_waitcnt lgkmcnt(4)
    v_mfma_f32_32x32x16_bf16 v[72:87], a[152:155], a[104:107], v[72:87]
    v_exp_f32 v62, v62
    v_exp_f32 v63, v63
    s_add_u32 s51, s48, 159744
    s_mov_b32 m0, s59
    s_nop 0
    buffer_load_dwordx4 v12, s[24:27], s51 offen offset:0 nt lds
    ds_read_b128 a[148:151], v11 offset:128
    s_waitcnt lgkmcnt(4)
    v_mfma_f32_32x32x16_bf16 v[72:87], a[156:159], a[108:111], v[72:87]
    v_cvt_pk_bf16_f32 v32, v56, v57
    v_cvt_pk_bf16_f32 v33, v58, v59
    v_cvt_pk_bf16_f32 v34, v60, v61
    ds_read_b128 a[152:155], v8 offset:256
    s_waitcnt lgkmcnt(4)
    v_mfma_f32_32x32x16_bf16 v[72:87], a[160:163], a[112:115], v[72:87]
    v_cvt_pk_bf16_f32 v35, v62, v63
    v_exp_f32 v64, v64
    v_exp_f32 v65, v65
    ds_read_b128 a[156:159], v9 offset:256
    s_waitcnt lgkmcnt(4)
    v_mfma_f32_32x32x16_bf16 v[72:87], a[164:167], a[116:119], v[72:87]
    v_exp_f32 v66, v66
    v_exp_f32 v67, v67
    buffer_load_dwordx4 v13, s[24:27], s51 offen offset:1024 nt lds
    ds_read_b128 a[160:163], v10 offset:256
    s_waitcnt lgkmcnt(4)
    v_mfma_f32_32x32x16_bf16 v[72:87], a[144:147], a[120:123], v[72:87]
    v_exp_f32 v68, v68
    v_exp_f32 v69, v69
    v_exp_f32 v70, v70
    ds_read_b128 a[164:167], v11 offset:256
    s_waitcnt lgkmcnt(4)
    v_mfma_f32_32x32x16_bf16 v[72:87], a[148:151], a[124:127], v[72:87]
    v_exp_f32 v71, v71
    v_cvt_pk_bf16_f32 v36, v64, v65
    v_cvt_pk_bf16_f32 v37, v66, v67
    s_waitcnt lgkmcnt(3)
    v_mfma_f32_32x32x16_bf16 v[72:87], a[152:155], a[128:131], v[72:87]
    v_cvt_pk_bf16_f32 v38, v68, v69
    v_cvt_pk_bf16_f32 v39, v70, v71
    buffer_load_dwordx4 v14, s[24:27], s51 offen offset:2048 nt lds
    s_add_u32 s59, s59, 12288
    s_cmp_eq_u32 s59, s68
    s_cselect_b32 s59, s67, s59
    v_add_u32 v8, s66, v6
    v_add_u32 v9, s66, v7
    s_add_u32 s66, s66, 12288
    s_cmp_eq_u32 s66, 61440
    s_cselect_b32 s66, 0, s66
    s_waitcnt lgkmcnt(0)
    s_waitcnt vmcnt(9)
    s_barrier
    ds_read_b64_tr_b16 a[144:145], v8 offset:0
    ds_read_b64_tr_b16 a[146:147], v8 offset:3072
    ds_read_b64_tr_b16 a[148:149], v9 offset:0
    ds_read_b64_tr_b16 a[150:151], v9 offset:3072
    v_mfma_f32_32x32x16_bf16 v[72:87], a[156:159], a[132:135], v[72:87]
    ds_read_b64_tr_b16 a[152:153], v8 offset:128
    ds_read_b64_tr_b16 a[154:155], v8 offset:3200
    v_mfma_f32_32x32x16_bf16 v[72:87], a[160:163], a[136:139], v[72:87]
    ds_read_b64_tr_b16 a[156:157], v9 offset:128
    ds_read_b64_tr_b16 a[158:159], v9 offset:3200
    v_mfma_f32_32x32x16_bf16 v[72:87], a[164:167], a[140:143], v[72:87]
    ds_read_b64_tr_b16 a[160:161], v8 offset:256
    ds_read_b64_tr_b16 a[162:163], v8 offset:3328
    s_waitcnt lgkmcnt(8)
    v_mfma_f32_32x32x16_bf16 a[0:15], a[144:147], v[32:35], a[0:15]
    v_add_f32 v24, v24, v56
    v_add_f32 v24, v24, v57
    v_add_f32 v24, v24, v58
    v_add_f32 v24, v24, v59
    ds_read_b64_tr_b16 a[164:165], v9 offset:256
    ds_read_b64_tr_b16 a[166:167], v9 offset:3328
    s_waitcnt lgkmcnt(8)
    v_mfma_f32_32x32x16_bf16 a[16:31], a[148:151], v[32:35], a[16:31]
    v_add_f32 v24, v24, v60
    v_add_f32 v24, v24, v61
    v_add_f32 v24, v24, v62
    ds_read_b64_tr_b16 a[144:145], v8 offset:6144
    ds_read_b64_tr_b16 a[146:147], v8 offset:9216
    s_waitcnt lgkmcnt(8)
    v_mfma_f32_32x32x16_bf16 a[32:47], a[152:155], v[32:35], a[32:47]
    v_add_f32 v24, v24, v63
    v_add_f32 v24, v24, v64
    s_add_u32 s51, s48, 147456
    s_mov_b32 m0, s59
    s_nop 0
    buffer_load_dwordx4 v15, s[28:31], s51 offen offset:0 nt lds
    ds_read_b64_tr_b16 a[148:149], v9 offset:6144
    ds_read_b64_tr_b16 a[150:151], v9 offset:9216
    s_waitcnt lgkmcnt(8)
    v_mfma_f32_32x32x16_bf16 a[48:63], a[156:159], v[32:35], a[48:63]
    v_add_f32 v24, v24, v65
    v_add_f32 v24, v24, v66
    v_add_f32 v24, v24, v67
    ds_read_b64_tr_b16 a[152:153], v8 offset:6272
    ds_read_b64_tr_b16 a[154:155], v8 offset:9344
    s_waitcnt lgkmcnt(8)
    v_mfma_f32_32x32x16_bf16 a[64:79], a[160:163], v[32:35], a[64:79]
    v_add_f32 v24, v24, v68
    v_add_f32 v24, v24, v69
    v_add_f32 v24, v24, v70
    v_add_f32 v24, v24, v71
    ds_read_b64_tr_b16 a[156:157], v9 offset:6272
    ds_read_b64_tr_b16 a[158:159], v9 offset:9344
    s_waitcnt lgkmcnt(8)
    v_mfma_f32_32x32x16_bf16 a[80:95], a[164:167], v[32:35], a[80:95]
    v_max3_f32 v26, v72, v73, v74
    v_max3_f32 v26, v26, v75, v76
    buffer_load_dwordx4 v16, s[28:31], s51 offen offset:1024 nt lds
    ds_read_b64_tr_b16 a[160:161], v8 offset:6400
    ds_read_b64_tr_b16 a[162:163], v8 offset:9472
    s_waitcnt lgkmcnt(8)
    v_mfma_f32_32x32x16_bf16 a[0:15], a[144:147], v[36:39], a[0:15]
    v_max3_f32 v26, v26, v77, v78
    v_max3_f32 v26, v26, v79, v80
    v_max3_f32 v26, v26, v81, v82
    ds_read_b64_tr_b16 a[164:165], v9 offset:6400
    ds_read_b64_tr_b16 a[166:167], v9 offset:9472
    s_waitcnt lgkmcnt(8)
    v_mfma_f32_32x32x16_bf16 a[16:31], a[148:151], v[36:39], a[16:31]
    v_max3_f32 v26, v26, v83, v84
    v_max3_f32 v26, v26, v85, v86
    v_max_f32 v26, v26, v87
    s_waitcnt lgkmcnt(6)
    v_mfma_f32_32x32x16_bf16 a[32:47], a[152:155], v[36:39], a[32:47]
    v_cmp_lt_f32 vcc, 0x41000000, v26
    s_nop 1
    s_mov_b64 s[54:55], vcc
    buffer_load_dwordx4 v17, s[28:31], s51 offen offset:2048 nt lds
    s_add_u32 s59, s59, 12288
    s_cmp_eq_u32 s59, s68
    s_cselect_b32 s59, s67, s59
    v_add_u32 v8, s66, v2
    v_add_u32 v9, s66, v3
    v_add_u32 v10, s66, v4
    v_add_u32 v11, s66, v5
    s_add_u32 s66, s66, 12288
    s_cmp_eq_u32 s66, 61440
    s_cselect_b32 s66, 0, s66
    s_waitcnt lgkmcnt(0)
    s_waitcnt vmcnt(9)
    s_barrier
    ds_read_b128 a[144:147], v8 offset:0
    ds_read_b128 a[148:151], v9 offset:0
    v_mfma_f32_32x32x16_bf16 a[48:63], a[156:159], v[36:39], a[48:63]
    ds_read_b128 a[152:155], v10 offset:0
    v_mfma_f32_32x32x16_bf16 a[64:79], a[160:163], v[36:39], a[64:79]
    ds_read_b128 a[156:159], v11 offset:0
    v_mfma_f32_32x32x16_bf16 a[80:95], a[164:167], v[36:39], a[80:95]
    ds_read_b128 a[160:163], v8 offset:128
    s_mov_b32 s56, 10
    s_cmp_lg_u64 s[54:55], 0
    s_cbranch_scc1 attn_SLOW1
attn_RET10:
    s_waitcnt lgkmcnt(4)
    v_mfma_f32_32x32x16_bf16 v[56:71], a[144:147], a[96:99], v[40:55]
    v_exp_f32 v72, v72
    v_exp_f32 v73, v73
    v_exp_f32 v74, v74
    ds_read_b128 a[164:167], v9 offset:128
    s_waitcnt lgkmcnt(4)
    v_mfma_f32_32x32x16_bf16 v[56:71], a[148:151], a[100:103], v[56:71]
    v_exp_f32 v75, v75
    v_exp_f32 v76, v76
    v_exp_f32 v77, v77
    ds_read_b128 a[144:147], v10 offset:128
    s_waitcnt lgkmcnt(4)
    v_mfma_f32_32x32x16_bf16 v[56:71], a[152:155], a[104:107], v[56:71]
    v_exp_f32 v78, v78
    v_exp_f32 v79, v79
    s_add_u32 s51, s48, 172032
    s_mov_b32 m0, s59
    s_nop 0
    buffer_load_dwordx4 v12, s[24:27], s51 offen offset:0 nt lds
    ds_read_b128 a[148:151], v11 offset:128
    s_waitcnt lgkmcnt(4)
    v_mfma_f32_32x32x16_bf16 v[56:71], a[156:159], a[108:111], v[56:71]
    v_cvt_pk_bf16_f32 v32, v72, v73
    v_cvt_pk_bf16_f32 v33, v74, v75
    v_cvt_pk_bf16_f32 v34, v76, v77
    ds_read_b128 a[152:155], v8 offset:256
    s_waitcnt lgkmcnt(4)
    v_mfma_f32_32x32x16_bf16 v[56:71], a[160:163], a[112:115], v[56:71]
    v_cvt_pk_bf16_f32 v35, v78, v79
    v_exp_f32 v80, v80
    v_exp_f32 v81, v81
    ds_read_b128 a[156:159], v9 offset:256
    s_waitcnt lgkmcnt(4)
    v_mfma_f32_32x32x16_bf16 v[56:71], a[164:167], a[116:119], v[56:71]
    v_exp_f32 v82, v82
    v_exp_f32 v83, v83
    buffer_load_dwordx4 v13, s[24:27], s51 offen offset:1024 nt lds
    ds_read_b128 a[160:163], v10 offset:256
    s_waitcnt lgkmcnt(4)
    v_mfma_f32_32x32x16_bf16 v[56:71], a[144:147], a[120:123], v[56:71]
    v_exp_f32 v84, v84
    v_exp_f32 v85, v85
    v_exp_f32 v86, v86
    ds_read_b128 a[164:167], v11 offset:256
    s_waitcnt lgkmcnt(4)
    v_mfma_f32_32x32x16_bf16 v[56:71], a[148:151], a[124:127], v[56:71]
    v_exp_f32 v87, v87
    v_cvt_pk_bf16_f32 v36, v80, v81
    v_cvt_pk_bf16_f32 v37, v82, v83
    s_waitcnt lgkmcnt(3)
    v_mfma_f32_32x32x16_bf16 v[56:71], a[152:155], a[128:131], v[56:71]
    v_cvt_pk_bf16_f32 v38, v84, v85
    v_cvt_pk_bf16_f32 v39, v86, v87
    buffer_load_dwordx4 v14, s[24:27], s51 offen offset:2048 nt lds
    s_add_u32 s59, s59, 12288
    s_cmp_eq_u32 s59, s68
    s_cselect_b32 s59, s67, s59
    v_add_u32 v8, s66, v6
    v_add_u32 v9, s66, v7
    s_add_u32 s66, s66, 12288
    s_cmp_eq_u32 s66, 61440
    s_cselect_b32 s66, 0, s66
    s_waitcnt lgkmcnt(0)
    s_waitcnt vmcnt(9)
    s_barrier
    ds_read_b64_tr_b16 a[144:145], v8 offset:0
    ds_read_b64_tr_b16 a[146:147], v8 offset:3072
    ds_read_b64_tr_b16 a[148:149], v9 offset:0
    ds_read_b64_tr_b16 a[150:151], v9 offset:3072
    v_mfma_f32_32x32x16_bf16 v[56:71], a[156:159], a[132:135], v[56:71]
    ds_read_b64_tr_b16 a[152:153], v8 offset:128
    ds_read_b64_tr_b16 a[154:155], v8 offset:3200
    v_mfma_f32_32x32x16_bf16 v[56:71], a[160:163], a[136:139], v[56:71]
    ds_read_b64_tr_b16 a[156:157], v9 offset:128
    ds_read_b64_tr_b16 a[158:159], v9 offset:3200
    v_mfma_f32_32x32x16_bf16 v[56:71], a[164:167], a[140:143], v[56:71]
    ds_read_b64_tr_b16 a[160:161], v8 offset:256
    ds_read_b64_tr_b16 a[162:163], v8 offset:3328
    s_waitcnt lgkmcnt(8)
    v_mfma_f32_32x32x16_bf16 a[0:15], a[144:147], v[32:35], a[0:15]
    v_add_f32 v24, v24, v72
    v_add_f32 v24, v24, v73
    v_add_f32 v24, v24, v74
    v_add_f32 v24, v24, v75
    ds_read_b64_tr_b16 a[164:165], v9 offset:256
    ds_read_b64_tr_b16 a[166:167], v9 offset:3328
    s_waitcnt lgkmcnt(8)
    v_mfma_f32_32x32x16_bf16 a[16:31], a[148:151], v[32:35], a[16:31]
    v_add_f32 v24, v24, v76
    v_add_f32 v24, v24, v77
    v_add_f32 v24, v24, v78
    ds_read_b64_tr_b16 a[144:145], v8 offset:6144
    ds_read_b64_tr_b16 a[146:147], v8 offset:9216
    s_waitcnt lgkmcnt(8)
    v_mfma_f32_32x32x16_bf16 a[32:47], a[152:155], v[32:35], a[32:47]
    v_add_f32 v24, v24, v79
    v_add_f32 v24, v24, v80
    s_add_u32 s51, s48, 159744
    s_mov_b32 m0, s59
    s_nop 0
    buffer_load_dwordx4 v15, s[28:31], s51 offen offset:0 nt lds
    ds_read_b64_tr_b16 a[148:149], v9 offset:6144
    ds_read_b64_tr_b16 a[150:151], v9 offset:9216
    s_waitcnt lgkmcnt(8)
    v_mfma_f32_32x32x16_bf16 a[48:63], a[156:159], v[32:35], a[48:63]
    v_add_f32 v24, v24, v81
    v_add_f32 v24, v24, v82
    v_add_f32 v24, v24, v83
    ds_read_b64_tr_b16 a[152:153], v8 offset:6272
    ds_read_b64_tr_b16 a[154:155], v8 offset:9344
    s_waitcnt lgkmcnt(8)
    v_mfma_f32_32x32x16_bf16 a[64:79], a[160:163], v[32:35], a[64:79]
    v_add_f32 v24, v24, v84
    v_add_f32 v24, v24, v85
    v_add_f32 v24, v24, v86
    v_add_f32 v24, v24, v87
    ds_read_b64_tr_b16 a[156:157], v9 offset:6272
    ds_read_b64_tr_b16 a[158:159], v9 offset:9344
    s_waitcnt lgkmcnt(8)
    v_mfma_f32_32x32x16_bf16 a[80:95], a[164:167], v[32:35], a[80:95]
    v_max3_f32 v26, v56, v57, v58
    v_max3_f32 v26, v26, v59, v60
    buffer_load_dwordx4 v16, s[28:31], s51 offen offset:1024 nt lds
    ds_read_b64_tr_b16 a[160:161], v8 offset:6400
    ds_read_b64_tr_b16 a[162:163], v8 offset:9472
    s_waitcnt lgkmcnt(8)
    v_mfma_f32_32x32x16_bf16 a[0:15], a[144:147], v[36:39], a[0:15]
    v_max3_f32 v26, v26, v61, v62
    v_max3_f32 v26, v26, v63, v64
    v_max3_f32 v26, v26, v65, v66
    ds_read_b64_tr_b16 a[164:165], v9 offset:6400
    ds_read_b64_tr_b16 a[166:167], v9 offset:9472
    s_waitcnt lgkmcnt(8)
    v_mfma_f32_32x32x16_bf16 a[16:31], a[148:151], v[36:39], a[16:31]
    v_max3_f32 v26, v26, v67, v68
    v_max3_f32 v26, v26, v69, v70
    v_max_f32 v26, v26, v71
    s_waitcnt lgkmcnt(6)
    v_mfma_f32_32x32x16_bf16 a[32:47], a[152:155], v[36:39], a[32:47]
    v_cmp_lt_f32 vcc, 0x41000000, v26
    s_nop 1
    s_mov_b64 s[54:55], vcc
    buffer_load_dwordx4 v17, s[28:31], s51 offen offset:2048 nt lds
    s_add_u32 s59, s59, 12288
    s_cmp_eq_u32 s59, s68
    s_cselect_b32 s59, s67, s59
    v_add_u32 v8, s66, v2
    v_add_u32 v9, s66, v3
    v_add_u32 v10, s66, v4
    v_add_u32 v11, s66, v5
    s_add_u32 s66, s66, 12288
    s_cmp_eq_u32 s66, 61440
    s_cselect_b32 s66, 0, s66
    s_waitcnt lgkmcnt(0)
    s_waitcnt vmcnt(9)
    s_barrier
    ds_read_b128 a[144:147], v8 offset:0
    ds_read_b128 a[148:151], v9 offset:0
    v_mfma_f32_32x32x16_bf16 a[48:63], a[156:159], v[36:39], a[48:63]
    ds_read_b128 a[152:155], v10 offset:0
    v_mfma_f32_32x32x16_bf16 a[64:79], a[160:163], v[36:39], a[64:79]
    ds_read_b128 a[156:159], v11 offset:0
    v_mfma_f32_32x32x16_bf16 a[80:95], a[164:167], v[36:39], a[80:95]
    ds_read_b128 a[160:163], v8 offset:128
    s_mov_b32 s56, 11
    s_cmp_lg_u64 s[54:55], 0
    s_cbranch_scc1 attn_SLOW0
attn_RET11:
    s_waitcnt lgkmcnt(4)
    v_mfma_f32_32x32x16_bf16 v[72:87], a[144:147], a[96:99], v[40:55]
    v_exp_f32 v56, v56
    v_exp_f32 v57, v57
    v_exp_f32 v58, v58
    ds_read_b128 a[164:167], v9 offset:128
    s_waitcnt lgkmcnt(4)
    v_mfma_f32_32x32x16_bf16 v[72:87], a[148:151], a[100:103], v[72:87]
    v_exp_f32 v59, v59
    v_exp_f32 v60, v60
    v_exp_f32 v61, v61
    ds_read_b128 a[144:147], v10 offset:128
    s_waitcnt lgkmcnt(4)
    v_mfma_f32_32x32x16_bf16 v[72:87], a[152:155], a[104:107], v[72:87]
    v_exp_f32 v62, v62
    v_exp_f32 v63, v63
    s_add_u32 s51, s48, 184320
    s_mov_b32 m0, s59
    s_nop 0
    buffer_load_dwordx4 v12, s[24:27], s51 offen offset:0 nt lds
    ds_read_b128 a[148:151], v11 offset:128
    s_waitcnt lgkmcnt(4)
    v_mfma_f32_32x32x16_bf16 v[72:87], a[156:159], a[108:111], v[72:87]
    v_cvt_pk_bf16_f32 v32, v56, v57
    v_cvt_pk_bf16_f32 v33, v58, v59
    v_cvt_pk_bf16_f32 v34, v60, v61
    ds_read_b128 a[152:155], v8 offset:256
    s_waitcnt lgkmcnt(4)
    v_mfma_f32_32x32x16_bf16 v[72:87], a[160:163], a[112:115], v[72:87]
    v_cvt_pk_bf16_f32 v35, v62, v63
    v_exp_f32 v64, v64
    v_exp_f32 v65, v65
    ds_read_b128 a[156:159], v9 offset:256
    s_waitcnt lgkmcnt(4)
    v_mfma_f32_32x32x16_bf16 v[72:87], a[164:167], a[116:119], v[72:87]
    v_exp_f32 v66, v66
    v_exp_f32 v67, v67
    buffer_load_dwordx4 v13, s[24:27], s51 offen offset:1024 nt lds
    ds_read_b128 a[160:163], v10 offset:256
    s_waitcnt lgkmcnt(4)
    v_mfma_f32_32x32x16_bf16 v[72:87], a[144:147], a[120:123], v[72:87]
    v_exp_f32 v68, v68
    v_exp_f32 v69, v69
    v_exp_f32 v70, v70
    ds_read_b128 a[164:167], v11 offset:256
    s_waitcnt lgkmcnt(4)
    v_mfma_f32_32x32x16_bf16 v[72:87], a[148:151], a[124:127], v[72:87]
    v_exp_f32 v71, v71
    v_cvt_pk_bf16_f32 v36, v64, v65
    v_cvt_pk_bf16_f32 v37, v66, v67
    s_waitcnt lgkmcnt(3)
    v_mfma_f32_32x32x16_bf16 v[72:87], a[152:155], a[128:131], v[72:87]
    v_cvt_pk_bf16_f32 v38, v68, v69
    v_cvt_pk_bf16_f32 v39, v70, v71
    buffer_load_dwordx4 v14, s[24:27], s51 offen offset:2048 nt lds
    s_add_u32 s59, s59, 12288
    s_cmp_eq_u32 s59, s68
    s_cselect_b32 s59, s67, s59
    v_add_u32 v8, s66, v6
    v_add_u32 v9, s66, v7
    s_add_u32 s66, s66, 12288
    s_cmp_eq_u32 s66, 61440
    s_cselect_b32 s66, 0, s66
    s_waitcnt lgkmcnt(0)
    s_waitcnt vmcnt(9)
    s_barrier
    ds_read_b64_tr_b16 a[144:145], v8 offset:0
    ds_read_b64_tr_b16 a[146:147], v8 offset:3072
    ds_read_b64_tr_b16 a[148:149], v9 offset:0
    ds_read_b64_tr_b16 a[150:151], v9 offset:3072
    v_mfma_f32_32x32x16_bf16 v[72:87], a[156:159], a[132:135], v[72:87]
    ds_read_b64_tr_b16 a[152:153], v8 offset:128
    ds_read_b64_tr_b16 a[154:155], v8 offset:3200
    v_mfma_f32_32x32x16_bf16 v[72:87], a[160:163], a[136:139], v[72:87]
    ds_read_b64_tr_b16 a[156:157], v9 offset:128
    ds_read_b64_tr_b16 a[158:159], v9 offset:3200
    v_mfma_f32_32x32x16_bf16 v[72:87], a[164:167], a[140:143], v[72:87]
    ds_read_b64_tr_b16 a[160:161], v8 offset:256
    ds_read_b64_tr_b16 a[162:163], v8 offset:3328
    s_waitcnt lgkmcnt(8)
    v_mfma_f32_32x32x16_bf16 a[0:15], a[144:147], v[32:35], a[0:15]
    v_add_f32 v24, v24, v56
    v_add_f32 v24, v24, v57
    v_add_f32 v24, v24, v58
    v_add_f32 v24, v24, v59
    ds_read_b64_tr_b16 a[164:165], v9 offset:256
    ds_read_b64_tr_b16 a[166:167], v9 offset:3328
    s_waitcnt lgkmcnt(8)
    v_mfma_f32_32x32x16_bf16 a[16:31], a[148:151], v[32:35], a[16:31]
    v_add_f32 v24, v24, v60
    v_add_f32 v24, v24, v61
    v_add_f32 v24, v24, v62
    ds_read_b64_tr_b16 a[144:145], v8 offset:6144
    ds_read_b64_tr_b16 a[146:147], v8 offset:9216
    s_waitcnt lgkmcnt(8)
    v_mfma_f32_32x32x16_bf16 a[32:47], a[152:155], v[32:35], a[32:47]
    v_add_f32 v24, v24, v63
    v_add_f32 v24, v24, v64
    s_add_u32 s51, s48, 172032
    s_mov_b32 m0, s59
    s_nop 0
    buffer_load_dwordx4 v15, s[28:31], s51 offen offset:0 nt lds
    ds_read_b64_tr_b16 a[148:149], v9 offset:6144
    ds_read_b64_tr_b16 a[150:151], v9 offset:9216
    s_waitcnt lgkmcnt(8)
    v_mfma_f32_32x32x16_bf16 a[48:63], a[156:159], v[32:35], a[48:63]
    v_add_f32 v24, v24, v65
    v_add_f32 v24, v24, v66
    v_add_f32 v24, v24, v67
    ds_read_b64_tr_b16 a[152:153], v8 offset:6272
    ds_read_b64_tr_b16 a[154:155], v8 offset:9344
    s_waitcnt lgkmcnt(8)
    v_mfma_f32_32x32x16_bf16 a[64:79], a[160:163], v[32:35], a[64:79]
    v_add_f32 v24, v24, v68
    v_add_f32 v24, v24, v69
    v_add_f32 v24, v24, v70
    v_add_f32 v24, v24, v71
    ds_read_b64_tr_b16 a[156:157], v9 offset:6272
    ds_read_b64_tr_b16 a[158:159], v9 offset:9344
    s_waitcnt lgkmcnt(8)
    v_mfma_f32_32x32x16_bf16 a[80:95], a[164:167], v[32:35], a[80:95]
    v_max3_f32 v26, v72, v73, v74
    v_max3_f32 v26, v26, v75, v76
    buffer_load_dwordx4 v16, s[28:31], s51 offen offset:1024 nt lds
    ds_read_b64_tr_b16 a[160:161], v8 offset:6400
    ds_read_b64_tr_b16 a[162:163], v8 offset:9472
    s_waitcnt lgkmcnt(8)
    v_mfma_f32_32x32x16_bf16 a[0:15], a[144:147], v[36:39], a[0:15]
    v_max3_f32 v26, v26, v77, v78
    v_max3_f32 v26, v26, v79, v80
    v_max3_f32 v26, v26, v81, v82
    ds_read_b64_tr_b16 a[164:165], v9 offset:6400
    ds_read_b64_tr_b16 a[166:167], v9 offset:9472
    s_waitcnt lgkmcnt(8)
    v_mfma_f32_32x32x16_bf16 a[16:31], a[148:151], v[36:39], a[16:31]
    v_max3_f32 v26, v26, v83, v84
    v_max3_f32 v26, v26, v85, v86
    v_max_f32 v26, v26, v87
    s_waitcnt lgkmcnt(6)
    v_mfma_f32_32x32x16_bf16 a[32:47], a[152:155], v[36:39], a[32:47]
    v_cmp_lt_f32 vcc, 0x41000000, v26
    s_nop 1
    s_mov_b64 s[54:55], vcc
    buffer_load_dwordx4 v17, s[28:31], s51 offen offset:2048 nt lds
    s_add_u32 s59, s59, 12288
    s_cmp_eq_u32 s59, s68
    s_cselect_b32 s59, s67, s59
    v_add_u32 v8, s66, v2
    v_add_u32 v9, s66, v3
    v_add_u32 v10, s66, v4
    v_add_u32 v11, s66, v5
    s_add_u32 s66, s66, 12288
    s_cmp_eq_u32 s66, 61440
    s_cselect_b32 s66, 0, s66
    s_waitcnt lgkmcnt(0)
    s_waitcnt vmcnt(9)
    s_barrier
    ds_read_b128 a[144:147], v8 offset:0
    ds_read_b128 a[148:151], v9 offset:0
    v_mfma_f32_32x32x16_bf16 a[48:63], a[156:159], v[36:39], a[48:63]
    ds_read_b128 a[152:155], v10 offset:0
    v_mfma_f32_32x32x16_bf16 a[64:79], a[160:163], v[36:39], a[64:79]
    ds_read_b128 a[156:159], v11 offset:0
    v_mfma_f32_32x32x16_bf16 a[80:95], a[164:167], v[36:39], a[80:95]
    ds_read_b128 a[160:163], v8 offset:128
    s_mov_b32 s56, 12
    s_cmp_lg_u64 s[54:55], 0
    s_cbranch_scc1 attn_SLOW1
attn_RET12:
    s_waitcnt lgkmcnt(4)
    v_mfma_f32_32x32x16_bf16 v[56:71], a[144:147], a[96:99], v[40:55]
    v_exp_f32 v72, v72
    v_exp_f32 v73, v73
    v_exp_f32 v74, v74
    ds_read_b128 a[164:167], v9 offset:128
    s_waitcnt lgkmcnt(4)
    v_mfma_f32_32x32x16_bf16 v[56:71], a[148:151], a[100:103], v[56:71]
    v_exp_f32 v75, v75
    v_exp_f32 v76, v76
    v_exp_f32 v77, v77
    ds_read_b128 a[144:147], v10 offset:128
    s_waitcnt lgkmcnt(4)
    v_mfma_f32_32x32x16_bf16 v[56:71], a[152:155], a[104:107], v[56:71]
    v_exp_f32 v78, v78
    v_exp_f32 v79, v79
    s_add_u32 s51, s48, 184320
    s_mov_b32 m0, s59
    s_nop 0
    buffer_load_dwordx4 v15, s[28:31], s51 offen offset:0 nt lds
    ds_read_b128 a[148:151], v11 offset:128
    s_waitcnt lgkmcnt(4)
    v_mfma_f32_32x32x16_bf16 v[56:71], a[156:159], a[108:111], v[56:71]
    v_cvt_pk_bf16_f32 v32, v72, v73
    v_cvt_pk_bf16_f32 v33, v74, v75
    v_cvt_pk_bf16_f32 v34, v76, v77
    ds_read_b128 a[152:155], v8 offset:256
    s_waitcnt lgkmcnt(4)
    v_mfma_f32_32x32x16_bf16 v[56:71], a[160:163], a[112:115], v[56:71]
    v_cvt_pk_bf16_f32 v35, v78, v79
    v_exp_f32 v80, v80
    v_exp_f32 v81, v81
    ds_read_b128 a[156:159], v9 offset:256
    s_waitcnt lgkmcnt(4)
    v_mfma_f32_32x32x16_bf16 v[56:71], a[164:167], a[116:119], v[56:71]
    v_exp_f32 v82, v82
    v_exp_f32 v83, v83
    buffer_load_dwordx4 v16, s[28:31], s51 offen offset:1024 nt lds
    ds_read_b128 a[160:163], v10 offset:256
    s_waitcnt lgkmcnt(4)
    v_mfma_f32_32x32x16_bf16 v[56:71], a[144:147], a[120:123], v[56:71]
    v_exp_f32 v84, v84
    v_exp_f32 v85, v85
    v_exp_f32 v86, v86
    ds_read_b128 a[164:167], v11 offset:256
    s_waitcnt lgkmcnt(4)
    v_mfma_f32_32x32x16_bf16 v[56:71], a[148:151], a[124:127], v[56:71]
    v_exp_f32 v87, v87
    v_cvt_pk_bf16_f32 v36, v80, v81
    v_cvt_pk_bf16_f32 v37, v82, v83
    s_waitcnt lgkmcnt(3)
    v_mfma_f32_32x32x16_bf16 v[56:71], a[152:155], a[128:131], v[56:71]
    v_cvt_pk_bf16_f32 v38, v84, v85
    v_cvt_pk_bf16_f32 v39, v86, v87
    buffer_load_dwordx4 v17, s[28:31], s51 offen offset:2048 nt lds
    s_add_u32 s59, s59, 12288
    s_cmp_eq_u32 s59, s68
    s_cselect_b32 s59, s67, s59
    v_add_u32 v8, s66, v6
    v_add_u32 v9, s66, v7
    s_add_u32 s66, s66, 12288
    s_cmp_eq_u32 s66, 61440
    s_cselect_b32 s66, 0, s66
    s_waitcnt lgkmcnt(0)
    s_waitcnt vmcnt(9)
    s_barrier
    ds_read_b64_tr_b16 a[144:145], v8 offset:0
    ds_read_b64_tr_b16 a[146:147], v8 offset:3072
    ds_read_b64_tr_b16 a[148:149], v9 offset:0
    ds_read_b64_tr_b16 a[150:151], v9 offset:3072
    v_mfma_f32_32x32x16_bf16 v[56:71], a[156:159], a[132:135], v[56:71]
    ds_read_b64_tr_b16 a[152:153], v8 offset:128
    ds_read_b64_tr_b16 a[154:155], v8 offset:3200
    v_mfma_f32_32x32x16_bf16 v[56:71], a[160:163], a[136:139], v[56:71]
    ds_read_b64_tr_b16 a[156:157], v9 offset:128
    ds_read_b64_tr_b16 a[158:159], v9 offset:3200
    v_mfma_f32_32x32x16_bf16 v[56:71], a[164:167], a[140:143], v[56:71]
    ds_read_b64_tr_b16 a[160:161], v8 offset:256
    ds_read_b64_tr_b16 a[162:163], v8 offset:3328
    s_waitcnt lgkmcnt(8)
    v_mfma_f32_32x32x16_bf16 a[0:15], a[144:147], v[32:35], a[0:15]
    v_add_f32 v24, v24, v72
    v_add_f32 v24, v24, v73
    v_add_f32 v24, v24, v74
    v_add_f32 v24, v24, v75
    ds_read_b64_tr_b16 a[164:165], v9 offset:256
    ds_read_b64_tr_b16 a[166:167], v9 offset:3328
    s_waitcnt lgkmcnt(8)
    v_mfma_f32_32x32x16_bf16 a[16:31], a[148:151], v[32:35], a[16:31]
    v_add_f32 v24, v24, v76
    v_add_f32 v24, v24, v77
    v_add_f32 v24, v24, v78
    ds_read_b64_tr_b16 a[144:145], v8 offset:6144
    ds_read_b64_tr_b16 a[146:147], v8 offset:9216
    s_waitcnt lgkmcnt(8)
    v_mfma_f32_32x32x16_bf16 a[32:47], a[152:155], v[32:35], a[32:47]
    v_add_f32 v24, v24, v79
    v_add_f32 v24, v24, v80
    s_add_u32 s51, s49, 0
    s_mov_b32 m0, s59
    s_nop 0
    buffer_load_dwordx4 v12, s[24:27], s51 offen offset:0 nt lds
    ds_read_b64_tr_b16 a[148:149], v9 offset:6144
    ds_read_b64_tr_b16 a[150:151], v9 offset:9216
    s_waitcnt lgkmcnt(8)
    v_mfma_f32_32x32x16_bf16 a[48:63], a[156:159], v[32:35], a[48:63]
    v_add_f32 v24, v24, v81
    v_add_f32 v24, v24, v82
    v_add_f32 v24, v24, v83
    ds_read_b64_tr_b16 a[152:153], v8 offset:6272
    ds_read_b64_tr_b16 a[154:155], v8 offset:9344
    s_waitcnt lgkmcnt(8)
    v_mfma_f32_32x32x16_bf16 a[64:79], a[160:163], v[32:35], a[64:79]
    v_add_f32 v24, v24, v84
    v_add_f32 v24, v24, v85
    v_add_f32 v24, v24, v86
    v_add_f32 v24, v24, v87
    ds_read_b64_tr_b16 a[156:157], v9 offset:6272
    ds_read_b64_tr_b16 a[158:159], v9 offset:9344
    s_waitcnt lgkmcnt(8)
    v_mfma_f32_32x32x16_bf16 a[80:95], a[164:167], v[32:35], a[80:95]
    v_max3_f32 v26, v56, v57, v58
    v_max3_f32 v26, v26, v59, v60
    buffer_load_dwordx4 v13, s[24:27], s51 offen offset:1024 nt lds
    ds_read_b64_tr_b16 a[160:161], v8 offset:6400
    ds_read_b64_tr_b16 a[162:163], v8 offset:9472
    s_waitcnt lgkmcnt(8)
    v_mfma_f32_32x32x16_bf16 a[0:15], a[144:147], v[36:39], a[0:15]
    v_max3_f32 v26, v26, v61, v62
    v_max3_f32 v26, v26, v63, v64
    v_max3_f32 v26, v26, v65, v66
    ds_read_b64_tr_b16 a[164:165], v9 offset:6400
    ds_read_b64_tr_b16 a[166:167], v9 offset:9472
    s_waitcnt lgkmcnt(8)
    v_mfma_f32_32x32x16_bf16 a[16:31], a[148:151], v[36:39], a[16:31]
    v_max3_f32 v26, v26, v67, v68
    v_max3_f32 v26, v26, v69, v70
    v_max_f32 v26, v26, v71
    s_waitcnt lgkmcnt(6)
    v_mfma_f32_32x32x16_bf16 a[32:47], a[152:155], v[36:39], a[32:47]
    v_cmp_lt_f32 vcc, 0x41000000, v26
    s_nop 1
    s_mov_b64 s[54:55], vcc
    buffer_load_dwordx4 v14, s[24:27], s51 offen offset:2048 nt lds
    s_add_u32 s59, s59, 12288
    s_cmp_eq_u32 s59, s68
    s_cselect_b32 s59, s67, s59
    v_add_u32 v8, s66, v2
    v_add_u32 v9, s66, v3
    v_add_u32 v10, s66, v4
    v_add_u32 v11, s66, v5
    s_add_u32 s66, s66, 12288
    s_cmp_eq_u32 s66, 61440
    s_cselect_b32 s66, 0, s66
    s_waitcnt lgkmcnt(0)
    s_waitcnt vmcnt(9)
    s_barrier
    ds_read_b128 a[144:147], v8 offset:0
    ds_read_b128 a[148:151], v9 offset:0
    v_mfma_f32_32x32x16_bf16 a[48:63], a[156:159], v[36:39], a[48:63]
    ds_read_b128 a[152:155], v10 offset:0
    v_mfma_f32_32x32x16_bf16 a[64:79], a[160:163], v[36:39], a[64:79]
    ds_read_b128 a[156:159], v11 offset:0
    v_mfma_f32_32x32x16_bf16 a[80:95], a[164:167], v[36:39], a[80:95]
    ds_read_b128 a[160:163], v8 offset:128
    s_mov_b32 s56, 13
    s_cmp_lg_u64 s[54:55], 0
    s_cbranch_scc1 attn_SLOW0
attn_RET13:
    s_waitcnt lgkmcnt(4)
    v_mfma_f32_32x32x16_bf16 v[72:87], a[144:147], a[96:99], v[40:55]
    v_exp_f32 v56, v56
    v_exp_f32 v57, v57
    v_exp_f32 v58, v58
    ds_read_b128 a[164:167], v9 offset:128
    s_waitcnt lgkmcnt(4)
    v_mfma_f32_32x32x16_bf16 v[72:87], a[148:151], a[100:103], v[72:87]
    v_exp_f32 v59, v59
    v_exp_f32 v60, v60
    v_exp_f32 v61, v61
    ds_read_b128 a[144:147], v10 offset:128
    s_waitcnt lgkmcnt(4)
    v_mfma_f32_32x32x16_bf16 v[72:87], a[152:155], a[104:107], v[72:87]
    v_exp_f32 v62, v62
    v_exp_f32 v63, v63
    s_add_u32 s51, s49, 12288
    s_mov_b32 m0, s59
    s_nop 0
    buffer_load_dwordx4 v12, s[24:27], s51 offen offset:0 nt lds
    ds_read_b128 a[148:151], v11 offset:128
    s_waitcnt lgkmcnt(4)
    v_mfma_f32_32x32x16_bf16 v[72:87], a[156:159], a[108:111], v[72:87]
    v_cvt_pk_bf16_f32 v32, v56, v57
    v_cvt_pk_bf16_f32 v33, v58, v59
    v_cvt_pk_bf16_f32 v34, v60, v61
    ds_read_b128 a[152:155], v8 offset:256
    s_waitcnt lgkmcnt(4)
    v_mfma_f32_32x32x16_bf16 v[72:87], a[160:163], a[112:115], v[72:87]
    v_cvt_pk_bf16_f32 v35, v62, v63
    v_exp_f32 v64, v64
    v_exp_f32 v65, v65
    ds_read_b128 a[156:159], v9 offset:256
    s_waitcnt lgkmcnt(4)
    v_mfma_f32_32x32x16_bf16 v[72:87], a[164:167], a[116:119], v[72:87]
    v_exp_f32 v66, v66
    v_exp_f32 v67, v67
    buffer_load_dwordx4 v13, s[24:27], s51 offen offset:1024 nt lds
    ds_read_b128 a[160:163], v10 offset:256
    s_waitcnt lgkmcnt(4)
    v_mfma_f32_32x32x16_bf16 v[72:87], a[144:147], a[120:123], v[72:87]
    v_exp_f32 v68, v68
    v_exp_f32 v69, v69
    v_exp_f32 v70, v70
    ds_read_b128 a[164:167], v11 offset:256
    s_waitcnt lgkmcnt(4)
    v_mfma_f32_32x32x16_bf16 v[72:87], a[148:151], a[124:127], v[72:87]
    v_exp_f32 v71, v71
    v_cvt_pk_bf16_f32 v36, v64, v65
    v_cvt_pk_bf16_f32 v37, v66, v67
    s_waitcnt lgkmcnt(3)
    v_mfma_f32_32x32x16_bf16 v[72:87], a[152:155], a[128:131], v[72:87]
    v_cvt_pk_bf16_f32 v38, v68, v69
    v_cvt_pk_bf16_f32 v39, v70, v71
    buffer_load_dwordx4 v14, s[24:27], s51 offen offset:2048 nt lds
    s_add_u32 s59, s59, 12288
    s_cmp_eq_u32 s59, s68
    s_cselect_b32 s59, s67, s59
    v_add_u32 v8, s66, v6
    v_add_u32 v9, s66, v7
    s_add_u32 s66, s66, 12288
    s_cmp_eq_u32 s66, 61440
    s_cselect_b32 s66, 0, s66
    s_waitcnt lgkmcnt(0)
    s_waitcnt vmcnt(9)
    s_barrier
    ds_read_b64_tr_b16 a[144:145], v8 offset:0
    ds_read_b64_tr_b16 a[146:147], v8 offset:3072
    ds_read_b64_tr_b16 a[148:149], v9 offset:0
    ds_read_b64_tr_b16 a[150:151], v9 offset:3072
    v_mfma_f32_32x32x16_bf16 v[72:87], a[156:159], a[132:135], v[72:87]
    ds_read_b64_tr_b16 a[152:153], v8 offset:128
    ds_read_b64_tr_b16 a[154:155], v8 offset:3200
    v_mfma_f32_32x32x16_bf16 v[72:87], a[160:163], a[136:139], v[72:87]
    ds_read_b64_tr_b16 a[156:157], v9 offset:128
    ds_read_b64_tr_b16 a[158:159], v9 offset:3200
    v_mfma_f32_32x32x16_bf16 v[72:87], a[164:167], a[140:143], v[72:87]
    ds_read_b64_tr_b16 a[160:161], v8 offset:256
    ds_read_b64_tr_b16 a[162:163], v8 offset:3328
    s_waitcnt lgkmcnt(8)
    v_mfma_f32_32x32x16_bf16 a[0:15], a[144:147], v[32:35], a[0:15]
    v_add_f32 v24, v24, v56
    v_add_f32 v24, v24, v57
    v_add_f32 v24, v24, v58
    v_add_f32 v24, v24, v59
    ds_read_b64_tr_b16 a[164:165], v9 offset:256
    ds_read_b64_tr_b16 a[166:167], v9 offset:3328
    s_waitcnt lgkmcnt(8)
    v_mfma_f32_32x32x16_bf16 a[16:31], a[148:151], v[32:35], a[16:31]
    v_add_f32 v24, v24, v60
    v_add_f32 v24, v24, v61
    v_add_f32 v24, v24, v62
    ds_read_b64_tr_b16 a[144:145], v8 offset:6144
    ds_read_b64_tr_b16 a[146:147], v8 offset:9216
    s_waitcnt lgkmcnt(8)
    v_mfma_f32_32x32x16_bf16 a[32:47], a[152:155], v[32:35], a[32:47]
    v_add_f32 v24, v24, v63
    v_add_f32 v24, v24, v64
    s_add_u32 s51, s49, 0
    s_mov_b32 m0, s59
    s_nop 0
    buffer_load_dwordx4 v15, s[28:31], s51 offen offset:0 nt lds
    ds_read_b64_tr_b16 a[148:149], v9 offset:6144
    ds_read_b64_tr_b16 a[150:151], v9 offset:9216
    s_waitcnt lgkmcnt(8)
    v_mfma_f32_32x32x16_bf16 a[48:63], a[156:159], v[32:35], a[48:63]
    v_add_f32 v24, v24, v65
    v_add_f32 v24, v24, v66
    v_add_f32 v24, v24, v67
    ds_read_b64_tr_b16 a[152:153], v8 offset:6272
    ds_read_b64_tr_b16 a[154:155], v8 offset:9344
    s_waitcnt lgkmcnt(8)
    v_mfma_f32_32x32x16_bf16 a[64:79], a[160:163], v[32:35], a[64:79]
    v_add_f32 v24, v24, v68
    v_add_f32 v24, v24, v69
    v_add_f32 v24, v24, v70
    v_add_f32 v24, v24, v71
    ds_read_b64_tr_b16 a[156:157], v9 offset:6272
    ds_read_b64_tr_b16 a[158:159], v9 offset:9344
    s_waitcnt lgkmcnt(8)
    v_mfma_f32_32x32x16_bf16 a[80:95], a[164:167], v[32:35], a[80:95]
    v_max3_f32 v26, v72, v73, v74
    v_max3_f32 v26, v26, v75, v76
    buffer_load_dwordx4 v16, s[28:31], s51 offen offset:1024 nt lds
    ds_read_b64_tr_b16 a[160:161], v8 offset:6400
    ds_read_b64_tr_b16 a[162:163], v8 offset:9472
    s_waitcnt lgkmcnt(8)
    v_mfma_f32_32x32x16_bf16 a[0:15], a[144:147], v[36:39], a[0:15]
    v_max3_f32 v26, v26, v77, v78
    v_max3_f32 v26, v26, v79, v80
    v_max3_f32 v26, v26, v81, v82
    ds_read_b64_tr_b16 a[164:165], v9 offset:6400
    ds_read_b64_tr_b16 a[166:167], v9 offset:9472
    s_waitcnt lgkmcnt(8)
    v_mfma_f32_32x32x16_bf16 a[16:31], a[148:151], v[36:39], a[16:31]
    v_max3_f32 v26, v26, v83, v84
    v_max3_f32 v26, v26, v85, v86
    v_max_f32 v26, v26, v87
    s_waitcnt lgkmcnt(6)
    v_mfma_f32_32x32x16_bf16 a[32:47], a[152:155], v[36:39], a[32:47]
    v_cmp_lt_f32 vcc, 0x41000000, v26
    s_nop 1
    s_mov_b64 s[54:55], vcc
    buffer_load_dwordx4 v17, s[28:31], s51 offen offset:2048 nt lds
    s_add_u32 s59, s59, 12288
    s_cmp_eq_u32 s59, s68
    s_cselect_b32 s59, s67, s59
    v_add_u32 v8, s66, v6
    v_add_u32 v9, s66, v7
    s_add_u32 s66, s66, 12288
    s_cmp_eq_u32 s66, 61440
    s_cselect_b32 s66, 0, s66
    s_waitcnt lgkmcnt(0)
    s_waitcnt vmcnt(9)
    s_barrier
    ds_read_b64_tr_b16 a[144:145], v8 offset:0
    ds_read_b64_tr_b16 a[146:147], v8 offset:3072
    ds_read_b64_tr_b16 a[148:149], v9 offset:0
    ds_read_b64_tr_b16 a[150:151], v9 offset:3072
    v_mfma_f32_32x32x16_bf16 a[48:63], a[156:159], v[36:39], a[48:63]
    ds_read_b64_tr_b16 a[152:153], v8 offset:128
    ds_read_b64_tr_b16 a[154:155], v8 offset:3200
    v_mfma_f32_32x32x16_bf16 a[64:79], a[160:163], v[36:39], a[64:79]
    ds_read_b64_tr_b16 a[156:157], v9 offset:128
    ds_read_b64_tr_b16 a[158:159], v9 offset:3200
    v_mfma_f32_32x32x16_bf16 a[80:95], a[164:167], v[36:39], a[80:95]
    ds_read_b64_tr_b16 a[160:161], v8 offset:256
    ds_read_b64_tr_b16 a[162:163], v8 offset:3328
    ds_read_b128 a[96:99], v20 offset:0
    ds_read_b128 a[100:103], v20 offset:1024
    ds_read_b128 a[104:107], v20 offset:2048
    ds_read_b128 a[108:111], v20 offset:3072
    ds_read_b128 a[112:115], v20 offset:4096
    ds_read_b128 a[116:119], v20 offset:5120
    ds_read_b128 a[120:123], v20 offset:6144
    ds_read_b128 a[124:127], v20 offset:7168
    ds_read_b128 a[128:131], v20 offset:8192
    ds_read_b128 a[132:135], v20 offset:9216
    ds_read_b128 a[136:139], v20 offset:10240
    ds_read_b128 a[140:143], v20 offset:11264
    s_mov_b32 s56, 14
    s_cmp_lg_u64 s[54:55], 0
    s_cbranch_scc1 attn_SLOW1
attn_RET14:
    v_exp_f32 v72, v72
    v_exp_f32 v73, v73
    v_exp_f32 v74, v74
    v_exp_f32 v75, v75
    v_exp_f32 v76, v76
    v_exp_f32 v77, v77
    v_exp_f32 v78, v78
    v_exp_f32 v79, v79
    v_cvt_pk_bf16_f32 v56, v72, v73
    v_cvt_pk_bf16_f32 v57, v74, v75
    v_cvt_pk_bf16_f32 v58, v76, v77
    v_cvt_pk_bf16_f32 v59, v78, v79
    v_exp_f32 v80, v80
    v_exp_f32 v81, v81
    v_exp_f32 v82, v82
    v_exp_f32 v83, v83
    v_exp_f32 v84, v84
    v_exp_f32 v85, v85
    v_exp_f32 v86, v86
    v_exp_f32 v87, v87
    v_cvt_pk_bf16_f32 v60, v80, v81
    v_cvt_pk_bf16_f32 v61, v82, v83
    v_cvt_pk_bf16_f32 v62, v84, v85
    v_cvt_pk_bf16_f32 v63, v86, v87
    s_waitcnt lgkmcnt(15)
    v_mfma_f32_32x32x16_bf16 a[0:15], a[144:147], v[56:59], a[0:15]
    v_add_f32 v24, v24, v72
    v_add_f32 v24, v24, v73
    ds_read_b64_tr_b16 a[164:165], v9 offset:256
    ds_read_b64_tr_b16 a[166:167], v9 offset:3328
    v_mfma_f32_32x32x16_bf16 a[16:31], a[148:151], v[56:59], a[16:31]
    v_add_f32 v24, v24, v74
    v_add_f32 v24, v24, v75
    ds_read_b64_tr_b16 a[144:145], v8 offset:6144
    ds_read_b64_tr_b16 a[146:147], v8 offset:9216
    v_mfma_f32_32x32x16_bf16 a[32:47], a[152:155], v[56:59], a[32:47]
    v_add_f32 v24, v24, v76
    ds_read_b64_tr_b16 a[148:149], v9 offset:6144
    ds_read_b64_tr_b16 a[150:151], v9 offset:9216
    s_waitcnt lgkmcnt(15)
    v_mfma_f32_32x32x16_bf16 a[48:63], a[156:159], v[56:59], a[48:63]
    v_add_f32 v24, v24, v77
    s_add_u32 s51, s49, 24576
    s_mov_b32 m0, s59
    s_nop 0
    buffer_load_dwordx4 v12, s[24:27], s51 offen offset:0 nt lds
    ds_read_b64_tr_b16 a[152:153], v8 offset:6272
    ds_read_b64_tr_b16 a[154:155], v8 offset:9344
    v_mfma_f32_32x32x16_bf16 a[64:79], a[160:163], v[56:59], a[64:79]
    v_add_f32 v24, v24, v78
    v_add_f32 v24, v24, v79
    ds_read_b64_tr_b16 a[156:157], v9 offset:6272
    ds_read_b64_tr_b16 a[158:159], v9 offset:9344
    s_waitcnt lgkmcnt(8)
    v_mfma_f32_32x32x16_bf16 a[80:95], a[164:167], v[56:59], a[80:95]
    v_add_f32 v24, v24, v80
    ds_read_b64_tr_b16 a[160:161], v8 offset:6400
    ds_read_b64_tr_b16 a[162:163], v8 offset:9472
    s_waitcnt lgkmcnt(8)
    v_mfma_f32_32x32x16_bf16 a[0:15], a[144:147], v[60:63], a[0:15]
    v_add_f32 v24, v24, v81
    v_add_f32 v24, v24, v82
    ds_read_b64_tr_b16 a[164:165], v9 offset:6400
    ds_read_b64_tr_b16 a[166:167], v9 offset:9472
    s_waitcnt lgkmcnt(8)
    v_mfma_f32_32x32x16_bf16 a[16:31], a[148:151], v[60:63], a[16:31]
    v_add_f32 v24, v24, v83
    buffer_load_dwordx4 v13, s[24:27], s51 offen offset:1024 nt lds
    s_waitcnt lgkmcnt(6)
    v_mfma_f32_32x32x16_bf16 a[32:47], a[152:155], v[60:63], a[32:47]
    v_add_f32 v24, v24, v84
    s_waitcnt lgkmcnt(4)
    v_mfma_f32_32x32x16_bf16 a[48:63], a[156:159], v[60:63], a[48:63]
    v_add_f32 v24, v24, v85
    v_add_f32 v24, v24, v86
    s_waitcnt lgkmcnt(2)
    v_mfma_f32_32x32x16_bf16 a[64:79], a[160:163], v[60:63], a[64:79]
    v_add_f32 v24, v24, v87
    v_mov_b32 v27, v24
    s_nop 1
    v_permlane32_swap_b32 v24, v27
    v_add_f32 v24, v24, v27
    v_rcp_f32 v25, v24
    s_mov_b64 s[54:55], 0
    s_waitcnt lgkmcnt(0)
    v_mfma_f32_32x32x16_bf16 a[80:95], a[164:167], v[60:63], a[80:95]
    buffer_load_dwordx4 v14, s[24:27], s51 offen offset:2048 nt lds
    s_add_u32 s59, s59, 12288
    s_cmp_eq_u32 s59, s68
    s_cselect_b32 s59, s67, s59
    v_accvgpr_read_b32 v56, a0
    v_accvgpr_read_b32 v57, a1
    v_accvgpr_read_b32 v58, a2
    v_accvgpr_read_b32 v59, a3
    v_accvgpr_read_b32 v60, a4
    v_accvgpr_read_b32 v61, a5
    v_accvgpr_read_b32 v62, a6
    v_accvgpr_read_b32 v63, a7
    v_accvgpr_read_b32 v64, a8
    v_accvgpr_read_b32 v65, a9
    v_accvgpr_read_b32 v66, a10
    v_accvgpr_read_b32 v67, a11
    v_accvgpr_read_b32 v68, a12
    v_accvgpr_read_b32 v69, a13
    v_accvgpr_read_b32 v70, a14
    v_accvgpr_read_b32 v71, a15
    v_mul_f32 v56, v56, v25
    v_mul_f32 v57, v57, v25
    v_mul_f32 v58, v58, v25
    v_mul_f32 v59, v59, v25
    v_mul_f32 v60, v60, v25
    v_mul_f32 v61, v61, v25
    v_mul_f32 v62, v62, v25
    v_mul_f32 v63, v63, v25
    v_mul_f32 v64, v64, v25
    v_mul_f32 v65, v65, v25
    v_mul_f32 v66, v66, v25
    v_mul_f32 v67, v67, v25
    v_mul_f32 v68, v68, v25
    v_mul_f32 v69, v69, v25
    v_mul_f32 v70, v70, v25
    v_mul_f32 v71, v71, v25
    v_cvt_pk_bf16_f32 v72, v56, v57
    v_cvt_pk_bf16_f32 v73, v58, v59
    v_cvt_pk_bf16_f32 v74, v60, v61
    v_cvt_pk_bf16_f32 v75, v62, v63
    v_cvt_pk_bf16_f32 v76, v64, v65
    v_cvt_pk_bf16_f32 v77, v66, v67
    v_cvt_pk_bf16_f32 v78, v68, v69
    v_cvt_pk_bf16_f32 v79, v70, v71
    s_add_u32 s52, s58, 0
    buffer_store_dwordx4 v[72:75], v23, s[36:39], s52 offen offset:0 sc1
    buffer_store_dwordx4 v[76:79], v23, s[36:39], s52 offen offset:1024 sc1
    v_accvgpr_read_b32 v56, a16
    v_accvgpr_read_b32 v57, a17
    v_accvgpr_read_b32 v58, a18
    v_accvgpr_read_b32 v59, a19
    v_accvgpr_read_b32 v60, a20
    v_accvgpr_read_b32 v61, a21
    v_accvgpr_read_b32 v62, a22
    v_accvgpr_read_b32 v63, a23
    v_accvgpr_read_b32 v64, a24
    v_accvgpr_read_b32 v65, a25
    v_accvgpr_read_b32 v66, a26
    v_accvgpr_read_b32 v67, a27
    v_accvgpr_read_b32 v68, a28
    v_accvgpr_read_b32 v69, a29
    v_accvgpr_read_b32 v70, a30
    v_accvgpr_read_b32 v71, a31
    v_mul_f32 v56, v56, v25
    v_mul_f32 v57, v57, v25
    v_mul_f32 v58, v58, v25
    v_mul_f32 v59, v59, v25
    v_mul_f32 v60, v60, v25
    v_mul_f32 v61, v61, v25
    v_mul_f32 v62, v62, v25
    v_mul_f32 v63, v63, v25
    v_mul_f32 v64, v64, v25
    v_mul_f32 v65, v65, v25
    v_mul_f32 v66, v66, v25
    v_mul_f32 v67, v67, v25
    v_mul_f32 v68, v68, v25
    v_mul_f32 v69, v69, v25
    v_mul_f32 v70, v70, v25
    v_mul_f32 v71, v71, v25
    v_cvt_pk_bf16_f32 v72, v56, v57
    v_cvt_pk_bf16_f32 v73, v58, v59
    v_cvt_pk_bf16_f32 v74, v60, v61
    v_cvt_pk_bf16_f32 v75, v62, v63
    v_cvt_pk_bf16_f32 v76, v64, v65
    v_cvt_pk_bf16_f32 v77, v66, v67
    v_cvt_pk_bf16_f32 v78, v68, v69
    v_cvt_pk_bf16_f32 v79, v70, v71
    s_add_u32 s52, s58, 2048
    buffer_store_dwordx4 v[72:75], v23, s[36:39], s52 offen offset:0 sc1
    buffer_store_dwordx4 v[76:79], v23, s[36:39], s52 offen offset:1024 sc1
    v_accvgpr_read_b32 v56, a32
    v_accvgpr_read_b32 v57, a33
    v_accvgpr_read_b32 v58, a34
    v_accvgpr_read_b32 v59, a35
    v_accvgpr_read_b32 v60, a36
    v_accvgpr_read_b32 v61, a37
    v_accvgpr_read_b32 v62, a38
    v_accvgpr_read_b32 v63, a39
    v_accvgpr_read_b32 v64, a40
    v_accvgpr_read_b32 v65, a41
    v_accvgpr_read_b32 v66, a42
    v_accvgpr_read_b32 v67, a43
    v_accvgpr_read_b32 v68, a44
    v_accvgpr_read_b32 v69, a45
    v_accvgpr_read_b32 v70, a46
    v_accvgpr_read_b32 v71, a47
    v_mul_f32 v56, v56, v25
    v_mul_f32 v57, v57, v25
    v_mul_f32 v58, v58, v25
    v_mul_f32 v59, v59, v25
    v_mul_f32 v60, v60, v25
    v_mul_f32 v61, v61, v25
    v_mul_f32 v62, v62, v25
    v_mul_f32 v63, v63, v25
    v_mul_f32 v64, v64, v25
    v_mul_f32 v65, v65, v25
    v_mul_f32 v66, v66, v25
    v_mul_f32 v67, v67, v25
    v_mul_f32 v68, v68, v25
    v_mul_f32 v69, v69, v25
    v_mul_f32 v70, v70, v25
    v_mul_f32 v71, v71, v25
    v_cvt_pk_bf16_f32 v72, v56, v57
    v_cvt_pk_bf16_f32 v73, v58, v59
    v_cvt_pk_bf16_f32 v74, v60, v61
    v_cvt_pk_bf16_f32 v75, v62, v63
    v_cvt_pk_bf16_f32 v76, v64, v65
    v_cvt_pk_bf16_f32 v77, v66, v67
    v_cvt_pk_bf16_f32 v78, v68, v69
    v_cvt_pk_bf16_f32 v79, v70, v71
    s_add_u32 s52, s58, 4096
    buffer_store_dwordx4 v[72:75], v23, s[36:39], s52 offen offset:0 sc1
    buffer_store_dwordx4 v[76:79], v23, s[36:39], s52 offen offset:1024 sc1
    v_accvgpr_read_b32 v56, a48
    v_accvgpr_read_b32 v57, a49
    v_accvgpr_read_b32 v58, a50
    v_accvgpr_read_b32 v59, a51
    v_accvgpr_read_b32 v60, a52
    v_accvgpr_read_b32 v61, a53
    v_accvgpr_read_b32 v62, a54
    v_accvgpr_read_b32 v63, a55
    v_accvgpr_read_b32 v64, a56
    v_accvgpr_read_b32 v65, a57
    v_accvgpr_read_b32 v66, a58
    v_accvgpr_read_b32 v67, a59
    v_accvgpr_read_b32 v68, a60
    v_accvgpr_read_b32 v69, a61
    v_accvgpr_read_b32 v70, a62
    v_accvgpr_read_b32 v71, a63
    v_mul_f32 v56, v56, v25
    v_mul_f32 v57, v57, v25
    v_mul_f32 v58, v58, v25
    v_mul_f32 v59, v59, v25
    v_mul_f32 v60, v60, v25
    v_mul_f32 v61, v61, v25
    v_mul_f32 v62, v62, v25
    v_mul_f32 v63, v63, v25
    v_mul_f32 v64, v64, v25
    v_mul_f32 v65, v65, v25
    v_mul_f32 v66, v66, v25
    v_mul_f32 v67, v67, v25
    v_mul_f32 v68, v68, v25
    v_mul_f32 v69, v69, v25
    v_mul_f32 v70, v70, v25
    v_mul_f32 v71, v71, v25
    v_cvt_pk_bf16_f32 v72, v56, v57
    v_cvt_pk_bf16_f32 v73, v58, v59
    v_cvt_pk_bf16_f32 v74, v60, v61
    v_cvt_pk_bf16_f32 v75, v62, v63
    v_cvt_pk_bf16_f32 v76, v64, v65
    v_cvt_pk_bf16_f32 v77, v66, v67
    v_cvt_pk_bf16_f32 v78, v68, v69
    v_cvt_pk_bf16_f32 v79, v70, v71
    s_add_u32 s52, s58, 6144
    buffer_store_dwordx4 v[72:75], v23, s[36:39], s52 offen offset:0 sc1
    buffer_store_dwordx4 v[76:79], v23, s[36:39], s52 offen offset:1024 sc1
    v_accvgpr_read_b32 v56, a64
    v_accvgpr_read_b32 v57, a65
    v_accvgpr_read_b32 v58, a66
    v_accvgpr_read_b32 v59, a67
    v_accvgpr_read_b32 v60, a68
    v_accvgpr_read_b32 v61, a69
    v_accvgpr_read_b32 v62, a70
    v_accvgpr_read_b32 v63, a71
    v_accvgpr_read_b32 v64, a72
    v_accvgpr_read_b32 v65, a73
    v_accvgpr_read_b32 v66, a74
    v_accvgpr_read_b32 v67, a75
    v_accvgpr_read_b32 v68, a76
    v_accvgpr_read_b32 v69, a77
    v_accvgpr_read_b32 v70, a78
    v_accvgpr_read_b32 v71, a79
    v_mul_f32 v56, v56, v25
    v_mul_f32 v57, v57, v25
    v_mul_f32 v58, v58, v25
    v_mul_f32 v59, v59, v25
    v_mul_f32 v60, v60, v25
    v_mul_f32 v61, v61, v25
    v_mul_f32 v62, v62, v25
    v_mul_f32 v63, v63, v25
    v_mul_f32 v64, v64, v25
    v_mul_f32 v65, v65, v25
    v_mul_f32 v66, v66, v25
    v_mul_f32 v67, v67, v25
    v_mul_f32 v68, v68, v25
    v_mul_f32 v69, v69, v25
    v_mul_f32 v70, v70, v25
    v_mul_f32 v71, v71, v25
    v_cvt_pk_bf16_f32 v72, v56, v57
    v_cvt_pk_bf16_f32 v73, v58, v59
    v_cvt_pk_bf16_f32 v74, v60, v61
    v_cvt_pk_bf16_f32 v75, v62, v63
    v_cvt_pk_bf16_f32 v76, v64, v65
    v_cvt_pk_bf16_f32 v77, v66, v67
    v_cvt_pk_bf16_f32 v78, v68, v69
    v_cvt_pk_bf16_f32 v79, v70, v71
    s_add_u32 s52, s58, 8192
    buffer_store_dwordx4 v[72:75], v23, s[36:39], s52 offen offset:0 sc1
    buffer_store_dwordx4 v[76:79], v23, s[36:39], s52 offen offset:1024 sc1
    v_accvgpr_read_b32 v56, a80
    v_accvgpr_read_b32 v57, a81
    v_accvgpr_read_b32 v58, a82
    v_accvgpr_read_b32 v59, a83
    v_accvgpr_read_b32 v60, a84
    v_accvgpr_read_b32 v61, a85
    v_accvgpr_read_b32 v62, a86
    v_accvgpr_read_b32 v63, a87
    v_accvgpr_read_b32 v64, a88
    v_accvgpr_read_b32 v65, a89
    v_accvgpr_read_b32 v66, a90
    v_accvgpr_read_b32 v67, a91
    v_accvgpr_read_b32 v68, a92
    v_accvgpr_read_b32 v69, a93
    v_accvgpr_read_b32 v70, a94
    v_accvgpr_read_b32 v71, a95
    v_mul_f32 v56, v56, v25
    v_mul_f32 v57, v57, v25
    v_mul_f32 v58, v58, v25
    v_mul_f32 v59, v59, v25
    v_mul_f32 v60, v60, v25
    v_mul_f32 v61, v61, v25
    v_mul_f32 v62, v62, v25
    v_mul_f32 v63, v63, v25
    v_mul_f32 v64, v64, v25
    v_mul_f32 v65, v65, v25
    v_mul_f32 v66, v66, v25
    v_mul_f32 v67, v67, v25
    v_mul_f32 v68, v68, v25
    v_mul_f32 v69, v69, v25
    v_mul_f32 v70, v70, v25
    v_mul_f32 v71, v71, v25
    v_cvt_pk_bf16_f32 v72, v56, v57
    v_cvt_pk_bf16_f32 v73, v58, v59
    v_cvt_pk_bf16_f32 v74, v60, v61
    v_cvt_pk_bf16_f32 v75, v62, v63
    v_cvt_pk_bf16_f32 v76, v64, v65
    v_cvt_pk_bf16_f32 v77, v66, v67
    v_cvt_pk_bf16_f32 v78, v68, v69
    v_cvt_pk_bf16_f32 v79, v70, v71
    s_add_u32 s52, s58, 10240
    buffer_store_dwordx4 v[72:75], v23, s[36:39], s52 offen offset:0 sc1
    buffer_store_dwordx4 v[76:79], v23, s[36:39], s52 offen offset:1024 sc1
    s_add_u32 s58, s58, 196608
    s_mov_b32 s48, s49
    s_add_u32 s49, s49, 786432
    s_add_u32 s50, s50, 1
    s_cmp_lt_u32 s50, 4
    s_cbranch_scc1 attn_ALOOP
    s_waitcnt vmcnt(0)
    s_branch attn_K2
attn_SLOW0:
    s_nop 7
    s_nop 7
    v_max3_f32 v26, v56, v57, v58
    v_max3_f32 v26, v26, v59, v60
    v_max3_f32 v26, v26, v61, v62
    v_max3_f32 v26, v26, v63, v64
    v_max3_f32 v26, v26, v65, v66
    v_max3_f32 v26, v26, v67, v68
    v_max3_f32 v26, v26, v69, v70
    v_max_f32 v26, v26, v71
    v_mov_b32 v27, v26
    s_nop 1
    v_permlane32_swap_b32 v26, v27
    v_max_f32 v26, v26, v27
    v_max_f32 v26, 0, v26
    v_sub_f32 v56, v56, v26
    v_sub_f32 v57, v57, v26
    v_sub_f32 v58, v58, v26
    v_sub_f32 v59, v59, v26
    v_sub_f32 v60, v60, v26
    v_sub_f32 v61, v61, v26
    v_sub_f32 v62, v62, v26
    v_sub_f32 v63, v63, v26
    v_sub_f32 v64, v64, v26
    v_sub_f32 v65, v65, v26
    v_sub_f32 v66, v66, v26
    v_sub_f32 v67, v67, v26
    v_sub_f32 v68, v68, v26
    v_sub_f32 v69, v69, v26
    v_sub_f32 v70, v70, v26
    v_sub_f32 v71, v71, v26
    v_sub_f32 v40, v40, v26
    v_sub_f32 v41, v41, v26
    v_sub_f32 v42, v42, v26
    v_sub_f32 v43, v43, v26
    v_sub_f32 v44, v44, v26
    v_sub_f32 v45, v45, v26
    v_sub_f32 v46, v46, v26
    v_sub_f32 v47, v47, v26
    v_sub_f32 v48, v48, v26
    v_sub_f32 v49, v49, v26
    v_sub_f32 v50, v50, v26
    v_sub_f32 v51, v51, v26
    v_sub_f32 v52, v52, v26
    v_sub_f32 v53, v53, v26
    v_sub_f32 v54, v54, v26
    v_sub_f32 v55, v55, v26
    v_sub_f32 v27, 0, v26
    v_exp_f32 v27, v27
    s_nop 0
    v_mul_f32 v24, v24, v27
    v_accvgpr_read_b32 v32, a0
    v_accvgpr_read_b32 v33, a1
    v_accvgpr_read_b32 v34, a2
    v_accvgpr_read_b32 v35, a3
    v_accvgpr_read_b32 v36, a4
    v_accvgpr_read_b32 v37, a5
    v_accvgpr_read_b32 v38, a6
    v_accvgpr_read_b32 v39, a7
    v_mul_f32 v32, v32, v27
    v_mul_f32 v33, v33, v27
    v_mul_f32 v34, v34, v27
    v_mul_f32 v35, v35, v27
    v_mul_f32 v36, v36, v27
    v_mul_f32 v37, v37, v27
    v_mul_f32 v38, v38, v27
    v_mul_f32 v39, v39, v27
    v_accvgpr_write_b32 a0, v32
    v_accvgpr_write_b32 a1, v33
    v_accvgpr_write_b32 a2, v34
    v_accvgpr_write_b32 a3, v35
    v_accvgpr_write_b32 a4, v36
    v_accvgpr_write_b32 a5, v37
    v_accvgpr_write_b32 a6, v38
    v_accvgpr_write_b32 a7, v39
    v_accvgpr_read_b32 v32, a8
    v_accvgpr_read_b32 v33, a9
    v_accvgpr_read_b32 v34, a10
    v_accvgpr_read_b32 v35, a11
    v_accvgpr_read_b32 v36, a12
    v_accvgpr_read_b32 v37, a13
    v_accvgpr_read_b32 v38, a14
    v_accvgpr_read_b32 v39, a15
    v_mul_f32 v32, v32, v27
    v_mul_f32 v33, v33, v27
    v_mul_f32 v34, v34, v27
    v_mul_f32 v35, v35, v27
    v_mul_f32 v36, v36, v27
    v_mul_f32 v37, v37, v27
    v_mul_f32 v38, v38, v27
    v_mul_f32 v39, v39, v27
    v_accvgpr_write_b32 a8, v32
    v_accvgpr_write_b32 a9, v33
    v_accvgpr_write_b32 a10, v34
    v_accvgpr_write_b32 a11, v35
    v_accvgpr_write_b32 a12, v36
    v_accvgpr_write_b32 a13, v37
    v_accvgpr_write_b32 a14, v38
    v_accvgpr_write_b32 a15, v39
    v_accvgpr_read_b32 v32, a16
    v_accvgpr_read_b32 v33, a17
    v_accvgpr_read_b32 v34, a18
    v_accvgpr_read_b32 v35, a19
    v_accvgpr_read_b32 v36, a20
    v_accvgpr_read_b32 v37, a21
    v_accvgpr_read_b32 v38, a22
    v_accvgpr_read_b32 v39, a23
    v_mul_f32 v32, v32, v27
    v_mul_f32 v33, v33, v27
    v_mul_f32 v34, v34, v27
    v_mul_f32 v35, v35, v27
    v_mul_f32 v36, v36, v27
    v_mul_f32 v37, v37, v27
    v_mul_f32 v38, v38, v27
    v_mul_f32 v39, v39, v27
    v_accvgpr_write_b32 a16, v32
    v_accvgpr_write_b32 a17, v33
    v_accvgpr_write_b32 a18, v34
    v_accvgpr_write_b32 a19, v35
    v_accvgpr_write_b32 a20, v36
    v_accvgpr_write_b32 a21, v37
    v_accvgpr_write_b32 a22, v38
    v_accvgpr_write_b32 a23, v39
    v_accvgpr_read_b32 v32, a24
    v_accvgpr_read_b32 v33, a25
    v_accvgpr_read_b32 v34, a26
    v_accvgpr_read_b32 v35, a27
    v_accvgpr_read_b32 v36, a28
    v_accvgpr_read_b32 v37, a29
    v_accvgpr_read_b32 v38, a30
    v_accvgpr_read_b32 v39, a31
    v_mul_f32 v32, v32, v27
    v_mul_f32 v33, v33, v27
    v_mul_f32 v34, v34, v27
    v_mul_f32 v35, v35, v27
    v_mul_f32 v36, v36, v27
    v_mul_f32 v37, v37, v27
    v_mul_f32 v38, v38, v27
    v_mul_f32 v39, v39, v27
    v_accvgpr_write_b32 a24, v32
    v_accvgpr_write_b32 a25, v33
    v_accvgpr_write_b32 a26, v34
    v_accvgpr_write_b32 a27, v35
    v_accvgpr_write_b32 a28, v36
    v_accvgpr_write_b32 a29, v37
    v_accvgpr_write_b32 a30, v38
    v_accvgpr_write_b32 a31, v39
    v_accvgpr_read_b32 v32, a32
    v_accvgpr_read_b32 v33, a33
    v_accvgpr_read_b32 v34, a34
    v_accvgpr_read_b32 v35, a35
    v_accvgpr_read_b32 v36, a36
    v_accvgpr_read_b32 v37, a37
    v_accvgpr_read_b32 v38, a38
    v_accvgpr_read_b32 v39, a39
    v_mul_f32 v32, v32, v27
    v_mul_f32 v33, v33, v27
    v_mul_f32 v34, v34, v27
    v_mul_f32 v35, v35, v27
    v_mul_f32 v36, v36, v27
    v_mul_f32 v37, v37, v27
    v_mul_f32 v38, v38, v27
    v_mul_f32 v39, v39, v27
    v_accvgpr_write_b32 a32, v32
    v_accvgpr_write_b32 a33, v33
    v_accvgpr_write_b32 a34, v34
    v_accvgpr_write_b32 a35, v35
    v_accvgpr_write_b32 a36, v36
    v_accvgpr_write_b32 a37, v37
    v_accvgpr_write_b32 a38, v38
    v_accvgpr_write_b32 a39, v39
    v_accvgpr_read_b32 v32, a40
    v_accvgpr_read_b32 v33, a41
    v_accvgpr_read_b32 v34, a42
    v_accvgpr_read_b32 v35, a43
    v_accvgpr_read_b32 v36, a44
    v_accvgpr_read_b32 v37, a45
    v_accvgpr_read_b32 v38, a46
    v_accvgpr_read_b32 v39, a47
    v_mul_f32 v32, v32, v27
    v_mul_f32 v33, v33, v27
    v_mul_f32 v34, v34, v27
    v_mul_f32 v35, v35, v27
    v_mul_f32 v36, v36, v27
    v_mul_f32 v37, v37, v27
    v_mul_f32 v38, v38, v27
    v_mul_f32 v39, v39, v27
    v_accvgpr_write_b32 a40, v32
    v_accvgpr_write_b32 a41, v33
    v_accvgpr_write_b32 a42, v34
    v_accvgpr_write_b32 a43, v35
    v_accvgpr_write_b32 a44, v36
    v_accvgpr_write_b32 a45, v37
    v_accvgpr_write_b32 a46, v38
    v_accvgpr_write_b32 a47, v39
    v_accvgpr_read_b32 v32, a48
    v_accvgpr_read_b32 v33, a49
    v_accvgpr_read_b32 v34, a50
    v_accvgpr_read_b32 v35, a51
    v_accvgpr_read_b32 v36, a52
    v_accvgpr_read_b32 v37, a53
    v_accvgpr_read_b32 v38, a54
    v_accvgpr_read_b32 v39, a55
    v_mul_f32 v32, v32, v27
    v_mul_f32 v33, v33, v27
    v_mul_f32 v34, v34, v27
    v_mul_f32 v35, v35, v27
    v_mul_f32 v36, v36, v27
    v_mul_f32 v37, v37, v27
    v_mul_f32 v38, v38, v27
    v_mul_f32 v39, v39, v27
    v_accvgpr_write_b32 a48, v32
    v_accvgpr_write_b32 a49, v33
    v_accvgpr_write_b32 a50, v34
    v_accvgpr_write_b32 a51, v35
    v_accvgpr_write_b32 a52, v36
    v_accvgpr_write_b32 a53, v37
    v_accvgpr_write_b32 a54, v38
    v_accvgpr_write_b32 a55, v39
    v_accvgpr_read_b32 v32, a56
    v_accvgpr_read_b32 v33, a57
    v_accvgpr_read_b32 v34, a58
    v_accvgpr_read_b32 v35, a59
    v_accvgpr_read_b32 v36, a60
    v_accvgpr_read_b32 v37, a61
    v_accvgpr_read_b32 v38, a62
    v_accvgpr_read_b32 v39, a63
    v_mul_f32 v32, v32, v27
    v_mul_f32 v33, v33, v27
    v_mul_f32 v34, v34, v27
    v_mul_f32 v35, v35, v27
    v_mul_f32 v36, v36, v27
    v_mul_f32 v37, v37, v27
    v_mul_f32 v38, v38, v27
    v_mul_f32 v39, v39, v27
    v_accvgpr_write_b32 a56, v32
    v_accvgpr_write_b32 a57, v33
    v_accvgpr_write_b32 a58, v34
    v_accvgpr_write_b32 a59, v35
    v_accvgpr_write_b32 a60, v36
    v_accvgpr_write_b32 a61, v37
    v_accvgpr_write_b32 a62, v38
    v_accvgpr_write_b32 a63, v39
    v_accvgpr_read_b32 v32, a64
    v_accvgpr_read_b32 v33, a65
    v_accvgpr_read_b32 v34, a66
    v_accvgpr_read_b32 v35, a67
    v_accvgpr_read_b32 v36, a68
    v_accvgpr_read_b32 v37, a69
    v_accvgpr_read_b32 v38, a70
    v_accvgpr_read_b32 v39, a71
    v_mul_f32 v32, v32, v27
    v_mul_f32 v33, v33, v27
    v_mul_f32 v34, v34, v27
    v_mul_f32 v35, v35, v27
    v_mul_f32 v36, v36, v27
    v_mul_f32 v37, v37, v27
    v_mul_f32 v38, v38, v27
    v_mul_f32 v39, v39, v27
    v_accvgpr_write_b32 a64, v32
    v_accvgpr_write_b32 a65, v33
    v_accvgpr_write_b32 a66, v34
    v_accvgpr_write_b32 a67, v35
    v_accvgpr_write_b32 a68, v36
    v_accvgpr_write_b32 a69, v37
    v_accvgpr_write_b32 a70, v38
    v_accvgpr_write_b32 a71, v39
    v_accvgpr_read_b32 v32, a72
    v_accvgpr_read_b32 v33, a73
    v_accvgpr_read_b32 v34, a74
    v_accvgpr_read_b32 v35, a75
    v_accvgpr_read_b32 v36, a76
    v_accvgpr_read_b32 v37, a77
    v_accvgpr_read_b32 v38, a78
    v_accvgpr_read_b32 v39, a79
    v_mul_f32 v32, v32, v27
    v_mul_f32 v33, v33, v27
    v_mul_f32 v34, v34, v27
    v_mul_f32 v35, v35, v27
    v_mul_f32 v36, v36, v27
    v_mul_f32 v37, v37, v27
    v_mul_f32 v38, v38, v27
    v_mul_f32 v39, v39, v27
    v_accvgpr_write_b32 a72, v32
    v_accvgpr_write_b32 a73, v33
    v_accvgpr_write_b32 a74, v34
    v_accvgpr_write_b32 a75, v35
    v_accvgpr_write_b32 a76, v36
    v_accvgpr_write_b32 a77, v37
    v_accvgpr_write_b32 a78, v38
    v_accvgpr_write_b32 a79, v39
    v_accvgpr_read_b32 v32, a80
    v_accvgpr_read_b32 v33, a81
    v_accvgpr_read_b32 v34, a82
    v_accvgpr_read_b32 v35, a83
    v_accvgpr_read_b32 v36, a84
    v_accvgpr_read_b32 v37, a85
    v_accvgpr_read_b32 v38, a86
    v_accvgpr_read_b32 v39, a87
    v_mul_f32 v32, v32, v27
    v_mul_f32 v33, v33, v27
    v_mul_f32 v34, v34, v27
    v_mul_f32 v35, v35, v27
    v_mul_f32 v36, v36, v27
    v_mul_f32 v37, v37, v27
    v_mul_f32 v38, v38, v27
    v_mul_f32 v39, v39, v27
    v_accvgpr_write_b32 a80, v32
    v_accvgpr_write_b32 a81, v33
    v_accvgpr_write_b32 a82, v34
    v_accvgpr_write_b32 a83, v35
    v_accvgpr_write_b32 a84, v36
    v_accvgpr_write_b32 a85, v37
    v_accvgpr_write_b32 a86, v38
    v_accvgpr_write_b32 a87, v39
    v_accvgpr_read_b32 v32, a88
    v_accvgpr_read_b32 v33, a89
    v_accvgpr_read_b32 v34, a90
    v_accvgpr_read_b32 v35, a91
    v_accvgpr_read_b32 v36, a92
    v_accvgpr_read_b32 v37, a93
    v_accvgpr_read_b32 v38, a94
    v_accvgpr_read_b32 v39, a95
    v_mul_f32 v32, v32, v27
    v_mul_f32 v33, v33, v27
    v_mul_f32 v34, v34, v27
    v_mul_f32 v35, v35, v27
    v_mul_f32 v36, v36, v27
    v_mul_f32 v37, v37, v27
    v_mul_f32 v38, v38, v27
    v_mul_f32 v39, v39, v27
    v_accvgpr_write_b32 a88, v32
    v_accvgpr_write_b32 a89, v33
    v_accvgpr_write_b32 a90, v34
    v_accvgpr_write_b32 a91, v35
    v_accvgpr_write_b32 a92, v36
    v_accvgpr_write_b32 a93, v37
    v_accvgpr_write_b32 a94, v38
    v_accvgpr_write_b32 a95, v39
    s_nop 7
    s_nop 7
    s_cmp_eq_u32 s56, 1
    s_cbranch_scc1 attn_RET1
    s_cmp_eq_u32 s56, 3
    s_cbranch_scc1 attn_RET3
    s_cmp_eq_u32 s56, 5
    s_cbranch_scc1 attn_RET5
    s_cmp_eq_u32 s56, 7
    s_cbranch_scc1 attn_RET7
    s_cmp_eq_u32 s56, 9
    s_cbranch_scc1 attn_RET9
    s_cmp_eq_u32 s56, 11
    s_cbranch_scc1 attn_RET11
    s_cmp_eq_u32 s56, 13
    s_cbranch_scc1 attn_RET13
    s_endpgm
attn_SLOW1:
    s_nop 7
    s_nop 7
    v_max3_f32 v26, v72, v73, v74
    v_max3_f32 v26, v26, v75, v76
    v_max3_f32 v26, v26, v77, v78
    v_max3_f32 v26, v26, v79, v80
    v_max3_f32 v26, v26, v81, v82
    v_max3_f32 v26, v26, v83, v84
    v_max3_f32 v26, v26, v85, v86
    v_max_f32 v26, v26, v87
    v_mov_b32 v27, v26
    s_nop 1
    v_permlane32_swap_b32 v26, v27
    v_max_f32 v26, v26, v27
    v_max_f32 v26, 0, v26
    v_sub_f32 v72, v72, v26
    v_sub_f32 v73, v73, v26
    v_sub_f32 v74, v74, v26
    v_sub_f32 v75, v75, v26
    v_sub_f32 v76, v76, v26
    v_sub_f32 v77, v77, v26
    v_sub_f32 v78, v78, v26
    v_sub_f32 v79, v79, v26
    v_sub_f32 v80, v80, v26
    v_sub_f32 v81, v81, v26
    v_sub_f32 v82, v82, v26
    v_sub_f32 v83, v83, v26
    v_sub_f32 v84, v84, v26
    v_sub_f32 v85, v85, v26
    v_sub_f32 v86, v86, v26
    v_sub_f32 v87, v87, v26
    v_sub_f32 v40, v40, v26
    v_sub_f32 v41, v41, v26
    v_sub_f32 v42, v42, v26
    v_sub_f32 v43, v43, v26
    v_sub_f32 v44, v44, v26
    v_sub_f32 v45, v45, v26
    v_sub_f32 v46, v46, v26
    v_sub_f32 v47, v47, v26
    v_sub_f32 v48, v48, v26
    v_sub_f32 v49, v49, v26
    v_sub_f32 v50, v50, v26
    v_sub_f32 v51, v51, v26
    v_sub_f32 v52, v52, v26
    v_sub_f32 v53, v53, v26
    v_sub_f32 v54, v54, v26
    v_sub_f32 v55, v55, v26
    v_sub_f32 v27, 0, v26
    v_exp_f32 v27, v27
    s_nop 0
    v_mul_f32 v24, v24, v27
    v_accvgpr_read_b32 v32, a0
    v_accvgpr_read_b32 v33, a1
    v_accvgpr_read_b32 v34, a2
    v_accvgpr_read_b32 v35, a3
    v_accvgpr_read_b32 v36, a4
    v_accvgpr_read_b32 v37, a5
    v_accvgpr_read_b32 v38, a6
    v_accvgpr_read_b32 v39, a7
    v_mul_f32 v32, v32, v27
    v_mul_f32 v33, v33, v27
    v_mul_f32 v34, v34, v27
    v_mul_f32 v35, v35, v27
    v_mul_f32 v36, v36, v27
    v_mul_f32 v37, v37, v27
    v_mul_f32 v38, v38, v27
    v_mul_f32 v39, v39, v27
    v_accvgpr_write_b32 a0, v32
    v_accvgpr_write_b32 a1, v33
    v_accvgpr_write_b32 a2, v34
    v_accvgpr_write_b32 a3, v35
    v_accvgpr_write_b32 a4, v36
    v_accvgpr_write_b32 a5, v37
    v_accvgpr_write_b32 a6, v38
    v_accvgpr_write_b32 a7, v39
    v_accvgpr_read_b32 v32, a8
    v_accvgpr_read_b32 v33, a9
    v_accvgpr_read_b32 v34, a10
    v_accvgpr_read_b32 v35, a11
    v_accvgpr_read_b32 v36, a12
    v_accvgpr_read_b32 v37, a13
    v_accvgpr_read_b32 v38, a14
    v_accvgpr_read_b32 v39, a15
    v_mul_f32 v32, v32, v27
    v_mul_f32 v33, v33, v27
    v_mul_f32 v34, v34, v27
    v_mul_f32 v35, v35, v27
    v_mul_f32 v36, v36, v27
    v_mul_f32 v37, v37, v27
    v_mul_f32 v38, v38, v27
    v_mul_f32 v39, v39, v27
    v_accvgpr_write_b32 a8, v32
    v_accvgpr_write_b32 a9, v33
    v_accvgpr_write_b32 a10, v34
    v_accvgpr_write_b32 a11, v35
    v_accvgpr_write_b32 a12, v36
    v_accvgpr_write_b32 a13, v37
    v_accvgpr_write_b32 a14, v38
    v_accvgpr_write_b32 a15, v39
    v_accvgpr_read_b32 v32, a16
    v_accvgpr_read_b32 v33, a17
    v_accvgpr_read_b32 v34, a18
    v_accvgpr_read_b32 v35, a19
    v_accvgpr_read_b32 v36, a20
    v_accvgpr_read_b32 v37, a21
    v_accvgpr_read_b32 v38, a22
    v_accvgpr_read_b32 v39, a23
    v_mul_f32 v32, v32, v27
    v_mul_f32 v33, v33, v27
    v_mul_f32 v34, v34, v27
    v_mul_f32 v35, v35, v27
    v_mul_f32 v36, v36, v27
    v_mul_f32 v37, v37, v27
    v_mul_f32 v38, v38, v27
    v_mul_f32 v39, v39, v27
    v_accvgpr_write_b32 a16, v32
    v_accvgpr_write_b32 a17, v33
    v_accvgpr_write_b32 a18, v34
    v_accvgpr_write_b32 a19, v35
    v_accvgpr_write_b32 a20, v36
    v_accvgpr_write_b32 a21, v37
    v_accvgpr_write_b32 a22, v38
    v_accvgpr_write_b32 a23, v39
    v_accvgpr_read_b32 v32, a24
    v_accvgpr_read_b32 v33, a25
    v_accvgpr_read_b32 v34, a26
    v_accvgpr_read_b32 v35, a27
    v_accvgpr_read_b32 v36, a28
    v_accvgpr_read_b32 v37, a29
    v_accvgpr_read_b32 v38, a30
    v_accvgpr_read_b32 v39, a31
    v_mul_f32 v32, v32, v27
    v_mul_f32 v33, v33, v27
    v_mul_f32 v34, v34, v27
    v_mul_f32 v35, v35, v27
    v_mul_f32 v36, v36, v27
    v_mul_f32 v37, v37, v27
    v_mul_f32 v38, v38, v27
    v_mul_f32 v39, v39, v27
    v_accvgpr_write_b32 a24, v32
    v_accvgpr_write_b32 a25, v33
    v_accvgpr_write_b32 a26, v34
    v_accvgpr_write_b32 a27, v35
    v_accvgpr_write_b32 a28, v36
    v_accvgpr_write_b32 a29, v37
    v_accvgpr_write_b32 a30, v38
    v_accvgpr_write_b32 a31, v39
    v_accvgpr_read_b32 v32, a32
    v_accvgpr_read_b32 v33, a33
    v_accvgpr_read_b32 v34, a34
    v_accvgpr_read_b32 v35, a35
    v_accvgpr_read_b32 v36, a36
    v_accvgpr_read_b32 v37, a37
    v_accvgpr_read_b32 v38, a38
    v_accvgpr_read_b32 v39, a39
    v_mul_f32 v32, v32, v27
    v_mul_f32 v33, v33, v27
    v_mul_f32 v34, v34, v27
    v_mul_f32 v35, v35, v27
    v_mul_f32 v36, v36, v27
    v_mul_f32 v37, v37, v27
    v_mul_f32 v38, v38, v27
    v_mul_f32 v39, v39, v27
    v_accvgpr_write_b32 a32, v32
    v_accvgpr_write_b32 a33, v33
    v_accvgpr_write_b32 a34, v34
    v_accvgpr_write_b32 a35, v35
    v_accvgpr_write_b32 a36, v36
    v_accvgpr_write_b32 a37, v37
    v_accvgpr_write_b32 a38, v38
    v_accvgpr_write_b32 a39, v39
    v_accvgpr_read_b32 v32, a40
    v_accvgpr_read_b32 v33, a41
    v_accvgpr_read_b32 v34, a42
    v_accvgpr_read_b32 v35, a43
    v_accvgpr_read_b32 v36, a44
    v_accvgpr_read_b32 v37, a45
    v_accvgpr_read_b32 v38, a46
    v_accvgpr_read_b32 v39, a47
    v_mul_f32 v32, v32, v27
    v_mul_f32 v33, v33, v27
    v_mul_f32 v34, v34, v27
    v_mul_f32 v35, v35, v27
    v_mul_f32 v36, v36, v27
    v_mul_f32 v37, v37, v27
    v_mul_f32 v38, v38, v27
    v_mul_f32 v39, v39, v27
    v_accvgpr_write_b32 a40, v32
    v_accvgpr_write_b32 a41, v33
    v_accvgpr_write_b32 a42, v34
    v_accvgpr_write_b32 a43, v35
    v_accvgpr_write_b32 a44, v36
    v_accvgpr_write_b32 a45, v37
    v_accvgpr_write_b32 a46, v38
    v_accvgpr_write_b32 a47, v39
    v_accvgpr_read_b32 v32, a48
    v_accvgpr_read_b32 v33, a49
    v_accvgpr_read_b32 v34, a50
    v_accvgpr_read_b32 v35, a51
    v_accvgpr_read_b32 v36, a52
    v_accvgpr_read_b32 v37, a53
    v_accvgpr_read_b32 v38, a54
    v_accvgpr_read_b32 v39, a55
    v_mul_f32 v32, v32, v27
    v_mul_f32 v33, v33, v27
    v_mul_f32 v34, v34, v27
    v_mul_f32 v35, v35, v27
    v_mul_f32 v36, v36, v27
    v_mul_f32 v37, v37, v27
    v_mul_f32 v38, v38, v27
    v_mul_f32 v39, v39, v27
    v_accvgpr_write_b32 a48, v32
    v_accvgpr_write_b32 a49, v33
    v_accvgpr_write_b32 a50, v34
    v_accvgpr_write_b32 a51, v35
    v_accvgpr_write_b32 a52, v36
    v_accvgpr_write_b32 a53, v37
    v_accvgpr_write_b32 a54, v38
    v_accvgpr_write_b32 a55, v39
    v_accvgpr_read_b32 v32, a56
    v_accvgpr_read_b32 v33, a57
    v_accvgpr_read_b32 v34, a58
    v_accvgpr_read_b32 v35, a59
    v_accvgpr_read_b32 v36, a60
    v_accvgpr_read_b32 v37, a61
    v_accvgpr_read_b32 v38, a62
    v_accvgpr_read_b32 v39, a63
    v_mul_f32 v32, v32, v27
    v_mul_f32 v33, v33, v27
    v_mul_f32 v34, v34, v27
    v_mul_f32 v35, v35, v27
    v_mul_f32 v36, v36, v27
    v_mul_f32 v37, v37, v27
    v_mul_f32 v38, v38, v27
    v_mul_f32 v39, v39, v27
    v_accvgpr_write_b32 a56, v32
    v_accvgpr_write_b32 a57, v33
    v_accvgpr_write_b32 a58, v34
    v_accvgpr_write_b32 a59, v35
    v_accvgpr_write_b32 a60, v36
    v_accvgpr_write_b32 a61, v37
    v_accvgpr_write_b32 a62, v38
    v_accvgpr_write_b32 a63, v39
    v_accvgpr_read_b32 v32, a64
    v_accvgpr_read_b32 v33, a65
    v_accvgpr_read_b32 v34, a66
    v_accvgpr_read_b32 v35, a67
    v_accvgpr_read_b32 v36, a68
    v_accvgpr_read_b32 v37, a69
    v_accvgpr_read_b32 v38, a70
    v_accvgpr_read_b32 v39, a71
    v_mul_f32 v32, v32, v27
    v_mul_f32 v33, v33, v27
    v_mul_f32 v34, v34, v27
    v_mul_f32 v35, v35, v27
    v_mul_f32 v36, v36, v27
    v_mul_f32 v37, v37, v27
    v_mul_f32 v38, v38, v27
    v_mul_f32 v39, v39, v27
    v_accvgpr_write_b32 a64, v32
    v_accvgpr_write_b32 a65, v33
    v_accvgpr_write_b32 a66, v34
    v_accvgpr_write_b32 a67, v35
    v_accvgpr_write_b32 a68, v36
    v_accvgpr_write_b32 a69, v37
    v_accvgpr_write_b32 a70, v38
    v_accvgpr_write_b32 a71, v39
    v_accvgpr_read_b32 v32, a72
    v_accvgpr_read_b32 v33, a73
    v_accvgpr_read_b32 v34, a74
    v_accvgpr_read_b32 v35, a75
    v_accvgpr_read_b32 v36, a76
    v_accvgpr_read_b32 v37, a77
    v_accvgpr_read_b32 v38, a78
    v_accvgpr_read_b32 v39, a79
    v_mul_f32 v32, v32, v27
    v_mul_f32 v33, v33, v27
    v_mul_f32 v34, v34, v27
    v_mul_f32 v35, v35, v27
    v_mul_f32 v36, v36, v27
    v_mul_f32 v37, v37, v27
    v_mul_f32 v38, v38, v27
    v_mul_f32 v39, v39, v27
    v_accvgpr_write_b32 a72, v32
    v_accvgpr_write_b32 a73, v33
    v_accvgpr_write_b32 a74, v34
    v_accvgpr_write_b32 a75, v35
    v_accvgpr_write_b32 a76, v36
    v_accvgpr_write_b32 a77, v37
    v_accvgpr_write_b32 a78, v38
    v_accvgpr_write_b32 a79, v39
    v_accvgpr_read_b32 v32, a80
    v_accvgpr_read_b32 v33, a81
    v_accvgpr_read_b32 v34, a82
    v_accvgpr_read_b32 v35, a83
    v_accvgpr_read_b32 v36, a84
    v_accvgpr_read_b32 v37, a85
    v_accvgpr_read_b32 v38, a86
    v_accvgpr_read_b32 v39, a87
    v_mul_f32 v32, v32, v27
    v_mul_f32 v33, v33, v27
    v_mul_f32 v34, v34, v27
    v_mul_f32 v35, v35, v27
    v_mul_f32 v36, v36, v27
    v_mul_f32 v37, v37, v27
    v_mul_f32 v38, v38, v27
    v_mul_f32 v39, v39, v27
    v_accvgpr_write_b32 a80, v32
    v_accvgpr_write_b32 a81, v33
    v_accvgpr_write_b32 a82, v34
    v_accvgpr_write_b32 a83, v35
    v_accvgpr_write_b32 a84, v36
    v_accvgpr_write_b32 a85, v37
    v_accvgpr_write_b32 a86, v38
    v_accvgpr_write_b32 a87, v39
    v_accvgpr_read_b32 v32, a88
    v_accvgpr_read_b32 v33, a89
    v_accvgpr_read_b32 v34, a90
    v_accvgpr_read_b32 v35, a91
    v_accvgpr_read_b32 v36, a92
    v_accvgpr_read_b32 v37, a93
    v_accvgpr_read_b32 v38, a94
    v_accvgpr_read_b32 v39, a95
    v_mul_f32 v32, v32, v27
    v_mul_f32 v33, v33, v27
    v_mul_f32 v34, v34, v27
    v_mul_f32 v35, v35, v27
    v_mul_f32 v36, v36, v27
    v_mul_f32 v37, v37, v27
    v_mul_f32 v38, v38, v27
    v_mul_f32 v39, v39, v27
    v_accvgpr_write_b32 a88, v32
    v_accvgpr_write_b32 a89, v33
    v_accvgpr_write_b32 a90, v34
    v_accvgpr_write_b32 a91, v35
    v_accvgpr_write_b32 a92, v36
    v_accvgpr_write_b32 a93, v37
    v_accvgpr_write_b32 a94, v38
    v_accvgpr_write_b32 a95, v39
    s_nop 7
    s_nop 7
    s_cmp_eq_u32 s56, 0
    s_cbranch_scc1 attn_RET0
    s_cmp_eq_u32 s56, 2
    s_cbranch_scc1 attn_RET2
    s_cmp_eq_u32 s56, 4
    s_cbranch_scc1 attn_RET4
    s_cmp_eq_u32 s56, 6
    s_cbranch_scc1 attn_RET6
    s_cmp_eq_u32 s56, 8
    s_cbranch_scc1 attn_RET8
    s_cmp_eq_u32 s56, 10
    s_cbranch_scc1 attn_RET10
    s_cmp_eq_u32 s56, 12
    s_cbranch_scc1 attn_RET12
    s_cmp_eq_u32 s56, 14
    s_cbranch_scc1 attn_RET14
    s_endpgm
attn_GSTART:
    s_nop 7
    s_nop 7
    v_lshrrev_b32 v56, 5, v0
    v_bfe_u32 v57, v0, 4, 1
    v_and_b32 v58, 3, v0
    v_bfe_u32 v59, v0, 2, 2
    v_bfe_u32 v60, v0, 3, 1
    v_lshrrev_b32 v61, 1, v58
    v_and_b32 v62, 1, v58
    v_lshl_add_u32 v63, v56, 3, v59
    v_mul_u32_u24 v63, 128, v63
    v_lshl_add_u32 v63, v61, 3, v63
    v_lshl_add_u32 v63, v62, 4, v63
    v_lshl_add_u32 v63, v57, 5, v63
    v_add_u32 v63, 110592, v63
    v_xor_b32 v64, 0, v60
    v_lshl_add_u32 v2, v64, 6, v63
    v_xor_b32 v64, 1, v60
    v_lshl_add_u32 v3, v64, 6, v63
    s_lshl_b32 s51, s22, 4
    v_lshrrev_b32 v56, 3, v0
    v_add_u32 v56, s51, v56
    s_movk_i32 s52, 12288
    v_mul_lo_u32 v56, v56, s52
    v_bfe_u32 v57, v0, 4, 1
    v_lshlrev_b32 v57, 2, v57
    v_and_b32 v58, 7, v0
    v_xor_b32 v57, v57, v58
    v_lshl_add_u32 v4, v57, 4, v56
    s_lshl_b32 s51, s22, 5
    v_and_b32 v56, 31, v0
    v_add_u32 v56, s51, v56
    v_mul_u32_u24 v56, 1280, v56
    v_lshrrev_b32 v57, 5, v0
    v_lshl_add_u32 v6, v57, 4, v56
    s_mul_i32 s51, s22, 12288
    s_add_u32 s52, s51, 61440
    v_lshlrev_b32 v5, 4, v0
    v_add_u32 v5, s52, v5
    s_mov_b32 s44, s14
    s_mov_b32 s45, s15
    s_mov_b32 s46, 7864320
    s_mov_b32 s47, 0x00020000
    s_mul_i32 s51, s61, 163840
    s_mov_b32 s40, s8
    s_mov_b32 s41, s9
    s_add_u32 s40, s40, s51
    s_addc_u32 s41, s41, 0
    s_mov_b32 s42, 163840
    s_mov_b32 s43, 0x00020000
    s_mul_i32 s65, s62, 384
    s_add_u32 s69, s65, 1536
    s_lshl_b32 s60, s22, 11
    s_add_u32 s60, s60, 110592
    s_mov_b32 s50, 0
    s_mov_b32 s84, s80
    s_mov_b32 s85, s81
    s_mov_b32 s86, 256
    s_mov_b32 s87, 0x00020000
    s_mov_b32 s24, s20
    s_mov_b32 s25, s21
    s_add_u32 s24, s24, 201326592
    s_addc_u32 s25, s25, 0
    s_mov_b32 s26, 8192
    s_mov_b32 s27, 0x00020000
    s_lshl_b32 s51, s63, 3
    s_lshr_b32 s52, s61, 1
    s_add_u32 s51, s51, s52
    s_lshl_b32 s51, s51, 1
    s_lshr_b32 s52, s62, 4
    s_add_u32 s51, s51, s52
    s_lshl_b32 s51, s51, 1
    s_bfe_u32 s52, s62, 0x10001
    s_add_u32 s51, s51, s52
    s_and_b32 s52, s61, 1
    s_lshl_b32 s52, s52, 1
    s_and_b32 s53, s62, 1
    s_add_u32 s52, s52, s53
    s_lshl_b32 s51, s51, 7
    s_lshl_b32 s52, s52, 2
    s_add_u32 s51, s51, s52
    s_cmp_eq_u32 s22, 0
    s_cselect_b32 s51, s51, 0x100000
    v_mov_b32 v1, s51
    s_mov_b32 s53, 0x3dd53b95
    buffer_load_dwordx4 a[0:3], v6, s[40:43], 0 offen offset:0
    buffer_load_dwordx4 a[4:7], v6, s[40:43], 0 offen offset:32
    buffer_load_dwordx4 a[8:11], v6, s[40:43], 0 offen offset:64
    buffer_load_dwordx4 a[12:15], v6, s[40:43], 0 offen offset:96
    s_add_u32 s51, s65, 0
    s_add_u32 m0, s60, 0
    s_nop 0
    buffer_load_dwordx4 v4, s[44:47], s51 offen offset:0 lds
    s_add_u32 s51, s65, 97280
    buffer_load_dwordx4 v4, s[44:47], s51 offen offset:1024 lds
    buffer_load_dwordx4 a[16:19], v6, s[40:43], 0 offen offset:128
    buffer_load_dwordx4 a[20:23], v6, s[40:43], 0 offen offset:160
    buffer_load_dwordx4 a[24:27], v6, s[40:43], 0 offen offset:192
    buffer_load_dwordx4 a[28:31], v6, s[40:43], 0 offen offset:224
    s_add_u32 s51, s65, 786432
    s_add_u32 m0, s60, 8192
    s_nop 0
    buffer_load_dwordx4 v4, s[44:47], s51 offen offset:0 lds
    s_add_u32 s51, s65, 883712
    buffer_load_dwordx4 v4, s[44:47], s51 offen offset:1024 lds
    buffer_load_dwordx4 a[32:35], v6, s[40:43], 0 offen offset:256
    buffer_load_dwordx4 a[36:39], v6, s[40:43], 0 offen offset:288
    buffer_load_dwordx4 a[40:43], v6, s[40:43], 0 offen offset:320
    buffer_load_dwordx4 a[44:47], v6, s[40:43], 0 offen offset:352
    s_add_u32 s51, s65, 1572864
    s_add_u32 m0, s60, 16384
    s_nop 0
    buffer_load_dwordx4 v4, s[44:47], s51 offen offset:0 lds
    s_add_u32 s51, s65, 1670144
    buffer_load_dwordx4 v4, s[44:47], s51 offen offset:1024 lds
    buffer_load_dwordx4 a[48:51], v6, s[40:43], 0 offen offset:384
    buffer_load_dwordx4 a[52:55], v6, s[40:43], 0 offen offset:416
    buffer_load_dwordx4 a[56:59], v6, s[40:43], 0 offen offset:448
    buffer_load_dwordx4 a[60:63], v6, s[40:43], 0 offen offset:480
    s_add_u32 s51, s65, 2359296
    s_add_u32 m0, s60, 24576
    s_nop 0
    buffer_load_dwordx4 v4, s[44:47], s51 offen offset:0 lds
    s_add_u32 s51, s65, 2456576
    buffer_load_dwordx4 v4, s[44:47], s51 offen offset:1024 lds
    buffer_load_dwordx4 a[64:67], v6, s[40:43], 0 offen offset:512
    buffer_load_dwordx4 a[68:71], v6, s[40:43], 0 offen offset:544
    buffer_load_dwordx4 a[72:75], v6, s[40:43], 0 offen offset:576
    buffer_load_dwordx4 a[76:79], v6, s[40:43], 0 offen offset:608
    s_add_u32 s51, s65, 3145728
    s_add_u32 m0, s60, 32768
    s_nop 0
    buffer_load_dwordx4 v4, s[44:47], s51 offen offset:0 lds
    s_add_u32 s51, s65, 3243008
    buffer_load_dwordx4 v4, s[44:47], s51 offen offset:1024 lds
    s_waitcnt vmcnt(24)
    s_barrier
    ds_read_b64_tr_b16 v[8:9], v2 offset:0
    ds_read_b64_tr_b16 v[10:11], v2 offset:512
    ds_read_b64_tr_b16 v[12:13], v3 offset:0
    ds_read_b64_tr_b16 v[14:15], v3 offset:512
    ds_read_b64_tr_b16 v[16:17], v2 offset:2048
    ds_read_b64_tr_b16 v[18:19], v2 offset:2560
    ds_read_b64_tr_b16 v[20:21], v3 offset:2048
    ds_read_b64_tr_b16 v[22:23], v3 offset:2560
    ds_read_b64_tr_b16 a[160:161], v2 offset:4096
    ds_read_b64_tr_b16 a[162:163], v2 offset:4608
    s_waitcnt lgkmcnt(8)
    v_mfma_f32_32x32x16_bf16 v[24:39], v[8:11], a[0:3], 0
    buffer_load_dwordx4 a[80:83], v6, s[40:43], 0 offen offset:640
    buffer_load_dwordx4 a[84:87], v6, s[40:43], 0 offen offset:672
    ds_read_b64_tr_b16 a[164:165], v3 offset:4096
    ds_read_b64_tr_b16 a[166:167], v3 offset:4608
    s_waitcnt lgkmcnt(8)
    v_mfma_f32_32x32x16_bf16 v[40:55], v[12:15], a[0:3], 0
    buffer_load_dwordx4 a[88:91], v6, s[40:43], 0 offen offset:704
    ds_read_b64_tr_b16 v[8:9], v2 offset:6144
    ds_read_b64_tr_b16 v[10:11], v2 offset:6656
    s_waitcnt lgkmcnt(8)
    v_mfma_f32_32x32x16_bf16 v[24:39], v[16:19], a[4:7], v[24:39]
    buffer_load_dwordx4 a[92:95], v6, s[40:43], 0 offen offset:736
    ds_read_b64_tr_b16 v[12:13], v3 offset:6144
    ds_read_b64_tr_b16 v[14:15], v3 offset:6656
    s_waitcnt lgkmcnt(8)
    v_mfma_f32_32x32x16_bf16 v[40:55], v[20:23], a[4:7], v[40:55]
    s_add_u32 s51, s65, 3932160
    s_add_u32 m0, s60, 40960
    s_nop 0
    buffer_load_dwordx4 v4, s[44:47], s51 offen offset:0 lds
    s_waitcnt lgkmcnt(6)
    v_mfma_f32_32x32x16_bf16 v[24:39], a[160:163], a[8:11], v[24:39]
    s_add_u32 s51, s65, 4029440
    buffer_load_dwordx4 v4, s[44:47], s51 offen offset:1024 lds
    s_waitcnt lgkmcnt(0)
    s_waitcnt vmcnt(24)
    s_barrier
    ds_read_b64_tr_b16 v[16:17], v2 offset:8192
    ds_read_b64_tr_b16 v[18:19], v2 offset:8704
    ds_read_b64_tr_b16 v[20:21], v3 offset:8192
    ds_read_b64_tr_b16 v[22:23], v3 offset:8704
    v_mfma_f32_32x32x16_bf16 v[40:55], a[164:167], a[8:11], v[40:55]
    ds_read_b64_tr_b16 a[160:161], v2 offset:10240
    ds_read_b64_tr_b16 a[162:163], v2 offset:10752
    v_mfma_f32_32x32x16_bf16 v[24:39], v[8:11], a[12:15], v[24:39]
    ds_read_b64_tr_b16 a[164:165], v3 offset:10240
    ds_read_b64_tr_b16 a[166:167], v3 offset:10752
    v_mfma_f32_32x32x16_bf16 v[40:55], v[12:15], a[12:15], v[40:55]
    ds_read_b64_tr_b16 v[8:9], v2 offset:12288
    ds_read_b64_tr_b16 v[10:11], v2 offset:12800
    s_waitcnt lgkmcnt(8)
    v_mfma_f32_32x32x16_bf16 v[24:39], v[16:19], a[16:19], v[24:39]
    buffer_load_dwordx4 a[96:99], v6, s[40:43], 0 offen offset:768
    buffer_load_dwordx4 a[100:103], v6, s[40:43], 0 offen offset:800
    ds_read_b64_tr_b16 v[12:13], v3 offset:12288
    ds_read_b64_tr_b16 v[14:15], v3 offset:12800
    s_waitcnt lgkmcnt(8)
    v_mfma_f32_32x32x16_bf16 v[40:55], v[20:23], a[16:19], v[40:55]
    buffer_load_dwordx4 a[104:107], v6, s[40:43], 0 offen offset:832
    ds_read_b64_tr_b16 v[16:17], v2 offset:14336
    ds_read_b64_tr_b16 v[18:19], v2 offset:14848
    s_waitcnt lgkmcnt(8)
    v_mfma_f32_32x32x16_bf16 v[24:39], a[160:163], a[20:23], v[24:39]
    buffer_load_dwordx4 a[108:111], v6, s[40:43], 0 offen offset:864
    ds_read_b64_tr_b16 v[20:21], v3 offset:14336
    ds_read_b64_tr_b16 v[22:23], v3 offset:14848
    s_waitcnt lgkmcnt(8)
    v_mfma_f32_32x32x16_bf16 v[40:55], a[164:167], a[20:23], v[40:55]
    s_add_u32 s51, s65, 4718592
    s_add_u32 m0, s60, 0
    s_nop 0
    buffer_load_dwordx4 v4, s[44:47], s51 offen offset:0 lds
    s_waitcnt lgkmcnt(6)
    v_mfma_f32_32x32x16_bf16 v[24:39], v[8:11], a[24:27], v[24:39]
    s_add_u32 s51, s65, 4815872
    buffer_load_dwordx4 v4, s[44:47], s51 offen offset:1024 lds
    s_waitcnt lgkmcnt(0)
    s_waitcnt vmcnt(24)
    s_barrier
    ds_read_b64_tr_b16 a[160:161], v2 offset:16384
    ds_read_b64_tr_b16 a[162:163], v2 offset:16896
    ds_read_b64_tr_b16 a[164:165], v3 offset:16384
    ds_read_b64_tr_b16 a[166:167], v3 offset:16896
    v_mfma_f32_32x32x16_bf16 v[40:55], v[12:15], a[24:27], v[40:55]
    ds_read_b64_tr_b16 v[8:9], v2 offset:18432
    ds_read_b64_tr_b16 v[10:11], v2 offset:18944
    v_mfma_f32_32x32x16_bf16 v[24:39], v[16:19], a[28:31], v[24:39]
    ds_read_b64_tr_b16 v[12:13], v3 offset:18432
    ds_read_b64_tr_b16 v[14:15], v3 offset:18944
    v_mfma_f32_32x32x16_bf16 v[40:55], v[20:23], a[28:31], v[40:55]
    ds_read_b64_tr_b16 v[16:17], v2 offset:20480
    ds_read_b64_tr_b16 v[18:19], v2 offset:20992
    s_waitcnt lgkmcnt(8)
    v_mfma_f32_32x32x16_bf16 v[24:39], a[160:163], a[32:35], v[24:39]
    buffer_load_dwordx4 a[112:115], v6, s[40:43], 0 offen offset:896
    buffer_load_dwordx4 a[116:119], v6, s[40:43], 0 offen offset:928
    ds_read_b64_tr_b16 v[20:21], v3 offset:20480
    ds_read_b64_tr_b16 v[22:23], v3 offset:20992
    s_waitcnt lgkmcnt(8)
    v_mfma_f32_32x32x16_bf16 v[40:55], a[164:167], a[32:35], v[40:55]
    buffer_load_dwordx4 a[120:123], v6, s[40:43], 0 offen offset:960
    ds_read_b64_tr_b16 a[160:161], v2 offset:22528
    ds_read_b64_tr_b16 a[162:163], v2 offset:23040
    s_waitcnt lgkmcnt(8)
    v_mfma_f32_32x32x16_bf16 v[24:39], v[8:11], a[36:39], v[24:39]
    buffer_load_dwordx4 a[124:127], v6, s[40:43], 0 offen offset:992
    ds_read_b64_tr_b16 a[164:165], v3 offset:22528
    ds_read_b64_tr_b16 a[166:167], v3 offset:23040
    s_waitcnt lgkmcnt(8)
    v_mfma_f32_32x32x16_bf16 v[40:55], v[12:15], a[36:39], v[40:55]
    s_add_u32 s51, s65, 5505024
    s_add_u32 m0, s60, 8192
    s_nop 0
    buffer_load_dwordx4 v4, s[44:47], s51 offen offset:0 lds
    s_waitcnt lgkmcnt(6)
    v_mfma_f32_32x32x16_bf16 v[24:39], v[16:19], a[40:43], v[24:39]
    s_add_u32 s51, s65, 5602304
    buffer_load_dwordx4 v4, s[44:47], s51 offen offset:1024 lds
    s_waitcnt lgkmcnt(0)
    s_waitcnt vmcnt(24)
    s_barrier
    ds_read_b64_tr_b16 v[8:9], v2 offset:24576
    ds_read_b64_tr_b16 v[10:11], v2 offset:25088
    ds_read_b64_tr_b16 v[12:13], v3 offset:24576
    ds_read_b64_tr_b16 v[14:15], v3 offset:25088
    v_mfma_f32_32x32x16_bf16 v[40:55], v[20:23], a[40:43], v[40:55]
    ds_read_b64_tr_b16 v[16:17], v2 offset:26624
    ds_read_b64_tr_b16 v[18:19], v2 offset:27136
    v_mfma_f32_32x32x16_bf16 v[24:39], a[160:163], a[44:47], v[24:39]
    ds_read_b64_tr_b16 v[20:21], v3 offset:26624
    ds_read_b64_tr_b16 v[22:23], v3 offset:27136
    v_mfma_f32_32x32x16_bf16 v[40:55], a[164:167], a[44:47], v[40:55]
    ds_read_b64_tr_b16 a[160:161], v2 offset:28672
    ds_read_b64_tr_b16 a[162:163], v2 offset:29184
    s_waitcnt lgkmcnt(8)
    v_mfma_f32_32x32x16_bf16 v[24:39], v[8:11], a[48:51], v[24:39]
    buffer_load_dwordx4 a[128:131], v6, s[40:43], 0 offen offset:1024
    buffer_load_dwordx4 a[132:135], v6, s[40:43], 0 offen offset:1056
    ds_read_b64_tr_b16 a[164:165], v3 offset:28672
    ds_read_b64_tr_b16 a[166:167], v3 offset:29184
    s_waitcnt lgkmcnt(8)
    v_mfma_f32_32x32x16_bf16 v[40:55], v[12:15], a[48:51], v[40:55]
    buffer_load_dwordx4 a[136:139], v6, s[40:43], 0 offen offset:1088
    ds_read_b64_tr_b16 v[8:9], v2 offset:30720
    ds_read_b64_tr_b16 v[10:11], v2 offset:31232
    s_waitcnt lgkmcnt(8)
    v_mfma_f32_32x32x16_bf16 v[24:39], v[16:19], a[52:55], v[24:39]
    buffer_load_dwordx4 a[140:143], v6, s[40:43], 0 offen offset:1120
    ds_read_b64_tr_b16 v[12:13], v3 offset:30720
    ds_read_b64_tr_b16 v[14:15], v3 offset:31232
    s_waitcnt lgkmcnt(8)
    v_mfma_f32_32x32x16_bf16 v[40:55], v[20:23], a[52:55], v[40:55]
    s_add_u32 s51, s65, 6291456
    s_add_u32 m0, s60, 16384
    s_nop 0
    buffer_load_dwordx4 v4, s[44:47], s51 offen offset:0 lds
    s_waitcnt lgkmcnt(6)
    v_mfma_f32_32x32x16_bf16 v[24:39], a[160:163], a[56:59], v[24:39]
    s_add_u32 s51, s65, 6388736
    buffer_load_dwordx4 v4, s[44:47], s51 offen offset:1024 lds
    s_waitcnt lgkmcnt(0)
    s_waitcnt vmcnt(24)
    s_barrier
    ds_read_b64_tr_b16 v[16:17], v2 offset:32768
    ds_read_b64_tr_b16 v[18:19], v2 offset:33280
    ds_read_b64_tr_b16 v[20:21], v3 offset:32768
    ds_read_b64_tr_b16 v[22:23], v3 offset:33280
    v_mfma_f32_32x32x16_bf16 v[40:55], a[164:167], a[56:59], v[40:55]
    ds_read_b64_tr_b16 a[160:161], v2 offset:34816
    ds_read_b64_tr_b16 a[162:163], v2 offset:35328
    v_mfma_f32_32x32x16_bf16 v[24:39], v[8:11], a[60:63], v[24:39]
    ds_read_b64_tr_b16 a[164:165], v3 offset:34816
    ds_read_b64_tr_b16 a[166:167], v3 offset:35328
    v_mfma_f32_32x32x16_bf16 v[40:55], v[12:15], a[60:63], v[40:55]
    ds_read_b64_tr_b16 v[8:9], v2 offset:36864
    ds_read_b64_tr_b16 v[10:11], v2 offset:37376
    s_waitcnt lgkmcnt(8)
    v_mfma_f32_32x32x16_bf16 v[24:39], v[16:19], a[64:67], v[24:39]
    buffer_load_dwordx4 a[144:147], v6, s[40:43], 0 offen offset:1152
    buffer_load_dwordx4 a[148:151], v6, s[40:43], 0 offen offset:1184
    ds_read_b64_tr_b16 v[12:13], v3 offset:36864
    ds_read_b64_tr_b16 v[14:15], v3 offset:37376
    s_waitcnt lgkmcnt(8)
    v_mfma_f32_32x32x16_bf16 v[40:55], v[20:23], a[64:67], v[40:55]
    buffer_load_dwordx4 a[152:155], v6, s[40:43], 0 offen offset:1216
    ds_read_b64_tr_b16 v[16:17], v2 offset:38912
    ds_read_b64_tr_b16 v[18:19], v2 offset:39424
    s_waitcnt lgkmcnt(8)
    v_mfma_f32_32x32x16_bf16 v[24:39], a[160:163], a[68:71], v[24:39]
    buffer_load_dwordx4 a[156:159], v6, s[40:43], 0 offen offset:1248
    ds_read_b64_tr_b16 v[20:21], v3 offset:38912
    ds_read_b64_tr_b16 v[22:23], v3 offset:39424
    s_waitcnt lgkmcnt(8)
    v_mfma_f32_32x32x16_bf16 v[40:55], a[164:167], a[68:71], v[40:55]
    s_add_u32 s51, s65, 7077888
    s_add_u32 m0, s60, 24576
    s_nop 0
    buffer_load_dwordx4 v4, s[44:47], s51 offen offset:0 lds
    s_waitcnt lgkmcnt(6)
    v_mfma_f32_32x32x16_bf16 v[24:39], v[8:11], a[72:75], v[24:39]
    s_add_u32 s51, s65, 7175168
    buffer_load_dwordx4 v4, s[44:47], s51 offen offset:1024 lds
    s_waitcnt lgkmcnt(0)
    s_waitcnt vmcnt(24)
    s_barrier
    ds_read_b64_tr_b16 a[160:161], v2 offset:40960
    ds_read_b64_tr_b16 a[162:163], v2 offset:41472
    ds_read_b64_tr_b16 a[164:165], v3 offset:40960
    ds_read_b64_tr_b16 a[166:167], v3 offset:41472
    v_mfma_f32_32x32x16_bf16 v[40:55], v[12:15], a[72:75], v[40:55]
    ds_read_b64_tr_b16 v[8:9], v2 offset:43008
    ds_read_b64_tr_b16 v[10:11], v2 offset:43520
    v_mfma_f32_32x32x16_bf16 v[24:39], v[16:19], a[76:79], v[24:39]
    ds_read_b64_tr_b16 v[12:13], v3 offset:43008
    ds_read_b64_tr_b16 v[14:15], v3 offset:43520
    v_mfma_f32_32x32x16_bf16 v[40:55], v[20:23], a[76:79], v[40:55]
    ds_read_b64_tr_b16 v[16:17], v2 offset:45056
    ds_read_b64_tr_b16 v[18:19], v2 offset:45568
    s_waitcnt lgkmcnt(8)
    v_mfma_f32_32x32x16_bf16 v[24:39], a[160:163], a[80:83], v[24:39]
    s_add_u32 s51, s65, 128
    s_add_u32 m0, s60, 32768
    s_nop 0
    buffer_load_dwordx4 v4, s[44:47], s51 offen offset:0 lds
    ds_read_b64_tr_b16 v[20:21], v3 offset:45056
    ds_read_b64_tr_b16 v[22:23], v3 offset:45568
    s_waitcnt lgkmcnt(8)
    v_mfma_f32_32x32x16_bf16 v[40:55], a[164:167], a[80:83], v[40:55]
    ds_read_b64_tr_b16 a[160:161], v2 offset:47104
    ds_read_b64_tr_b16 a[162:163], v2 offset:47616
    s_waitcnt lgkmcnt(8)
    v_mfma_f32_32x32x16_bf16 v[24:39], v[8:11], a[84:87], v[24:39]
    s_add_u32 s51, s65, 97408
    buffer_load_dwordx4 v4, s[44:47], s51 offen offset:1024 lds
    ds_read_b64_tr_b16 a[164:165], v3 offset:47104
    ds_read_b64_tr_b16 a[166:167], v3 offset:47616
    s_waitcnt lgkmcnt(8)
    v_mfma_f32_32x32x16_bf16 v[40:55], v[12:15], a[84:87], v[40:55]
    s_waitcnt lgkmcnt(6)
    v_mfma_f32_32x32x16_bf16 v[24:39], v[16:19], a[88:91], v[24:39]
    s_waitcnt lgkmcnt(0)
    s_waitcnt vmcnt(20)
    s_barrier
    ds_read_b64_tr_b16 v[8:9], v2 offset:0
    ds_read_b64_tr_b16 v[10:11], v2 offset:512
    ds_read_b64_tr_b16 v[12:13], v3 offset:0
    ds_read_b64_tr_b16 v[14:15], v3 offset:512
    v_mfma_f32_32x32x16_bf16 v[40:55], v[20:23], a[88:91], v[40:55]
    ds_read_b64_tr_b16 v[16:17], v2 offset:2048
    ds_read_b64_tr_b16 v[18:19], v2 offset:2560
    v_mfma_f32_32x32x16_bf16 v[24:39], a[160:163], a[92:95], v[24:39]
    ds_read_b64_tr_b16 v[20:21], v3 offset:2048
    ds_read_b64_tr_b16 v[22:23], v3 offset:2560
    v_mfma_f32_32x32x16_bf16 v[40:55], a[164:167], a[92:95], v[40:55]
    ds_read_b64_tr_b16 a[160:161], v2 offset:4096
    ds_read_b64_tr_b16 a[162:163], v2 offset:4608
    s_waitcnt lgkmcnt(8)
    v_mfma_f32_32x32x16_bf16 v[24:39], v[8:11], a[96:99], v[24:39]
    s_add_u32 s51, s65, 786560
    s_add_u32 m0, s60, 40960
    s_nop 0
    buffer_load_dwordx4 v4, s[44:47], s51 offen offset:0 lds
    ds_read_b64_tr_b16 a[164:165], v3 offset:4096
    ds_read_b64_tr_b16 a[166:167], v3 offset:4608
    s_waitcnt lgkmcnt(8)
    v_mfma_f32_32x32x16_bf16 v[40:55], v[12:15], a[96:99], v[40:55]
    ds_read_b64_tr_b16 v[8:9], v2 offset:6144
    ds_read_b64_tr_b16 v[10:11], v2 offset:6656
    s_waitcnt lgkmcnt(8)
    v_mfma_f32_32x32x16_bf16 v[24:39], v[16:19], a[100:103], v[24:39]
    s_add_u32 s51, s65, 883840
    buffer_load_dwordx4 v4, s[44:47], s51 offen offset:1024 lds
    ds_read_b64_tr_b16 v[12:13], v3 offset:6144
    ds_read_b64_tr_b16 v[14:15], v3 offset:6656
    s_waitcnt lgkmcnt(8)
    v_mfma_f32_32x32x16_bf16 v[40:55], v[20:23], a[100:103], v[40:55]
    s_waitcnt lgkmcnt(6)
    v_mfma_f32_32x32x16_bf16 v[24:39], a[160:163], a[104:107], v[24:39]
    s_waitcnt lgkmcnt(0)
    s_waitcnt vmcnt(16)
    s_barrier
    ds_read_b64_tr_b16 v[16:17], v2 offset:8192
    ds_read_b64_tr_b16 v[18:19], v2 offset:8704
    ds_read_b64_tr_b16 v[20:21], v3 offset:8192
    ds_read_b64_tr_b16 v[22:23], v3 offset:8704
    v_mfma_f32_32x32x16_bf16 v[40:55], a[164:167], a[104:107], v[40:55]
    ds_read_b64_tr_b16 a[160:161], v2 offset:10240
    ds_read_b64_tr_b16 a[162:163], v2 offset:10752
    v_mfma_f32_32x32x16_bf16 v[24:39], v[8:11], a[108:111], v[24:39]
    ds_read_b64_tr_b16 a[164:165], v3 offset:10240
    ds_read_b64_tr_b16 a[166:167], v3 offset:10752
    v_mfma_f32_32x32x16_bf16 v[40:55], v[12:15], a[108:111], v[40:55]
    ds_read_b64_tr_b16 v[8:9], v2 offset:12288
    ds_read_b64_tr_b16 v[10:11], v2 offset:12800
    s_waitcnt lgkmcnt(8)
    v_mfma_f32_32x32x16_bf16 v[24:39], v[16:19], a[112:115], v[24:39]
    s_add_u32 s51, s65, 1572992
    s_add_u32 m0, s60, 0
    s_nop 0
    buffer_load_dwordx4 v4, s[44:47], s51 offen offset:0 lds
    ds_read_b64_tr_b16 v[12:13], v3 offset:12288
    ds_read_b64_tr_b16 v[14:15], v3 offset:12800
    s_waitcnt lgkmcnt(8)
    v_mfma_f32_32x32x16_bf16 v[40:55], v[20:23], a[112:115], v[40:55]
    ds_read_b64_tr_b16 v[16:17], v2 offset:14336
    ds_read_b64_tr_b16 v[18:19], v2 offset:14848
    s_waitcnt lgkmcnt(8)
    v_mfma_f32_32x32x16_bf16 v[24:39], a[160:163], a[116:119], v[24:39]
    s_add_u32 s51, s65, 1670272
    buffer_load_dwordx4 v4, s[44:47], s51 offen offset:1024 lds
    ds_read_b64_tr_b16 v[20:21], v3 offset:14336
    ds_read_b64_tr_b16 v[22:23], v3 offset:14848
    s_waitcnt lgkmcnt(8)
    v_mfma_f32_32x32x16_bf16 v[40:55], a[164:167], a[116:119], v[40:55]
    s_waitcnt lgkmcnt(6)
    v_mfma_f32_32x32x16_bf16 v[24:39], v[8:11], a[120:123], v[24:39]
    s_waitcnt lgkmcnt(0)
    s_waitcnt vmcnt(12)
    s_barrier
    ds_read_b64_tr_b16 a[160:161], v2 offset:16384
    ds_read_b64_tr_b16 a[162:163], v2 offset:16896
    ds_read_b64_tr_b16 a[164:165], v3 offset:16384
    ds_read_b64_tr_b16 a[166:167], v3 offset:16896
    v_mfma_f32_32x32x16_bf16 v[40:55], v[12:15], a[120:123], v[40:55]
    ds_read_b64_tr_b16 v[8:9], v2 offset:18432
    ds_read_b64_tr_b16 v[10:11], v2 offset:18944
    v_mfma_f32_32x32x16_bf16 v[24:39], v[16:19], a[124:127], v[24:39]
    ds_read_b64_tr_b16 v[12:13], v3 offset:18432
    ds_read_b64_tr_b16 v[14:15], v3 offset:18944
    v_mfma_f32_32x32x16_bf16 v[40:55], v[20:23], a[124:127], v[40:55]
    ds_read_b64_tr_b16 v[16:17], v2 offset:20480
    ds_read_b64_tr_b16 v[18:19], v2 offset:20992
    s_waitcnt lgkmcnt(8)
    v_mfma_f32_32x32x16_bf16 v[24:39], a[160:163], a[128:131], v[24:39]
    s_add_u32 s51, s65, 2359424
    s_add_u32 m0, s60, 8192
    s_nop 0
    buffer_load_dwordx4 v4, s[44:47], s51 offen offset:0 lds
    ds_read_b64_tr_b16 v[20:21], v3 offset:20480
    ds_read_b64_tr_b16 v[22:23], v3 offset:20992
    s_waitcnt lgkmcnt(8)
    v_mfma_f32_32x32x16_bf16 v[40:55], a[164:167], a[128:131], v[40:55]
    ds_read_b64_tr_b16 a[160:161], v2 offset:22528
    ds_read_b64_tr_b16 a[162:163], v2 offset:23040
    s_waitcnt lgkmcnt(8)
    v_mfma_f32_32x32x16_bf16 v[24:39], v[8:11], a[132:135], v[24:39]
    s_add_u32 s51, s65, 2456704
    buffer_load_dwordx4 v4, s[44:47], s51 offen offset:1024 lds
    ds_read_b64_tr_b16 a[164:165], v3 offset:22528
    ds_read_b64_tr_b16 a[166:167], v3 offset:23040
    s_waitcnt lgkmcnt(8)
    v_mfma_f32_32x32x16_bf16 v[40:55], v[12:15], a[132:135], v[40:55]
    s_waitcnt lgkmcnt(6)
    v_mfma_f32_32x32x16_bf16 v[24:39], v[16:19], a[136:139], v[24:39]
    s_waitcnt lgkmcnt(0)
    s_waitcnt vmcnt(8)
    s_barrier
    ds_read_b64_tr_b16 v[8:9], v2 offset:24576
    ds_read_b64_tr_b16 v[10:11], v2 offset:25088
    ds_read_b64_tr_b16 v[12:13], v3 offset:24576
    ds_read_b64_tr_b16 v[14:15], v3 offset:25088
    v_mfma_f32_32x32x16_bf16 v[40:55], v[20:23], a[136:139], v[40:55]
    ds_read_b64_tr_b16 v[16:17], v2 offset:26624
    ds_read_b64_tr_b16 v[18:19], v2 offset:27136
    v_mfma_f32_32x32x16_bf16 v[24:39], a[160:163], a[140:143], v[24:39]
    ds_read_b64_tr_b16 v[20:21], v3 offset:26624
    ds_read_b64_tr_b16 v[22:23], v3 offset:27136
    v_mfma_f32_32x32x16_bf16 v[40:55], a[164:167], a[140:143], v[40:55]
    ds_read_b64_tr_b16 a[160:161], v2 offset:28672
    ds_read_b64_tr_b16 a[162:163], v2 offset:29184
    s_waitcnt lgkmcnt(8)
    v_mfma_f32_32x32x16_bf16 v[24:39], v[8:11], a[144:147], v[24:39]
    s_add_u32 s51, s65, 3145856
    s_add_u32 m0, s60, 16384
    s_nop 0
    buffer_load_dwordx4 v4, s[44:47], s51 offen offset:0 lds
    ds_read_b64_tr_b16 a[164:165], v3 offset:28672
    ds_read_b64_tr_b16 a[166:167], v3 offset:29184
    s_waitcnt lgkmcnt(8)
    v_mfma_f32_32x32x16_bf16 v[40:55], v[12:15], a[144:147], v[40:55]
    ds_read_b64_tr_b16 v[8:9], v2 offset:30720
    ds_read_b64_tr_b16 v[10:11], v2 offset:31232
    s_waitcnt lgkmcnt(8)
    v_mfma_f32_32x32x16_bf16 v[24:39], v[16:19], a[148:151], v[24:39]
    s_add_u32 s51, s65, 3243136
    buffer_load_dwordx4 v4, s[44:47], s51 offen offset:1024 lds
    ds_read_b64_tr_b16 v[12:13], v3 offset:30720
    ds_read_b64_tr_b16 v[14:15], v3 offset:31232
    s_waitcnt lgkmcnt(8)
    v_mfma_f32_32x32x16_bf16 v[40:55], v[20:23], a[148:151], v[40:55]
    s_waitcnt lgkmcnt(6)
    v_mfma_f32_32x32x16_bf16 v[24:39], a[160:163], a[152:155], v[24:39]
    s_waitcnt lgkmcnt(0)
    s_waitcnt vmcnt(8)
    s_barrier
    ds_read_b64_tr_b16 v[16:17], v2 offset:32768
    ds_read_b64_tr_b16 v[18:19], v2 offset:33280
    ds_read_b64_tr_b16 v[20:21], v3 offset:32768
    ds_read_b64_tr_b16 v[22:23], v3 offset:33280
    v_mfma_f32_32x32x16_bf16 v[40:55], a[164:167], a[152:155], v[40:55]
    ds_read_b64_tr_b16 a[160:161], v2 offset:34816
    ds_read_b64_tr_b16 a[162:163], v2 offset:35328
    v_mfma_f32_32x32x16_bf16 v[24:39], v[8:11], a[156:159], v[24:39]
    ds_read_b64_tr_b16 a[164:165], v3 offset:34816
    ds_read_b64_tr_b16 a[166:167], v3 offset:35328
    v_mfma_f32_32x32x16_bf16 v[40:55], v[12:15], a[156:159], v[40:55]
    ds_read_b64_tr_b16 v[8:9], v2 offset:36864
    ds_read_b64_tr_b16 v[10:11], v2 offset:37376
    s_waitcnt lgkmcnt(8)
    v_mfma_f32_32x32x16_bf16 v[56:71], v[16:19], a[0:3], 0
    s_nop 4
    v_mul_f32 v24, s53, v24
    v_mul_f32 v25, s53, v25
    v_mul_f32 v26, s53, v26
    v_mul_f32 v27, s53, v27
    v_mul_f32 v28, s53, v28
    v_mul_f32 v29, s53, v29
    v_mul_f32 v30, s53, v30
    v_mul_f32 v31, s53, v31
    v_cvt_pk_bf16_f32 v24, v24, v25
    v_cvt_pk_bf16_f32 v25, v26, v27
    v_cvt_pk_bf16_f32 v26, v28, v29
    ds_read_b64_tr_b16 v[12:13], v3 offset:36864
    ds_read_b64_tr_b16 v[14:15], v3 offset:37376
    s_waitcnt lgkmcnt(8)
    v_mfma_f32_32x32x16_bf16 v[72:87], v[20:23], a[0:3], 0
    v_cvt_pk_bf16_f32 v27, v30, v31
    ds_write_b128 v5, v[24:27] offset:0
    v_mul_f32 v32, s53, v32
    v_mul_f32 v33, s53, v33
    v_mul_f32 v34, s53, v34
    v_mul_f32 v35, s53, v35
    v_mul_f32 v36, s53, v36
    v_mul_f32 v37, s53, v37
    v_mul_f32 v38, s53, v38
    v_mul_f32 v39, s53, v39
    v_cvt_pk_bf16_f32 v32, v32, v33
    ds_read_b64_tr_b16 v[16:17], v2 offset:38912
    ds_read_b64_tr_b16 v[18:19], v2 offset:39424
    s_waitcnt lgkmcnt(9)
    v_mfma_f32_32x32x16_bf16 v[56:71], a[160:163], a[4:7], v[56:71]
    v_cvt_pk_bf16_f32 v33, v34, v35
    v_cvt_pk_bf16_f32 v34, v36, v37
    v_cvt_pk_bf16_f32 v35, v38, v39
    ds_write_b128 v5, v[32:35] offset:1024
    s_add_u32 s51, s65, 3932288
    s_add_u32 m0, s60, 24576
    s_nop 0
    buffer_load_dwordx4 v4, s[44:47], s51 offen offset:0 lds
    v_mul_f32 v40, s53, v40
    v_mul_f32 v41, s53, v41
    v_mul_f32 v42, s53, v42
    v_mul_f32 v43, s53, v43
    v_mul_f32 v44, s53, v44
    v_mul_f32 v45, s53, v45
    ds_read_b64_tr_b16 v[20:21], v3 offset:38912
    ds_read_b64_tr_b16 v[22:23], v3 offset:39424
    s_waitcnt lgkmcnt(10)
    v_mfma_f32_32x32x16_bf16 v[72:87], a[164:167], a[4:7], v[72:87]
    v_mul_f32 v46, s53, v46
    v_mul_f32 v47, s53, v47
    v_cvt_pk_bf16_f32 v40, v40, v41
    v_cvt_pk_bf16_f32 v41, v42, v43
    v_cvt_pk_bf16_f32 v42, v44, v45
    v_cvt_pk_bf16_f32 v43, v46, v47
    ds_write_b128 v5, v[40:43] offset:2048
    v_mul_f32 v48, s53, v48
    v_mul_f32 v49, s53, v49
    v_mul_f32 v50, s53, v50
    v_mul_f32 v51, s53, v51
    s_waitcnt lgkmcnt(9)
    v_mfma_f32_32x32x16_bf16 v[56:71], v[8:11], a[8:11], v[56:71]
    v_mul_f32 v52, s53, v52
    v_mul_f32 v53, s53, v53
    v_mul_f32 v54, s53, v54
    v_mul_f32 v55, s53, v55
    v_cvt_pk_bf16_f32 v48, v48, v49
    v_cvt_pk_bf16_f32 v49, v50, v51
    v_cvt_pk_bf16_f32 v50, v52, v53
    v_cvt_pk_bf16_f32 v51, v54, v55
    ds_write_b128 v5, v[48:51] offset:3072
    s_add_u32 s51, s65, 4029568
    buffer_load_dwordx4 v4, s[44:47], s51 offen offset:1024 lds
    s_waitcnt lgkmcnt(0)
    s_waitcnt vmcnt(8)
    s_barrier
    ds_read_b64_tr_b16 a[160:161], v2 offset:40960
    ds_read_b64_tr_b16 a[162:163], v2 offset:41472
    ds_read_b64_tr_b16 a[164:165], v3 offset:40960
    ds_read_b64_tr_b16 a[166:167], v3 offset:41472
    v_mfma_f32_32x32x16_bf16 v[72:87], v[12:15], a[8:11], v[72:87]
    ds_read_b64_tr_b16 v[8:9], v2 offset:43008
    ds_read_b64_tr_b16 v[10:11], v2 offset:43520
    v_mfma_f32_32x32x16_bf16 v[56:71], v[16:19], a[12:15], v[56:71]
    ds_read_b64_tr_b16 v[12:13], v3 offset:43008
    ds_read_b64_tr_b16 v[14:15], v3 offset:43520
    v_mfma_f32_32x32x16_bf16 v[72:87], v[20:23], a[12:15], v[72:87]
    ds_read_b64_tr_b16 v[16:17], v2 offset:45056
    ds_read_b64_tr_b16 v[18:19], v2 offset:45568
    s_waitcnt lgkmcnt(8)
    v_mfma_f32_32x32x16_bf16 v[56:71], a[160:163], a[16:19], v[56:71]
    s_add_u32 s51, s65, 4718720
    s_add_u32 m0, s60, 32768
    s_nop 0
    buffer_load_dwordx4 v4, s[44:47], s51 offen offset:0 lds
    ds_read_b64_tr_b16 v[20:21], v3 offset:45056
    ds_read_b64_tr_b16 v[22:23], v3 offset:45568
    s_waitcnt lgkmcnt(8)
    v_mfma_f32_32x32x16_bf16 v[72:87], a[164:167], a[16:19], v[72:87]
    ds_read_b64_tr_b16 a[160:161], v2 offset:47104
    ds_read_b64_tr_b16 a[162:163], v2 offset:47616
    s_waitcnt lgkmcnt(8)
    v_mfma_f32_32x32x16_bf16 v[56:71], v[8:11], a[20:23], v[56:71]
    s_add_u32 s51, s65, 4816000
    buffer_load_dwordx4 v4, s[44:47], s51 offen offset:1024 lds
    ds_read_b64_tr_b16 a[164:165], v3 offset:47104
    ds_read_b64_tr_b16 a[166:167], v3 offset:47616
    s_waitcnt lgkmcnt(8)
    v_mfma_f32_32x32x16_bf16 v[72:87], v[12:15], a[20:23], v[72:87]
    s_waitcnt lgkmcnt(6)
    v_mfma_f32_32x32x16_bf16 v[56:71], v[16:19], a[24:27], v[56:71]
    s_waitcnt lgkmcnt(0)
    s_waitcnt vmcnt(8)
    s_barrier
    ds_read_b64_tr_b16 v[8:9], v2 offset:0
    ds_read_b64_tr_b16 v[10:11], v2 offset:512
    ds_read_b64_tr_b16 v[12:13], v3 offset:0
    ds_read_b64_tr_b16 v[14:15], v3 offset:512
    v_mfma_f32_32x32x16_bf16 v[72:87], v[20:23], a[24:27], v[72:87]
    ds_read_b64_tr_b16 v[16:17], v2 offset:2048
    ds_read_b64_tr_b16 v[18:19], v2 offset:2560
    v_mfma_f32_32x32x16_bf16 v[56:71], a[160:163], a[28:31], v[56:71]
    ds_read_b64_tr_b16 v[20:21], v3 offset:2048
    ds_read_b64_tr_b16 v[22:23], v3 offset:2560
    v_mfma_f32_32x32x16_bf16 v[72:87], a[164:167], a[28:31], v[72:87]
    ds_read_b64_tr_b16 a[160:161], v2 offset:4096
    ds_read_b64_tr_b16 a[162:163], v2 offset:4608
    s_waitcnt lgkmcnt(8)
    v_mfma_f32_32x32x16_bf16 v[56:71], v[8:11], a[32:35], v[56:71]
    s_add_u32 s51, s65, 5505152
    s_add_u32 m0, s60, 40960
    s_nop 0
    buffer_load_dwordx4 v4, s[44:47], s51 offen offset:0 lds
    ds_read_b64_tr_b16 a[164:165], v3 offset:4096
    ds_read_b64_tr_b16 a[166:167], v3 offset:4608
    s_waitcnt lgkmcnt(8)
    v_mfma_f32_32x32x16_bf16 v[72:87], v[12:15], a[32:35], v[72:87]
    ds_read_b64_tr_b16 v[8:9], v2 offset:6144
    ds_read_b64_tr_b16 v[10:11], v2 offset:6656
    s_waitcnt lgkmcnt(8)
    v_mfma_f32_32x32x16_bf16 v[56:71], v[16:19], a[36:39], v[56:71]
    s_add_u32 s51, s65, 5602432
    buffer_load_dwordx4 v4, s[44:47], s51 offen offset:1024 lds
    ds_read_b64_tr_b16 v[12:13], v3 offset:6144
    ds_read_b64_tr_b16 v[14:15], v3 offset:6656
    s_waitcnt lgkmcnt(8)
    v_mfma_f32_32x32x16_bf16 v[72:87], v[20:23], a[36:39], v[72:87]
    s_waitcnt lgkmcnt(6)
    v_mfma_f32_32x32x16_bf16 v[56:71], a[160:163], a[40:43], v[56:71]
    s_waitcnt lgkmcnt(0)
    s_waitcnt vmcnt(8)
    s_barrier
    ds_read_b64_tr_b16 v[16:17], v2 offset:8192
    ds_read_b64_tr_b16 v[18:19], v2 offset:8704
    ds_read_b64_tr_b16 v[20:21], v3 offset:8192
    ds_read_b64_tr_b16 v[22:23], v3 offset:8704
    v_mfma_f32_32x32x16_bf16 v[72:87], a[164:167], a[40:43], v[72:87]
    ds_read_b64_tr_b16 a[160:161], v2 offset:10240
    ds_read_b64_tr_b16 a[162:163], v2 offset:10752
    v_mfma_f32_32x32x16_bf16 v[56:71], v[8:11], a[44:47], v[56:71]
    ds_read_b64_tr_b16 a[164:165], v3 offset:10240
    ds_read_b64_tr_b16 a[166:167], v3 offset:10752
    v_mfma_f32_32x32x16_bf16 v[72:87], v[12:15], a[44:47], v[72:87]
    ds_read_b64_tr_b16 v[8:9], v2 offset:12288
    ds_read_b64_tr_b16 v[10:11], v2 offset:12800
    s_waitcnt lgkmcnt(8)
    v_mfma_f32_32x32x16_bf16 v[56:71], v[16:19], a[48:51], v[56:71]
    s_add_u32 s51, s65, 6291584
    s_add_u32 m0, s60, 0
    s_nop 0
    buffer_load_dwordx4 v4, s[44:47], s51 offen offset:0 lds
    ds_read_b64_tr_b16 v[12:13], v3 offset:12288
    ds_read_b64_tr_b16 v[14:15], v3 offset:12800
    s_waitcnt lgkmcnt(8)
    v_mfma_f32_32x32x16_bf16 v[72:87], v[20:23], a[48:51], v[72:87]
    ds_read_b64_tr_b16 v[16:17], v2 offset:14336
    ds_read_b64_tr_b16 v[18:19], v2 offset:14848
    s_waitcnt lgkmcnt(8)
    v_mfma_f32_32x32x16_bf16 v[56:71], a[160:163], a[52:55], v[56:71]
    s_add_u32 s51, s65, 6388864
    buffer_load_dwordx4 v4, s[44:47], s51 offen offset:1024 lds
    ds_read_b64_tr_b16 v[20:21], v3 offset:14336
    ds_read_b64_tr_b16 v[22:23], v3 offset:14848
    s_waitcnt lgkmcnt(8)
    v_mfma_f32_32x32x16_bf16 v[72:87], a[164:167], a[52:55], v[72:87]
    s_waitcnt lgkmcnt(6)
    v_mfma_f32_32x32x16_bf16 v[56:71], v[8:11], a[56:59], v[56:71]
    s_waitcnt lgkmcnt(0)
    s_waitcnt vmcnt(8)
    s_barrier
    ds_read_b64_tr_b16 a[160:161], v2 offset:16384
    ds_read_b64_tr_b16 a[162:163], v2 offset:16896
    ds_read_b64_tr_b16 a[164:165], v3 offset:16384
    ds_read_b64_tr_b16 a[166:167], v3 offset:16896
    v_mfma_f32_32x32x16_bf16 v[72:87], v[12:15], a[56:59], v[72:87]
    ds_read_b64_tr_b16 v[8:9], v2 offset:18432
    ds_read_b64_tr_b16 v[10:11], v2 offset:18944
    v_mfma_f32_32x32x16_bf16 v[56:71], v[16:19], a[60:63], v[56:71]
    ds_read_b64_tr_b16 v[12:13], v3 offset:18432
    ds_read_b64_tr_b16 v[14:15], v3 offset:18944
    v_mfma_f32_32x32x16_bf16 v[72:87], v[20:23], a[60:63], v[72:87]
    ds_read_b64_tr_b16 v[16:17], v2 offset:20480
    ds_read_b64_tr_b16 v[18:19], v2 offset:20992
    s_waitcnt lgkmcnt(8)
    v_mfma_f32_32x32x16_bf16 v[56:71], a[160:163], a[64:67], v[56:71]
    s_add_u32 s51, s65, 7078016
    s_add_u32 m0, s60, 8192
    s_nop 0
    buffer_load_dwordx4 v4, s[44:47], s51 offen offset:0 lds
    ds_read_b64_tr_b16 v[20:21], v3 offset:20480
    ds_read_b64_tr_b16 v[22:23], v3 offset:20992
    s_waitcnt lgkmcnt(8)
    v_mfma_f32_32x32x16_bf16 v[72:87], a[164:167], a[64:67], v[72:87]
    ds_read_b64_tr_b16 a[160:161], v2 offset:22528
    ds_read_b64_tr_b16 a[162:163], v2 offset:23040
    s_waitcnt lgkmcnt(8)
    v_mfma_f32_32x32x16_bf16 v[56:71], v[8:11], a[68:71], v[56:71]
    s_add_u32 s51, s65, 7175296
    buffer_load_dwordx4 v4, s[44:47], s51 offen offset:1024 lds
    ds_read_b64_tr_b16 a[164:165], v3 offset:22528
    ds_read_b64_tr_b16 a[166:167], v3 offset:23040
    s_waitcnt lgkmcnt(8)
    v_mfma_f32_32x32x16_bf16 v[72:87], v[12:15], a[68:71], v[72:87]
    s_waitcnt lgkmcnt(6)
    v_mfma_f32_32x32x16_bf16 v[56:71], v[16:19], a[72:75], v[56:71]
    s_waitcnt lgkmcnt(0)
    s_waitcnt vmcnt(8)
    s_barrier
    ds_read_b64_tr_b16 v[8:9], v2 offset:24576
    ds_read_b64_tr_b16 v[10:11], v2 offset:25088
    ds_read_b64_tr_b16 v[12:13], v3 offset:24576
    ds_read_b64_tr_b16 v[14:15], v3 offset:25088
    v_mfma_f32_32x32x16_bf16 v[72:87], v[20:23], a[72:75], v[72:87]
    ds_read_b64_tr_b16 v[16:17], v2 offset:26624
    ds_read_b64_tr_b16 v[18:19], v2 offset:27136
    v_mfma_f32_32x32x16_bf16 v[56:71], a[160:163], a[76:79], v[56:71]
    ds_read_b64_tr_b16 v[20:21], v3 offset:26624
    ds_read_b64_tr_b16 v[22:23], v3 offset:27136
    v_mfma_f32_32x32x16_bf16 v[72:87], a[164:167], a[76:79], v[72:87]
    ds_read_b64_tr_b16 a[160:161], v2 offset:28672
    ds_read_b64_tr_b16 a[162:163], v2 offset:29184
    s_waitcnt lgkmcnt(8)
    v_mfma_f32_32x32x16_bf16 v[56:71], v[8:11], a[80:83], v[56:71]
    s_add_u32 s51, s65, 256
    s_add_u32 m0, s60, 16384
    s_nop 0
    buffer_load_dwordx4 v4, s[44:47], s51 offen offset:0 lds
    ds_read_b64_tr_b16 a[164:165], v3 offset:28672
    ds_read_b64_tr_b16 a[166:167], v3 offset:29184
    s_waitcnt lgkmcnt(8)
    v_mfma_f32_32x32x16_bf16 v[72:87], v[12:15], a[80:83], v[72:87]
    ds_read_b64_tr_b16 v[8:9], v2 offset:30720
    ds_read_b64_tr_b16 v[10:11], v2 offset:31232
    s_waitcnt lgkmcnt(8)
    v_mfma_f32_32x32x16_bf16 v[56:71], v[16:19], a[84:87], v[56:71]
    s_add_u32 s51, s65, 97536
    buffer_load_dwordx4 v4, s[44:47], s51 offen offset:1024 lds
    ds_read_b64_tr_b16 v[12:13], v3 offset:30720
    ds_read_b64_tr_b16 v[14:15], v3 offset:31232
    s_waitcnt lgkmcnt(8)
    v_mfma_f32_32x32x16_bf16 v[72:87], v[20:23], a[84:87], v[72:87]
    s_waitcnt lgkmcnt(6)
    v_mfma_f32_32x32x16_bf16 v[56:71], a[160:163], a[88:91], v[56:71]
    s_waitcnt lgkmcnt(0)
    s_waitcnt vmcnt(8)
    s_barrier
    ds_read_b64_tr_b16 v[16:17], v2 offset:32768
    ds_read_b64_tr_b16 v[18:19], v2 offset:33280
    ds_read_b64_tr_b16 v[20:21], v3 offset:32768
    ds_read_b64_tr_b16 v[22:23], v3 offset:33280
    v_mfma_f32_32x32x16_bf16 v[72:87], a[164:167], a[88:91], v[72:87]
    ds_read_b64_tr_b16 a[160:161], v2 offset:34816
    ds_read_b64_tr_b16 a[162:163], v2 offset:35328
    v_mfma_f32_32x32x16_bf16 v[56:71], v[8:11], a[92:95], v[56:71]
    ds_read_b64_tr_b16 a[164:165], v3 offset:34816
    ds_read_b64_tr_b16 a[166:167], v3 offset:35328
    v_mfma_f32_32x32x16_bf16 v[72:87], v[12:15], a[92:95], v[72:87]
    ds_read_b64_tr_b16 v[8:9], v2 offset:36864
    ds_read_b64_tr_b16 v[10:11], v2 offset:37376
    s_waitcnt lgkmcnt(8)
    v_mfma_f32_32x32x16_bf16 v[56:71], v[16:19], a[96:99], v[56:71]
    s_add_u32 s51, s65, 786688
    s_add_u32 m0, s60, 24576
    s_nop 0
    buffer_load_dwordx4 v4, s[44:47], s51 offen offset:0 lds
    ds_read_b64_tr_b16 v[12:13], v3 offset:36864
    ds_read_b64_tr_b16 v[14:15], v3 offset:37376
    s_waitcnt lgkmcnt(8)
    v_mfma_f32_32x32x16_bf16 v[72:87], v[20:23], a[96:99], v[72:87]
    ds_read_b64_tr_b16 v[16:17], v2 offset:38912
    ds_read_b64_tr_b16 v[18:19], v2 offset:39424
    s_waitcnt lgkmcnt(8)
    v_mfma_f32_32x32x16_bf16 v[56:71], a[160:163], a[100:103], v[56:71]
    s_add_u32 s51, s65, 883968
    buffer_load_dwordx4 v4, s[44:47], s51 offen offset:1024 lds
    ds_read_b64_tr_b16 v[20:21], v3 offset:38912
    ds_read_b64_tr_b16 v[22:23], v3 offset:39424
    s_waitcnt lgkmcnt(8)
    v_mfma_f32_32x32x16_bf16 v[72:87], a[164:167], a[100:103], v[72:87]
    s_waitcnt lgkmcnt(6)
    v_mfma_f32_32x32x16_bf16 v[56:71], v[8:11], a[104:107], v[56:71]
    s_waitcnt lgkmcnt(0)
    s_waitcnt vmcnt(8)
    s_barrier
    ds_read_b64_tr_b16 a[160:161], v2 offset:40960
    ds_read_b64_tr_b16 a[162:163], v2 offset:41472
    ds_read_b64_tr_b16 a[164:165], v3 offset:40960
    ds_read_b64_tr_b16 a[166:167], v3 offset:41472
    v_mfma_f32_32x32x16_bf16 v[72:87], v[12:15], a[104:107], v[72:87]
    ds_read_b64_tr_b16 v[8:9], v2 offset:43008
    ds_read_b64_tr_b16 v[10:11], v2 offset:43520
    v_mfma_f32_32x32x16_bf16 v[56:71], v[16:19], a[108:111], v[56:71]
    ds_read_b64_tr_b16 v[12:13], v3 offset:43008
    ds_read_b64_tr_b16 v[14:15], v3 offset:43520
    v_mfma_f32_32x32x16_bf16 v[72:87], v[20:23], a[108:111], v[72:87]
    ds_read_b64_tr_b16 v[16:17], v2 offset:45056
    ds_read_b64_tr_b16 v[18:19], v2 offset:45568
    s_waitcnt lgkmcnt(8)
    v_mfma_f32_32x32x16_bf16 v[56:71], a[160:163], a[112:115], v[56:71]
    s_add_u32 s51, s65, 1573120
    s_add_u32 m0, s60, 32768
    s_nop 0
    buffer_load_dwordx4 v4, s[44:47], s51 offen offset:0 lds
    ds_read_b64_tr_b16 v[20:21], v3 offset:45056
    ds_read_b64_tr_b16 v[22:23], v3 offset:45568
    s_waitcnt lgkmcnt(8)
    v_mfma_f32_32x32x16_bf16 v[72:87], a[164:167], a[112:115], v[72:87]
    ds_read_b64_tr_b16 a[160:161], v2 offset:47104
    ds_read_b64_tr_b16 a[162:163], v2 offset:47616
    s_waitcnt lgkmcnt(8)
    v_mfma_f32_32x32x16_bf16 v[56:71], v[8:11], a[116:119], v[56:71]
    s_add_u32 s51, s65, 1670400
    buffer_load_dwordx4 v4, s[44:47], s51 offen offset:1024 lds
    ds_read_b64_tr_b16 a[164:165], v3 offset:47104
    ds_read_b64_tr_b16 a[166:167], v3 offset:47616
    s_waitcnt lgkmcnt(8)
    v_mfma_f32_32x32x16_bf16 v[72:87], v[12:15], a[116:119], v[72:87]
    s_waitcnt lgkmcnt(6)
    v_mfma_f32_32x32x16_bf16 v[56:71], v[16:19], a[120:123], v[56:71]
    s_waitcnt lgkmcnt(0)
    s_waitcnt vmcnt(8)
    s_barrier
    ds_read_b64_tr_b16 v[8:9], v2 offset:0
    ds_read_b64_tr_b16 v[10:11], v2 offset:512
    ds_read_b64_tr_b16 v[12:13], v3 offset:0
    ds_read_b64_tr_b16 v[14:15], v3 offset:512
    v_mfma_f32_32x32x16_bf16 v[72:87], v[20:23], a[120:123], v[72:87]
    ds_read_b64_tr_b16 v[16:17], v2 offset:2048
    ds_read_b64_tr_b16 v[18:19], v2 offset:2560
    v_mfma_f32_32x32x16_bf16 v[56:71], a[160:163], a[124:127], v[56:71]
    ds_read_b64_tr_b16 v[20:21], v3 offset:2048
    ds_read_b64_tr_b16 v[22:23], v3 offset:2560
    v_mfma_f32_32x32x16_bf16 v[72:87], a[164:167], a[124:127], v[72:87]
    ds_read_b64_tr_b16 a[160:161], v2 offset:4096
    ds_read_b64_tr_b16 a[162:163], v2 offset:4608
    s_waitcnt lgkmcnt(8)
    v_mfma_f32_32x32x16_bf16 v[56:71], v[8:11], a[128:131], v[56:71]
    s_add_u32 s51, s65, 2359552
    s_add_u32 m0, s60, 40960
    s_nop 0
    buffer_load_dwordx4 v4, s[44:47], s51 offen offset:0 lds
    ds_read_b64_tr_b16 a[164:165], v3 offset:4096
    ds_read_b64_tr_b16 a[166:167], v3 offset:4608
    s_waitcnt lgkmcnt(8)
    v_mfma_f32_32x32x16_bf16 v[72:87], v[12:15], a[128:131], v[72:87]
    ds_read_b64_tr_b16 v[8:9], v2 offset:6144
    ds_read_b64_tr_b16 v[10:11], v2 offset:6656
    s_waitcnt lgkmcnt(8)
    v_mfma_f32_32x32x16_bf16 v[56:71], v[16:19], a[132:135], v[56:71]
    s_add_u32 s51, s65, 2456832
    buffer_load_dwordx4 v4, s[44:47], s51 offen offset:1024 lds
    ds_read_b64_tr_b16 v[12:13], v3 offset:6144
    ds_read_b64_tr_b16 v[14:15], v3 offset:6656
    s_waitcnt lgkmcnt(8)
    v_mfma_f32_32x32x16_bf16 v[72:87], v[20:23], a[132:135], v[72:87]
    s_waitcnt lgkmcnt(6)
    v_mfma_f32_32x32x16_bf16 v[56:71], a[160:163], a[136:139], v[56:71]
    s_waitcnt lgkmcnt(0)
    s_waitcnt vmcnt(8)
    s_barrier
    ds_read_b64_tr_b16 v[16:17], v2 offset:8192
    ds_read_b64_tr_b16 v[18:19], v2 offset:8704
    ds_read_b64_tr_b16 v[20:21], v3 offset:8192
    ds_read_b64_tr_b16 v[22:23], v3 offset:8704
    v_mfma_f32_32x32x16_bf16 v[72:87], a[164:167], a[136:139], v[72:87]
    ds_read_b64_tr_b16 a[160:161], v2 offset:10240
    ds_read_b64_tr_b16 a[162:163], v2 offset:10752
    v_mfma_f32_32x32x16_bf16 v[56:71], v[8:11], a[140:143], v[56:71]
    ds_read_b64_tr_b16 a[164:165], v3 offset:10240
    ds_read_b64_tr_b16 a[166:167], v3 offset:10752
    v_mfma_f32_32x32x16_bf16 v[72:87], v[12:15], a[140:143], v[72:87]
    ds_read_b64_tr_b16 v[8:9], v2 offset:12288
    ds_read_b64_tr_b16 v[10:11], v2 offset:12800
    s_waitcnt lgkmcnt(8)
    v_mfma_f32_32x32x16_bf16 v[56:71], v[16:19], a[144:147], v[56:71]
    s_add_u32 s51, s65, 3145984
    s_add_u32 m0, s60, 0
    s_nop 0
    buffer_load_dwordx4 v4, s[44:47], s51 offen offset:0 lds
    ds_read_b64_tr_b16 v[12:13], v3 offset:12288
    ds_read_b64_tr_b16 v[14:15], v3 offset:12800
    s_waitcnt lgkmcnt(8)
    v_mfma_f32_32x32x16_bf16 v[72:87], v[20:23], a[144:147], v[72:87]
    ds_read_b64_tr_b16 v[16:17], v2 offset:14336
    ds_read_b64_tr_b16 v[18:19], v2 offset:14848
    s_waitcnt lgkmcnt(8)
    v_mfma_f32_32x32x16_bf16 v[56:71], a[160:163], a[148:151], v[56:71]
    s_add_u32 s51, s65, 3243264
    buffer_load_dwordx4 v4, s[44:47], s51 offen offset:1024 lds
    ds_read_b64_tr_b16 v[20:21], v3 offset:14336
    ds_read_b64_tr_b16 v[22:23], v3 offset:14848
    s_waitcnt lgkmcnt(8)
    v_mfma_f32_32x32x16_bf16 v[72:87], a[164:167], a[148:151], v[72:87]
    s_waitcnt lgkmcnt(6)
    v_mfma_f32_32x32x16_bf16 v[56:71], v[8:11], a[152:155], v[56:71]
    s_waitcnt lgkmcnt(0)
    s_waitcnt vmcnt(8)
    s_barrier
    ds_read_b64_tr_b16 a[160:161], v2 offset:16384
    ds_read_b64_tr_b16 a[162:163], v2 offset:16896
    ds_read_b64_tr_b16 a[164:165], v3 offset:16384
    ds_read_b64_tr_b16 a[166:167], v3 offset:16896
    v_mfma_f32_32x32x16_bf16 v[72:87], v[12:15], a[152:155], v[72:87]
    ds_read_b64_tr_b16 v[8:9], v2 offset:18432
    ds_read_b64_tr_b16 v[10:11], v2 offset:18944
    v_mfma_f32_32x32x16_bf16 v[56:71], v[16:19], a[156:159], v[56:71]
    ds_read_b64_tr_b16 v[12:13], v3 offset:18432
    ds_read_b64_tr_b16 v[14:15], v3 offset:18944
    v_mfma_f32_32x32x16_bf16 v[72:87], v[20:23], a[156:159], v[72:87]
    ds_read_b64_tr_b16 v[16:17], v2 offset:20480
    ds_read_b64_tr_b16 v[18:19], v2 offset:20992
    s_waitcnt lgkmcnt(8)
    v_mfma_f32_32x32x16_bf16 v[24:39], a[160:163], a[0:3], 0
    s_nop 4
    v_mul_f32 v56, s53, v56
    v_mul_f32 v57, s53, v57
    v_mul_f32 v58, s53, v58
    v_mul_f32 v59, s53, v59
    v_mul_f32 v60, s53, v60
    v_mul_f32 v61, s53, v61
    v_mul_f32 v62, s53, v62
    v_mul_f32 v63, s53, v63
    v_cvt_pk_bf16_f32 v56, v56, v57
    v_cvt_pk_bf16_f32 v57, v58, v59
    v_cvt_pk_bf16_f32 v58, v60, v61
    ds_read_b64_tr_b16 v[20:21], v3 offset:20480
    ds_read_b64_tr_b16 v[22:23], v3 offset:20992
    s_waitcnt lgkmcnt(8)
    v_mfma_f32_32x32x16_bf16 v[40:55], a[164:167], a[0:3], 0
    v_cvt_pk_bf16_f32 v59, v62, v63
    ds_write_b128 v5, v[56:59] offset:4096
    v_mul_f32 v64, s53, v64
    v_mul_f32 v65, s53, v65
    v_mul_f32 v66, s53, v66
    v_mul_f32 v67, s53, v67
    v_mul_f32 v68, s53, v68
    v_mul_f32 v69, s53, v69
    v_mul_f32 v70, s53, v70
    v_mul_f32 v71, s53, v71
    v_cvt_pk_bf16_f32 v64, v64, v65
    ds_read_b64_tr_b16 a[160:161], v2 offset:22528
    ds_read_b64_tr_b16 a[162:163], v2 offset:23040
    s_waitcnt lgkmcnt(9)
    v_mfma_f32_32x32x16_bf16 v[24:39], v[8:11], a[4:7], v[24:39]
    v_cvt_pk_bf16_f32 v65, v66, v67
    v_cvt_pk_bf16_f32 v66, v68, v69
    v_cvt_pk_bf16_f32 v67, v70, v71
    ds_write_b128 v5, v[64:67] offset:5120
    s_add_u32 s51, s65, 3932416
    s_add_u32 m0, s60, 8192
    s_nop 0
    buffer_load_dwordx4 v4, s[44:47], s51 offen offset:0 lds
    v_mul_f32 v72, s53, v72
    v_mul_f32 v73, s53, v73
    v_mul_f32 v74, s53, v74
    v_mul_f32 v75, s53, v75
    v_mul_f32 v76, s53, v76
    v_mul_f32 v77, s53, v77
    ds_read_b64_tr_b16 a[164:165], v3 offset:22528
    ds_read_b64_tr_b16 a[166:167], v3 offset:23040
    s_waitcnt lgkmcnt(10)
    v_mfma_f32_32x32x16_bf16 v[40:55], v[12:15], a[4:7], v[40:55]
    v_mul_f32 v78, s53, v78
    v_mul_f32 v79, s53, v79
    v_cvt_pk_bf16_f32 v72, v72, v73
    v_cvt_pk_bf16_f32 v73, v74, v75
    v_cvt_pk_bf16_f32 v74, v76, v77
    v_cvt_pk_bf16_f32 v75, v78, v79
    ds_write_b128 v5, v[72:75] offset:6144
    v_mul_f32 v80, s53, v80
    v_mul_f32 v81, s53, v81
    v_mul_f32 v82, s53, v82
    v_mul_f32 v83, s53, v83
    s_waitcnt lgkmcnt(9)
    v_mfma_f32_32x32x16_bf16 v[24:39], v[16:19], a[8:11], v[24:39]
    v_mul_f32 v84, s53, v84
    v_mul_f32 v85, s53, v85
    v_mul_f32 v86, s53, v86
    v_mul_f32 v87, s53, v87
    v_cvt_pk_bf16_f32 v80, v80, v81
    v_cvt_pk_bf16_f32 v81, v82, v83
    v_cvt_pk_bf16_f32 v82, v84, v85
    v_cvt_pk_bf16_f32 v83, v86, v87
    ds_write_b128 v5, v[80:83] offset:7168
    s_add_u32 s51, s65, 4029696
    buffer_load_dwordx4 v4, s[44:47], s51 offen offset:1024 lds
    s_waitcnt lgkmcnt(0)
    s_waitcnt vmcnt(8)
    s_barrier
    ds_read_b64_tr_b16 v[8:9], v2 offset:24576
    ds_read_b64_tr_b16 v[10:11], v2 offset:25088
    ds_read_b64_tr_b16 v[12:13], v3 offset:24576
    ds_read_b64_tr_b16 v[14:15], v3 offset:25088
    v_mfma_f32_32x32x16_bf16 v[40:55], v[20:23], a[8:11], v[40:55]
    ds_read_b64_tr_b16 v[16:17], v2 offset:26624
    ds_read_b64_tr_b16 v[18:19], v2 offset:27136
    v_mfma_f32_32x32x16_bf16 v[24:39], a[160:163], a[12:15], v[24:39]
    ds_read_b64_tr_b16 v[20:21], v3 offset:26624
    ds_read_b64_tr_b16 v[22:23], v3 offset:27136
    v_mfma_f32_32x32x16_bf16 v[40:55], a[164:167], a[12:15], v[40:55]
    ds_read_b64_tr_b16 a[160:161], v2 offset:28672
    ds_read_b64_tr_b16 a[162:163], v2 offset:29184
    s_waitcnt lgkmcnt(8)
    v_mfma_f32_32x32x16_bf16 v[24:39], v[8:11], a[16:19], v[24:39]
    s_add_u32 s51, s65, 4718848
    s_add_u32 m0, s60, 16384
    s_nop 0
    buffer_load_dwordx4 v4, s[44:47], s51 offen offset:0 lds
    ds_read_b64_tr_b16 a[164:165], v3 offset:28672
    ds_read_b64_tr_b16 a[166:167], v3 offset:29184
    s_waitcnt lgkmcnt(8)
    v_mfma_f32_32x32x16_bf16 v[40:55], v[12:15], a[16:19], v[40:55]
    ds_read_b64_tr_b16 v[8:9], v2 offset:30720
    ds_read_b64_tr_b16 v[10:11], v2 offset:31232
    s_waitcnt lgkmcnt(8)
    v_mfma_f32_32x32x16_bf16 v[24:39], v[16:19], a[20:23], v[24:39]
    s_add_u32 s51, s65, 4816128
    buffer_load_dwordx4 v4, s[44:47], s51 offen offset:1024 lds
    ds_read_b64_tr_b16 v[12:13], v3 offset:30720
    ds_read_b64_tr_b16 v[14:15], v3 offset:31232
    s_waitcnt lgkmcnt(8)
    v_mfma_f32_32x32x16_bf16 v[40:55], v[20:23], a[20:23], v[40:55]
    s_waitcnt lgkmcnt(6)
    v_mfma_f32_32x32x16_bf16 v[24:39], a[160:163], a[24:27], v[24:39]
    s_waitcnt lgkmcnt(0)
    s_waitcnt vmcnt(8)
    s_barrier
    ds_read_b64_tr_b16 v[16:17], v2 offset:32768
    ds_read_b64_tr_b16 v[18:19], v2 offset:33280
    ds_read_b64_tr_b16 v[20:21], v3 offset:32768
    ds_read_b64_tr_b16 v[22:23], v3 offset:33280
    v_mfma_f32_32x32x16_bf16 v[40:55], a[164:167], a[24:27], v[40:55]
    ds_read_b64_tr_b16 a[160:161], v2 offset:34816
    ds_read_b64_tr_b16 a[162:163], v2 offset:35328
    v_mfma_f32_32x32x16_bf16 v[24:39], v[8:11], a[28:31], v[24:39]
    ds_read_b64_tr_b16 a[164:165], v3 offset:34816
    ds_read_b64_tr_b16 a[166:167], v3 offset:35328
    v_mfma_f32_32x32x16_bf16 v[40:55], v[12:15], a[28:31], v[40:55]
    ds_read_b64_tr_b16 v[8:9], v2 offset:36864
    ds_read_b64_tr_b16 v[10:11], v2 offset:37376
    s_waitcnt lgkmcnt(8)
    v_mfma_f32_32x32x16_bf16 v[24:39], v[16:19], a[32:35], v[24:39]
    s_add_u32 s51, s65, 5505280
    s_add_u32 m0, s60, 24576
    s_nop 0
    buffer_load_dwordx4 v4, s[44:47], s51 offen offset:0 lds
    ds_read_b64_tr_b16 v[12:13], v3 offset:36864
    ds_read_b64_tr_b16 v[14:15], v3 offset:37376
    s_waitcnt lgkmcnt(8)
    v_mfma_f32_32x32x16_bf16 v[40:55], v[20:23], a[32:35], v[40:55]
    ds_read_b64_tr_b16 v[16:17], v2 offset:38912
    ds_read_b64_tr_b16 v[18:19], v2 offset:39424
    s_waitcnt lgkmcnt(8)
    v_mfma_f32_32x32x16_bf16 v[24:39], a[160:163], a[36:39], v[24:39]
    s_add_u32 s51, s65, 5602560
    buffer_load_dwordx4 v4, s[44:47], s51 offen offset:1024 lds
    ds_read_b64_tr_b16 v[20:21], v3 offset:38912
    ds_read_b64_tr_b16 v[22:23], v3 offset:39424
    s_waitcnt lgkmcnt(8)
    v_mfma_f32_32x32x16_bf16 v[40:55], a[164:167], a[36:39], v[40:55]
    s_waitcnt lgkmcnt(6)
    v_mfma_f32_32x32x16_bf16 v[24:39], v[8:11], a[40:43], v[24:39]
    s_waitcnt lgkmcnt(0)
    s_waitcnt vmcnt(8)
    s_barrier
    ds_read_b64_tr_b16 a[160:161], v2 offset:40960
    ds_read_b64_tr_b16 a[162:163], v2 offset:41472
    ds_read_b64_tr_b16 a[164:165], v3 offset:40960
    ds_read_b64_tr_b16 a[166:167], v3 offset:41472
    v_mfma_f32_32x32x16_bf16 v[40:55], v[12:15], a[40:43], v[40:55]
    ds_read_b64_tr_b16 v[8:9], v2 offset:43008
    ds_read_b64_tr_b16 v[10:11], v2 offset:43520
    v_mfma_f32_32x32x16_bf16 v[24:39], v[16:19], a[44:47], v[24:39]
    ds_read_b64_tr_b16 v[12:13], v3 offset:43008
    ds_read_b64_tr_b16 v[14:15], v3 offset:43520
    v_mfma_f32_32x32x16_bf16 v[40:55], v[20:23], a[44:47], v[40:55]
    ds_read_b64_tr_b16 v[16:17], v2 offset:45056
    ds_read_b64_tr_b16 v[18:19], v2 offset:45568
    s_waitcnt lgkmcnt(8)
    v_mfma_f32_32x32x16_bf16 v[24:39], a[160:163], a[48:51], v[24:39]
    s_add_u32 s51, s65, 6291712
    s_add_u32 m0, s60, 32768
    s_nop 0
    buffer_load_dwordx4 v4, s[44:47], s51 offen offset:0 lds
    ds_read_b64_tr_b16 v[20:21], v3 offset:45056
    ds_read_b64_tr_b16 v[22:23], v3 offset:45568
    s_waitcnt lgkmcnt(8)
    v_mfma_f32_32x32x16_bf16 v[40:55], a[164:167], a[48:51], v[40:55]
    ds_read_b64_tr_b16 a[160:161], v2 offset:47104
    ds_read_b64_tr_b16 a[162:163], v2 offset:47616
    s_waitcnt lgkmcnt(8)
    v_mfma_f32_32x32x16_bf16 v[24:39], v[8:11], a[52:55], v[24:39]
    s_add_u32 s51, s65, 6388992
    buffer_load_dwordx4 v4, s[44:47], s51 offen offset:1024 lds
    ds_read_b64_tr_b16 a[164:165], v3 offset:47104
    ds_read_b64_tr_b16 a[166:167], v3 offset:47616
    s_waitcnt lgkmcnt(8)
    v_mfma_f32_32x32x16_bf16 v[40:55], v[12:15], a[52:55], v[40:55]
    s_waitcnt lgkmcnt(6)
    v_mfma_f32_32x32x16_bf16 v[24:39], v[16:19], a[56:59], v[24:39]
    s_waitcnt lgkmcnt(0)
    s_waitcnt vmcnt(8)
    s_barrier
    ds_read_b64_tr_b16 v[8:9], v2 offset:0
    ds_read_b64_tr_b16 v[10:11], v2 offset:512
    ds_read_b64_tr_b16 v[12:13], v3 offset:0
    ds_read_b64_tr_b16 v[14:15], v3 offset:512
    v_mfma_f32_32x32x16_bf16 v[40:55], v[20:23], a[56:59], v[40:55]
    ds_read_b64_tr_b16 v[16:17], v2 offset:2048
    ds_read_b64_tr_b16 v[18:19], v2 offset:2560
    v_mfma_f32_32x32x16_bf16 v[24:39], a[160:163], a[60:63], v[24:39]
    ds_read_b64_tr_b16 v[20:21], v3 offset:2048
    ds_read_b64_tr_b16 v[22:23], v3 offset:2560
    v_mfma_f32_32x32x16_bf16 v[40:55], a[164:167], a[60:63], v[40:55]
    ds_read_b64_tr_b16 a[160:161], v2 offset:4096
    ds_read_b64_tr_b16 a[162:163], v2 offset:4608
    s_waitcnt lgkmcnt(8)
    v_mfma_f32_32x32x16_bf16 v[24:39], v[8:11], a[64:67], v[24:39]
    s_add_u32 s51, s65, 7078144
    s_add_u32 m0, s60, 40960
    s_nop 0
    buffer_load_dwordx4 v4, s[44:47], s51 offen offset:0 lds
    ds_read_b64_tr_b16 a[164:165], v3 offset:4096
    ds_read_b64_tr_b16 a[166:167], v3 offset:4608
    s_waitcnt lgkmcnt(8)
    v_mfma_f32_32x32x16_bf16 v[40:55], v[12:15], a[64:67], v[40:55]
    ds_read_b64_tr_b16 v[8:9], v2 offset:6144
    ds_read_b64_tr_b16 v[10:11], v2 offset:6656
    s_waitcnt lgkmcnt(8)
    v_mfma_f32_32x32x16_bf16 v[24:39], v[16:19], a[68:71], v[24:39]
    s_add_u32 s51, s65, 7175424
    buffer_load_dwordx4 v4, s[44:47], s51 offen offset:1024 lds
    ds_read_b64_tr_b16 v[12:13], v3 offset:6144
    ds_read_b64_tr_b16 v[14:15], v3 offset:6656
    s_waitcnt lgkmcnt(8)
    v_mfma_f32_32x32x16_bf16 v[40:55], v[20:23], a[68:71], v[40:55]
    s_waitcnt lgkmcnt(6)
    v_mfma_f32_32x32x16_bf16 v[24:39], a[160:163], a[72:75], v[24:39]
    s_waitcnt lgkmcnt(0)
    s_waitcnt vmcnt(8)
    s_barrier
    ds_read_b64_tr_b16 v[16:17], v2 offset:8192
    ds_read_b64_tr_b16 v[18:19], v2 offset:8704
    ds_read_b64_tr_b16 v[20:21], v3 offset:8192
    ds_read_b64_tr_b16 v[22:23], v3 offset:8704
    v_mfma_f32_32x32x16_bf16 v[40:55], a[164:167], a[72:75], v[40:55]
    ds_read_b64_tr_b16 a[160:161], v2 offset:10240
    ds_read_b64_tr_b16 a[162:163], v2 offset:10752
    v_mfma_f32_32x32x16_bf16 v[24:39], v[8:11], a[76:79], v[24:39]
    ds_read_b64_tr_b16 a[164:165], v3 offset:10240
    ds_read_b64_tr_b16 a[166:167], v3 offset:10752
    v_mfma_f32_32x32x16_bf16 v[40:55], v[12:15], a[76:79], v[40:55]
    ds_read_b64_tr_b16 v[8:9], v2 offset:12288
    ds_read_b64_tr_b16 v[10:11], v2 offset:12800
    s_waitcnt lgkmcnt(8)
    v_mfma_f32_32x32x16_bf16 v[24:39], v[16:19], a[80:83], v[24:39]
    s_add_u32 s51, s69, 0
    s_add_u32 m0, s60, 0
    s_nop 0
    buffer_load_dwordx4 v4, s[44:47], s51 offen offset:0 lds
    ds_read_b64_tr_b16 v[12:13], v3 offset:12288
    ds_read_b64_tr_b16 v[14:15], v3 offset:12800
    s_waitcnt lgkmcnt(8)
    v_mfma_f32_32x32x16_bf16 v[40:55], v[20:23], a[80:83], v[40:55]
    ds_read_b64_tr_b16 v[16:17], v2 offset:14336
    ds_read_b64_tr_b16 v[18:19], v2 offset:14848
    s_waitcnt lgkmcnt(8)
    v_mfma_f32_32x32x16_bf16 v[24:39], a[160:163], a[84:87], v[24:39]
    s_add_u32 s51, s69, 97280
    buffer_load_dwordx4 v4, s[44:47], s51 offen offset:1024 lds
    ds_read_b64_tr_b16 v[20:21], v3 offset:14336
    ds_read_b64_tr_b16 v[22:23], v3 offset:14848
    s_waitcnt lgkmcnt(8)
    v_mfma_f32_32x32x16_bf16 v[40:55], a[164:167], a[84:87], v[40:55]
    s_waitcnt lgkmcnt(6)
    v_mfma_f32_32x32x16_bf16 v[24:39], v[8:11], a[88:91], v[24:39]
    s_waitcnt lgkmcnt(0)
    s_waitcnt vmcnt(8)
    s_barrier
    ds_read_b64_tr_b16 a[160:161], v2 offset:16384
    ds_read_b64_tr_b16 a[162:163], v2 offset:16896
    ds_read_b64_tr_b16 a[164:165], v3 offset:16384
    ds_read_b64_tr_b16 a[166:167], v3 offset:16896
    v_mfma_f32_32x32x16_bf16 v[40:55], v[12:15], a[88:91], v[40:55]
    ds_read_b64_tr_b16 v[8:9], v2 offset:18432
    ds_read_b64_tr_b16 v[10:11], v2 offset:18944
    v_mfma_f32_32x32x16_bf16 v[24:39], v[16:19], a[92:95], v[24:39]
    ds_read_b64_tr_b16 v[12:13], v3 offset:18432
    ds_read_b64_tr_b16 v[14:15], v3 offset:18944
    v_mfma_f32_32x32x16_bf16 v[40:55], v[20:23], a[92:95], v[40:55]
    ds_read_b64_tr_b16 v[16:17], v2 offset:20480
    ds_read_b64_tr_b16 v[18:19], v2 offset:20992
    s_waitcnt lgkmcnt(8)
    v_mfma_f32_32x32x16_bf16 v[24:39], a[160:163], a[96:99], v[24:39]
    s_add_u32 s51, s69, 786432
    s_add_u32 m0, s60, 8192
    s_nop 0
    buffer_load_dwordx4 v4, s[44:47], s51 offen offset:0 lds
    ds_read_b64_tr_b16 v[20:21], v3 offset:20480
    ds_read_b64_tr_b16 v[22:23], v3 offset:20992
    s_waitcnt lgkmcnt(8)
    v_mfma_f32_32x32x16_bf16 v[40:55], a[164:167], a[96:99], v[40:55]
    ds_read_b64_tr_b16 a[160:161], v2 offset:22528
    ds_read_b64_tr_b16 a[162:163], v2 offset:23040
    s_waitcnt lgkmcnt(8)
    v_mfma_f32_32x32x16_bf16 v[24:39], v[8:11], a[100:103], v[24:39]
    s_add_u32 s51, s69, 883712
    buffer_load_dwordx4 v4, s[44:47], s51 offen offset:1024 lds
    ds_read_b64_tr_b16 a[164:165], v3 offset:22528
    ds_read_b64_tr_b16 a[166:167], v3 offset:23040
    s_waitcnt lgkmcnt(8)
    v_mfma_f32_32x32x16_bf16 v[40:55], v[12:15], a[100:103], v[40:55]
    s_waitcnt lgkmcnt(6)
    v_mfma_f32_32x32x16_bf16 v[24:39], v[16:19], a[104:107], v[24:39]
    s_waitcnt lgkmcnt(0)
    s_waitcnt vmcnt(8)
    s_barrier
    ds_read_b64_tr_b16 v[8:9], v2 offset:24576
    ds_read_b64_tr_b16 v[10:11], v2 offset:25088
    ds_read_b64_tr_b16 v[12:13], v3 offset:24576
    ds_read_b64_tr_b16 v[14:15], v3 offset:25088
    v_mfma_f32_32x32x16_bf16 v[40:55], v[20:23], a[104:107], v[40:55]
    ds_read_b64_tr_b16 v[16:17], v2 offset:26624
    ds_read_b64_tr_b16 v[18:19], v2 offset:27136
    v_mfma_f32_32x32x16_bf16 v[24:39], a[160:163], a[108:111], v[24:39]
    ds_read_b64_tr_b16 v[20:21], v3 offset:26624
    ds_read_b64_tr_b16 v[22:23], v3 offset:27136
    v_mfma_f32_32x32x16_bf16 v[40:55], a[164:167], a[108:111], v[40:55]
    ds_read_b64_tr_b16 a[160:161], v2 offset:28672
    ds_read_b64_tr_b16 a[162:163], v2 offset:29184
    s_waitcnt lgkmcnt(8)
    v_mfma_f32_32x32x16_bf16 v[24:39], v[8:11], a[112:115], v[24:39]
    s_add_u32 s51, s69, 1572864
    s_add_u32 m0, s60, 16384
    s_nop 0
    buffer_load_dwordx4 v4, s[44:47], s51 offen offset:0 lds
    ds_read_b64_tr_b16 a[164:165], v3 offset:28672
    ds_read_b64_tr_b16 a[166:167], v3 offset:29184
    s_waitcnt lgkmcnt(8)
    v_mfma_f32_32x32x16_bf16 v[40:55], v[12:15], a[112:115], v[40:55]
    ds_read_b64_tr_b16 v[8:9], v2 offset:30720
    ds_read_b64_tr_b16 v[10:11], v2 offset:31232
    s_waitcnt lgkmcnt(8)
    v_mfma_f32_32x32x16_bf16 v[24:39], v[16:19], a[116:119], v[24:39]
    s_add_u32 s51, s69, 1670144
    buffer_load_dwordx4 v4, s[44:47], s51 offen offset:1024 lds
    ds_read_b64_tr_b16 v[12:13], v3 offset:30720
    ds_read_b64_tr_b16 v[14:15], v3 offset:31232
    s_waitcnt lgkmcnt(8)
    v_mfma_f32_32x32x16_bf16 v[40:55], v[20:23], a[116:119], v[40:55]
    s_waitcnt lgkmcnt(6)
    v_mfma_f32_32x32x16_bf16 v[24:39], a[160:163], a[120:123], v[24:39]
    s_waitcnt lgkmcnt(0)
    s_waitcnt vmcnt(8)
    s_barrier
    ds_read_b64_tr_b16 v[16:17], v2 offset:32768
    ds_read_b64_tr_b16 v[18:19], v2 offset:33280
    ds_read_b64_tr_b16 v[20:21], v3 offset:32768
    ds_read_b64_tr_b16 v[22:23], v3 offset:33280
    v_mfma_f32_32x32x16_bf16 v[40:55], a[164:167], a[120:123], v[40:55]
    ds_read_b64_tr_b16 a[160:161], v2 offset:34816
    ds_read_b64_tr_b16 a[162:163], v2 offset:35328
    v_mfma_f32_32x32x16_bf16 v[24:39], v[8:11], a[124:127], v[24:39]
    ds_read_b64_tr_b16 a[164:165], v3 offset:34816
    ds_read_b64_tr_b16 a[166:167], v3 offset:35328
    v_mfma_f32_32x32x16_bf16 v[40:55], v[12:15], a[124:127], v[40:55]
    ds_read_b64_tr_b16 v[8:9], v2 offset:36864
    ds_read_b64_tr_b16 v[10:11], v2 offset:37376
    s_waitcnt lgkmcnt(8)
    v_mfma_f32_32x32x16_bf16 v[24:39], v[16:19], a[128:131], v[24:39]
    s_add_u32 s51, s69, 2359296
    s_add_u32 m0, s60, 24576
    s_nop 0
    buffer_load_dwordx4 v4, s[44:47], s51 offen offset:0 lds
    ds_read_b64_tr_b16 v[12:13], v3 offset:36864
    ds_read_b64_tr_b16 v[14:15], v3 offset:37376
    s_waitcnt lgkmcnt(8)
    v_mfma_f32_32x32x16_bf16 v[40:55], v[20:23], a[128:131], v[40:55]
    ds_read_b64_tr_b16 v[16:17], v2 offset:38912
    ds_read_b64_tr_b16 v[18:19], v2 offset:39424
    s_waitcnt lgkmcnt(8)
    v_mfma_f32_32x32x16_bf16 v[24:39], a[160:163], a[132:135], v[24:39]
    s_add_u32 s51, s69, 2456576
    buffer_load_dwordx4 v4, s[44:47], s51 offen offset:1024 lds
    ds_read_b64_tr_b16 v[20:21], v3 offset:38912
    ds_read_b64_tr_b16 v[22:23], v3 offset:39424
    s_waitcnt lgkmcnt(8)
    v_mfma_f32_32x32x16_bf16 v[40:55], a[164:167], a[132:135], v[40:55]
    s_waitcnt lgkmcnt(6)
    v_mfma_f32_32x32x16_bf16 v[24:39], v[8:11], a[136:139], v[24:39]
    s_waitcnt lgkmcnt(0)
    s_waitcnt vmcnt(8)
    s_barrier
    ds_read_b64_tr_b16 a[160:161], v2 offset:40960
    ds_read_b64_tr_b16 a[162:163], v2 offset:41472
    ds_read_b64_tr_b16 a[164:165], v3 offset:40960
    ds_read_b64_tr_b16 a[166:167], v3 offset:41472
    v_mfma_f32_32x32x16_bf16 v[40:55], v[12:15], a[136:139], v[40:55]
    ds_read_b64_tr_b16 v[8:9], v2 offset:43008
    ds_read_b64_tr_b16 v[10:11], v2 offset:43520
    v_mfma_f32_32x32x16_bf16 v[24:39], v[16:19], a[140:143], v[24:39]
    ds_read_b64_tr_b16 v[12:13], v3 offset:43008
    ds_read_b64_tr_b16 v[14:15], v3 offset:43520
    v_mfma_f32_32x32x16_bf16 v[40:55], v[20:23], a[140:143], v[40:55]
    ds_read_b64_tr_b16 v[16:17], v2 offset:45056
    ds_read_b64_tr_b16 v[18:19], v2 offset:45568
    s_waitcnt lgkmcnt(8)
    v_mfma_f32_32x32x16_bf16 v[24:39], a[160:163], a[144:147], v[24:39]
    s_add_u32 s51, s69, 3145728
    s_add_u32 m0, s60, 32768
    s_nop 0
    buffer_load_dwordx4 v4, s[44:47], s51 offen offset:0 lds
    ds_read_b64_tr_b16 v[20:21], v3 offset:45056
    ds_read_b64_tr_b16 v[22:23], v3 offset:45568
    s_waitcnt lgkmcnt(8)
    v_mfma_f32_32x32x16_bf16 v[40:55], a[164:167], a[144:147], v[40:55]
    ds_read_b64_tr_b16 a[160:161], v2 offset:47104
    ds_read_b64_tr_b16 a[162:163], v2 offset:47616
    s_waitcnt lgkmcnt(8)
    v_mfma_f32_32x32x16_bf16 v[24:39], v[8:11], a[148:151], v[24:39]
    s_add_u32 s51, s69, 3243008
    buffer_load_dwordx4 v4, s[44:47], s51 offen offset:1024 lds
    ds_read_b64_tr_b16 a[164:165], v3 offset:47104
    ds_read_b64_tr_b16 a[166:167], v3 offset:47616
    s_waitcnt lgkmcnt(8)
    v_mfma_f32_32x32x16_bf16 v[40:55], v[12:15], a[148:151], v[40:55]
    s_waitcnt lgkmcnt(6)
    v_mfma_f32_32x32x16_bf16 v[24:39], v[16:19], a[152:155], v[24:39]
    s_waitcnt lgkmcnt(0)
    s_barrier
    v_mfma_f32_32x32x16_bf16 v[40:55], v[20:23], a[152:155], v[40:55]
    v_mfma_f32_32x32x16_bf16 v[24:39], a[160:163], a[156:159], v[24:39]
    v_mfma_f32_32x32x16_bf16 v[40:55], a[164:167], a[156:159], v[40:55]
    s_nop 7
    s_nop 2
    v_mul_f32 v24, s53, v24
    v_mul_f32 v25, s53, v25
    v_mul_f32 v26, s53, v26
    v_mul_f32 v27, s53, v27
    v_mul_f32 v28, s53, v28
    v_mul_f32 v29, s53, v29
    v_mul_f32 v30, s53, v30
    v_mul_f32 v31, s53, v31
    v_cvt_pk_bf16_f32 v24, v24, v25
    v_cvt_pk_bf16_f32 v25, v26, v27
    v_cvt_pk_bf16_f32 v26, v28, v29
    v_cvt_pk_bf16_f32 v27, v30, v31
    ds_write_b128 v5, v[24:27] offset:8192
    v_mul_f32 v32, s53, v32
    v_mul_f32 v33, s53, v33
    v_mul_f32 v34, s53, v34
    v_mul_f32 v35, s53, v35
    v_mul_f32 v36, s53, v36
    v_mul_f32 v37, s53, v37
    v_mul_f32 v38, s53, v38
    v_mul_f32 v39, s53, v39
    v_cvt_pk_bf16_f32 v32, v32, v33
    v_cvt_pk_bf16_f32 v33, v34, v35
    v_cvt_pk_bf16_f32 v34, v36, v37
    v_cvt_pk_bf16_f32 v35, v38, v39
    ds_write_b128 v5, v[32:35] offset:9216
    v_mul_f32 v40, s53, v40
    v_mul_f32 v41, s53, v41
    v_mul_f32 v42, s53, v42
    v_mul_f32 v43, s53, v43
    v_mul_f32 v44, s53, v44
    v_mul_f32 v45, s53, v45
    v_mul_f32 v46, s53, v46
    v_mul_f32 v47, s53, v47
    v_cvt_pk_bf16_f32 v40, v40, v41
    v_cvt_pk_bf16_f32 v41, v42, v43
    v_cvt_pk_bf16_f32 v42, v44, v45
    v_cvt_pk_bf16_f32 v43, v46, v47
    ds_write_b128 v5, v[40:43] offset:10240
    v_mul_f32 v48, s53, v48
    v_mul_f32 v49, s53, v49
    v_mul_f32 v50, s53, v50
    v_mul_f32 v51, s53, v51
    v_mul_f32 v52, s53, v52
    v_mul_f32 v53, s53, v53
    v_mul_f32 v54, s53, v54
    v_mul_f32 v55, s53, v55
    v_cvt_pk_bf16_f32 v48, v48, v49
    v_cvt_pk_bf16_f32 v49, v50, v51
    v_cvt_pk_bf16_f32 v50, v52, v53
    v_cvt_pk_bf16_f32 v51, v54, v55
    ds_write_b128 v5, v[48:51] offset:11264
    s_waitcnt lgkmcnt(0)
    s_barrier
    s_mov_b32 s65, s69
    s_add_u32 s69, s69, 1536
    s_add_u32 s50, s50, 1
    s_cmp_eq_u32 s50, 3
    s_cselect_b32 s69, 0x7f000000, s69
attn_GLOOP:
    s_nop 7
    s_nop 7
    s_waitcnt vmcnt(8)
    s_barrier
    ds_read_b64_tr_b16 v[8:9], v2 offset:0
    ds_read_b64_tr_b16 v[10:11], v2 offset:512
    ds_read_b64_tr_b16 v[12:13], v3 offset:0
    ds_read_b64_tr_b16 v[14:15], v3 offset:512
    ds_read_b64_tr_b16 v[16:17], v2 offset:2048
    ds_read_b64_tr_b16 v[18:19], v2 offset:2560
    ds_read_b64_tr_b16 v[20:21], v3 offset:2048
    ds_read_b64_tr_b16 v[22:23], v3 offset:2560
    ds_read_b64_tr_b16 a[160:161], v2 offset:4096
    ds_read_b64_tr_b16 a[162:163], v2 offset:4608
    s_waitcnt lgkmcnt(8)
    v_mfma_f32_32x32x16_bf16 v[24:39], v[8:11], a[0:3], 0
    s_add_u32 s51, s65, 3932160
    s_add_u32 m0, s60, 40960
    s_nop 0
    buffer_load_dwordx4 v4, s[44:47], s51 offen offset:0 lds
    ds_read_b64_tr_b16 a[164:165], v3 offset:4096
    ds_read_b64_tr_b16 a[166:167], v3 offset:4608
    s_waitcnt lgkmcnt(8)
    v_mfma_f32_32x32x16_bf16 v[40:55], v[12:15], a[0:3], 0
    ds_read_b64_tr_b16 v[8:9], v2 offset:6144
    ds_read_b64_tr_b16 v[10:11], v2 offset:6656
    s_waitcnt lgkmcnt(8)
    v_mfma_f32_32x32x16_bf16 v[24:39], v[16:19], a[4:7], v[24:39]
    s_add_u32 s51, s65, 4029440
    buffer_load_dwordx4 v4, s[44:47], s51 offen offset:1024 lds
    ds_read_b64_tr_b16 v[12:13], v3 offset:6144
    ds_read_b64_tr_b16 v[14:15], v3 offset:6656
    s_waitcnt lgkmcnt(8)
    v_mfma_f32_32x32x16_bf16 v[40:55], v[20:23], a[4:7], v[40:55]
    s_waitcnt lgkmcnt(6)
    v_mfma_f32_32x32x16_bf16 v[24:39], a[160:163], a[8:11], v[24:39]
    s_waitcnt lgkmcnt(0)
    s_waitcnt vmcnt(8)
    s_barrier
    ds_read_b64_tr_b16 v[16:17], v2 offset:8192
    ds_read_b64_tr_b16 v[18:19], v2 offset:8704
    ds_read_b64_tr_b16 v[20:21], v3 offset:8192
    ds_read_b64_tr_b16 v[22:23], v3 offset:8704
    v_mfma_f32_32x32x16_bf16 v[40:55], a[164:167], a[8:11], v[40:55]
    ds_read_b64_tr_b16 a[160:161], v2 offset:10240
    ds_read_b64_tr_b16 a[162:163], v2 offset:10752
    v_mfma_f32_32x32x16_bf16 v[24:39], v[8:11], a[12:15], v[24:39]
    ds_read_b64_tr_b16 a[164:165], v3 offset:10240
    ds_read_b64_tr_b16 a[166:167], v3 offset:10752
    v_mfma_f32_32x32x16_bf16 v[40:55], v[12:15], a[12:15], v[40:55]
    ds_read_b64_tr_b16 v[8:9], v2 offset:12288
    ds_read_b64_tr_b16 v[10:11], v2 offset:12800
    s_waitcnt lgkmcnt(8)
    v_mfma_f32_32x32x16_bf16 v[24:39], v[16:19], a[16:19], v[24:39]
    s_add_u32 s51, s65, 4718592
    s_add_u32 m0, s60, 0
    s_nop 0
    buffer_load_dwordx4 v4, s[44:47], s51 offen offset:0 lds
    ds_read_b64_tr_b16 v[12:13], v3 offset:12288
    ds_read_b64_tr_b16 v[14:15], v3 offset:12800
    s_waitcnt lgkmcnt(8)
    v_mfma_f32_32x32x16_bf16 v[40:55], v[20:23], a[16:19], v[40:55]
    ds_read_b64_tr_b16 v[16:17], v2 offset:14336
    ds_read_b64_tr_b16 v[18:19], v2 offset:14848
    s_waitcnt lgkmcnt(8)
    v_mfma_f32_32x32x16_bf16 v[24:39], a[160:163], a[20:23], v[24:39]
    s_add_u32 s51, s65, 4815872
    buffer_load_dwordx4 v4, s[44:47], s51 offen offset:1024 lds
    ds_read_b64_tr_b16 v[20:21], v3 offset:14336
    ds_read_b64_tr_b16 v[22:23], v3 offset:14848
    s_waitcnt lgkmcnt(8)
    v_mfma_f32_32x32x16_bf16 v[40:55], a[164:167], a[20:23], v[40:55]
    s_waitcnt lgkmcnt(6)
    v_mfma_f32_32x32x16_bf16 v[24:39], v[8:11], a[24:27], v[24:39]
    s_waitcnt lgkmcnt(0)
    s_waitcnt vmcnt(8)
    s_barrier
    ds_read_b64_tr_b16 a[160:161], v2 offset:16384
    ds_read_b64_tr_b16 a[162:163], v2 offset:16896
    ds_read_b64_tr_b16 a[164:165], v3 offset:16384
    ds_read_b64_tr_b16 a[166:167], v3 offset:16896
    v_mfma_f32_32x32x16_bf16 v[40:55], v[12:15], a[24:27], v[40:55]
    ds_read_b64_tr_b16 v[8:9], v2 offset:18432
    ds_read_b64_tr_b16 v[10:11], v2 offset:18944
    v_mfma_f32_32x32x16_bf16 v[24:39], v[16:19], a[28:31], v[24:39]
    ds_read_b64_tr_b16 v[12:13], v3 offset:18432
    ds_read_b64_tr_b16 v[14:15], v3 offset:18944
    v_mfma_f32_32x32x16_bf16 v[40:55], v[20:23], a[28:31], v[40:55]
    ds_read_b64_tr_b16 v[16:17], v2 offset:20480
    ds_read_b64_tr_b16 v[18:19], v2 offset:20992
    s_waitcnt lgkmcnt(8)
    v_mfma_f32_32x32x16_bf16 v[24:39], a[160:163], a[32:35], v[24:39]
    s_add_u32 s51, s65, 5505024
    s_add_u32 m0, s60, 8192
    s_nop 0
    buffer_load_dwordx4 v4, s[44:47], s51 offen offset:0 lds
    ds_read_b64_tr_b16 v[20:21], v3 offset:20480
    ds_read_b64_tr_b16 v[22:23], v3 offset:20992
    s_waitcnt lgkmcnt(8)
    v_mfma_f32_32x32x16_bf16 v[40:55], a[164:167], a[32:35], v[40:55]
    ds_read_b64_tr_b16 a[160:161], v2 offset:22528
    ds_read_b64_tr_b16 a[162:163], v2 offset:23040
    s_waitcnt lgkmcnt(8)
    v_mfma_f32_32x32x16_bf16 v[24:39], v[8:11], a[36:39], v[24:39]
    s_add_u32 s51, s65, 5602304
    buffer_load_dwordx4 v4, s[44:47], s51 offen offset:1024 lds
    ds_read_b64_tr_b16 a[164:165], v3 offset:22528
    ds_read_b64_tr_b16 a[166:167], v3 offset:23040
    s_waitcnt lgkmcnt(8)
    v_mfma_f32_32x32x16_bf16 v[40:55], v[12:15], a[36:39], v[40:55]
    s_waitcnt lgkmcnt(6)
    v_mfma_f32_32x32x16_bf16 v[24:39], v[16:19], a[40:43], v[24:39]
    s_waitcnt lgkmcnt(0)
    s_waitcnt vmcnt(8)
    s_barrier
    ds_read_b64_tr_b16 v[8:9], v2 offset:24576
    ds_read_b64_tr_b16 v[10:11], v2 offset:25088
    ds_read_b64_tr_b16 v[12:13], v3 offset:24576
    ds_read_b64_tr_b16 v[14:15], v3 offset:25088
    v_mfma_f32_32x32x16_bf16 v[40:55], v[20:23], a[40:43], v[40:55]
    ds_read_b64_tr_b16 v[16:17], v2 offset:26624
    ds_read_b64_tr_b16 v[18:19], v2 offset:27136
    v_mfma_f32_32x32x16_bf16 v[24:39], a[160:163], a[44:47], v[24:39]
    ds_read_b64_tr_b16 v[20:21], v3 offset:26624
    ds_read_b64_tr_b16 v[22:23], v3 offset:27136
    v_mfma_f32_32x32x16_bf16 v[40:55], a[164:167], a[44:47], v[40:55]
    ds_read_b64_tr_b16 a[160:161], v2 offset:28672
    ds_read_b64_tr_b16 a[162:163], v2 offset:29184
    s_waitcnt lgkmcnt(8)
    v_mfma_f32_32x32x16_bf16 v[24:39], v[8:11], a[48:51], v[24:39]
    s_add_u32 s51, s65, 6291456
    s_add_u32 m0, s60, 16384
    s_nop 0
    buffer_load_dwordx4 v4, s[44:47], s51 offen offset:0 lds
    ds_read_b64_tr_b16 a[164:165], v3 offset:28672
    ds_read_b64_tr_b16 a[166:167], v3 offset:29184
    s_waitcnt lgkmcnt(8)
    v_mfma_f32_32x32x16_bf16 v[40:55], v[12:15], a[48:51], v[40:55]
    ds_read_b64_tr_b16 v[8:9], v2 offset:30720
    ds_read_b64_tr_b16 v[10:11], v2 offset:31232
    s_waitcnt lgkmcnt(8)
    v_mfma_f32_32x32x16_bf16 v[24:39], v[16:19], a[52:55], v[24:39]
    s_add_u32 s51, s65, 6388736
    buffer_load_dwordx4 v4, s[44:47], s51 offen offset:1024 lds
    ds_read_b64_tr_b16 v[12:13], v3 offset:30720
    ds_read_b64_tr_b16 v[14:15], v3 offset:31232
    s_waitcnt lgkmcnt(8)
    v_mfma_f32_32x32x16_bf16 v[40:55], v[20:23], a[52:55], v[40:55]
    s_waitcnt lgkmcnt(6)
    v_mfma_f32_32x32x16_bf16 v[24:39], a[160:163], a[56:59], v[24:39]
    s_waitcnt lgkmcnt(0)
    s_waitcnt vmcnt(8)
    s_barrier
    s_sub_u32 s51, s50, 1
    v_mov_b32 v7, s51
    s_mov_b64 exec, 1
    buffer_store_dword v7, v1, s[24:27], 0 offen sc1
    s_mov_b64 exec, -1
    ds_read_b64_tr_b16 v[16:17], v2 offset:32768
    ds_read_b64_tr_b16 v[18:19], v2 offset:33280
    ds_read_b64_tr_b16 v[20:21], v3 offset:32768
    ds_read_b64_tr_b16 v[22:23], v3 offset:33280
    v_mfma_f32_32x32x16_bf16 v[40:55], a[164:167], a[56:59], v[40:55]
    ds_read_b64_tr_b16 a[160:161], v2 offset:34816
    ds_read_b64_tr_b16 a[162:163], v2 offset:35328
    v_mfma_f32_32x32x16_bf16 v[24:39], v[8:11], a[60:63], v[24:39]
    ds_read_b64_tr_b16 a[164:165], v3 offset:34816
    ds_read_b64_tr_b16 a[166:167], v3 offset:35328
    v_mfma_f32_32x32x16_bf16 v[40:55], v[12:15], a[60:63], v[40:55]
    ds_read_b64_tr_b16 v[8:9], v2 offset:36864
    ds_read_b64_tr_b16 v[10:11], v2 offset:37376
    s_waitcnt lgkmcnt(8)
    v_mfma_f32_32x32x16_bf16 v[24:39], v[16:19], a[64:67], v[24:39]
    s_add_u32 s51, s65, 7077888
    s_add_u32 m0, s60, 24576
    s_nop 0
    buffer_load_dwordx4 v4, s[44:47], s51 offen offset:0 lds
    ds_read_b64_tr_b16 v[12:13], v3 offset:36864
    ds_read_b64_tr_b16 v[14:15], v3 offset:37376
    s_waitcnt lgkmcnt(8)
    v_mfma_f32_32x32x16_bf16 v[40:55], v[20:23], a[64:67], v[40:55]
    ds_read_b64_tr_b16 v[16:17], v2 offset:38912
    ds_read_b64_tr_b16 v[18:19], v2 offset:39424
    s_waitcnt lgkmcnt(8)
    v_mfma_f32_32x32x16_bf16 v[24:39], a[160:163], a[68:71], v[24:39]
    s_add_u32 s51, s65, 7175168
    buffer_load_dwordx4 v4, s[44:47], s51 offen offset:1024 lds
    ds_read_b64_tr_b16 v[20:21], v3 offset:38912
    ds_read_b64_tr_b16 v[22:23], v3 offset:39424
    s_waitcnt lgkmcnt(8)
    v_mfma_f32_32x32x16_bf16 v[40:55], a[164:167], a[68:71], v[40:55]
    s_waitcnt lgkmcnt(6)
    v_mfma_f32_32x32x16_bf16 v[24:39], v[8:11], a[72:75], v[24:39]
    s_waitcnt lgkmcnt(0)
    s_waitcnt vmcnt(9)
    s_barrier
    ds_read_b64_tr_b16 a[160:161], v2 offset:40960
    ds_read_b64_tr_b16 a[162:163], v2 offset:41472
    ds_read_b64_tr_b16 a[164:165], v3 offset:40960
    ds_read_b64_tr_b16 a[166:167], v3 offset:41472
    v_mfma_f32_32x32x16_bf16 v[40:55], v[12:15], a[72:75], v[40:55]
    ds_read_b64_tr_b16 v[8:9], v2 offset:43008
    ds_read_b64_tr_b16 v[10:11], v2 offset:43520
    v_mfma_f32_32x32x16_bf16 v[24:39], v[16:19], a[76:79], v[24:39]
    ds_read_b64_tr_b16 v[12:13], v3 offset:43008
    ds_read_b64_tr_b16 v[14:15], v3 offset:43520
    v_mfma_f32_32x32x16_bf16 v[40:55], v[20:23], a[76:79], v[40:55]
    ds_read_b64_tr_b16 v[16:17], v2 offset:45056
    ds_read_b64_tr_b16 v[18:19], v2 offset:45568
    s_waitcnt lgkmcnt(8)
    v_mfma_f32_32x32x16_bf16 v[24:39], a[160:163], a[80:83], v[24:39]
    s_add_u32 s51, s65, 128
    s_add_u32 m0, s60, 32768
    s_nop 0
    buffer_load_dwordx4 v4, s[44:47], s51 offen offset:0 lds
    ds_read_b64_tr_b16 v[20:21], v3 offset:45056
    ds_read_b64_tr_b16 v[22:23], v3 offset:45568
    s_waitcnt lgkmcnt(8)
    v_mfma_f32_32x32x16_bf16 v[40:55], a[164:167], a[80:83], v[40:55]
    ds_read_b64_tr_b16 a[160:161], v2 offset:47104
    ds_read_b64_tr_b16 a[162:163], v2 offset:47616
    s_waitcnt lgkmcnt(8)
    v_mfma_f32_32x32x16_bf16 v[24:39], v[8:11], a[84:87], v[24:39]
    s_add_u32 s51, s65, 97408
    buffer_load_dwordx4 v4, s[44:47], s51 offen offset:1024 lds
    ds_read_b64_tr_b16 a[164:165], v3 offset:47104
    ds_read_b64_tr_b16 a[166:167], v3 offset:47616
    s_waitcnt lgkmcnt(8)
    v_mfma_f32_32x32x16_bf16 v[40:55], v[12:15], a[84:87], v[40:55]
    s_waitcnt lgkmcnt(6)
    v_mfma_f32_32x32x16_bf16 v[24:39], v[16:19], a[88:91], v[24:39]
    s_waitcnt lgkmcnt(0)
    s_waitcnt vmcnt(9)
    s_barrier
    ds_read_b64_tr_b16 v[8:9], v2 offset:0
    ds_read_b64_tr_b16 v[10:11], v2 offset:512
    ds_read_b64_tr_b16 v[12:13], v3 offset:0
    ds_read_b64_tr_b16 v[14:15], v3 offset:512
    v_mfma_f32_32x32x16_bf16 v[40:55], v[20:23], a[88:91], v[40:55]
    ds_read_b64_tr_b16 v[16:17], v2 offset:2048
    ds_read_b64_tr_b16 v[18:19], v2 offset:2560
    v_mfma_f32_32x32x16_bf16 v[24:39], a[160:163], a[92:95], v[24:39]
    ds_read_b64_tr_b16 v[20:21], v3 offset:2048
    ds_read_b64_tr_b16 v[22:23], v3 offset:2560
    v_mfma_f32_32x32x16_bf16 v[40:55], a[164:167], a[92:95], v[40:55]
    ds_read_b64_tr_b16 a[160:161], v2 offset:4096
    ds_read_b64_tr_b16 a[162:163], v2 offset:4608
    s_waitcnt lgkmcnt(8)
    v_mfma_f32_32x32x16_bf16 v[24:39], v[8:11], a[96:99], v[24:39]
    s_add_u32 s51, s65, 786560
    s_add_u32 m0, s60, 40960
    s_nop 0
    buffer_load_dwordx4 v4, s[44:47], s51 offen offset:0 lds
    ds_read_b64_tr_b16 a[164:165], v3 offset:4096
    ds_read_b64_tr_b16 a[166:167], v3 offset:4608
    s_waitcnt lgkmcnt(8)
    v_mfma_f32_32x32x16_bf16 v[40:55], v[12:15], a[96:99], v[40:55]
    ds_read_b64_tr_b16 v[8:9], v2 offset:6144
    ds_read_b64_tr_b16 v[10:11], v2 offset:6656
    s_waitcnt lgkmcnt(8)
    v_mfma_f32_32x32x16_bf16 v[24:39], v[16:19], a[100:103], v[24:39]
    s_add_u32 s51, s65, 883840
    buffer_load_dwordx4 v4, s[44:47], s51 offen offset:1024 lds
    ds_read_b64_tr_b16 v[12:13], v3 offset:6144
    ds_read_b64_tr_b16 v[14:15], v3 offset:6656
    s_waitcnt lgkmcnt(8)
    v_mfma_f32_32x32x16_bf16 v[40:55], v[20:23], a[100:103], v[40:55]
    s_waitcnt lgkmcnt(6)
    v_mfma_f32_32x32x16_bf16 v[24:39], a[160:163], a[104:107], v[24:39]
    s_waitcnt lgkmcnt(0)
    s_waitcnt vmcnt(9)
    s_barrier
    ds_read_b64_tr_b16 v[16:17], v2 offset:8192
    ds_read_b64_tr_b16 v[18:19], v2 offset:8704
    ds_read_b64_tr_b16 v[20:21], v3 offset:8192
    ds_read_b64_tr_b16 v[22:23], v3 offset:8704
    v_mfma_f32_32x32x16_bf16 v[40:55], a[164:167], a[104:107], v[40:55]
    ds_read_b64_tr_b16 a[160:161], v2 offset:10240
    ds_read_b64_tr_b16 a[162:163], v2 offset:10752
    v_mfma_f32_32x32x16_bf16 v[24:39], v[8:11], a[108:111], v[24:39]
    ds_read_b64_tr_b16 a[164:165], v3 offset:10240
    ds_read_b64_tr_b16 a[166:167], v3 offset:10752
    v_mfma_f32_32x32x16_bf16 v[40:55], v[12:15], a[108:111], v[40:55]
    ds_read_b64_tr_b16 v[8:9], v2 offset:12288
    ds_read_b64_tr_b16 v[10:11], v2 offset:12800
    s_waitcnt lgkmcnt(8)
    v_mfma_f32_32x32x16_bf16 v[24:39], v[16:19], a[112:115], v[24:39]
    s_add_u32 s51, s65, 1572992
    s_add_u32 m0, s60, 0
    s_nop 0
    buffer_load_dwordx4 v4, s[44:47], s51 offen offset:0 lds
    ds_read_b64_tr_b16 v[12:13], v3 offset:12288
    ds_read_b64_tr_b16 v[14:15], v3 offset:12800
    s_waitcnt lgkmcnt(8)
    v_mfma_f32_32x32x16_bf16 v[40:55], v[20:23], a[112:115], v[40:55]
    ds_read_b64_tr_b16 v[16:17], v2 offset:14336
    ds_read_b64_tr_b16 v[18:19], v2 offset:14848
    s_waitcnt lgkmcnt(8)
    v_mfma_f32_32x32x16_bf16 v[24:39], a[160:163], a[116:119], v[24:39]
    s_add_u32 s51, s65, 1670272
    buffer_load_dwordx4 v4, s[44:47], s51 offen offset:1024 lds
    ds_read_b64_tr_b16 v[20:21], v3 offset:14336
    ds_read_b64_tr_b16 v[22:23], v3 offset:14848
    s_waitcnt lgkmcnt(8)
    v_mfma_f32_32x32x16_bf16 v[40:55], a[164:167], a[116:119], v[40:55]
    s_waitcnt lgkmcnt(6)
    v_mfma_f32_32x32x16_bf16 v[24:39], v[8:11], a[120:123], v[24:39]
    s_waitcnt lgkmcnt(0)
    s_waitcnt vmcnt(9)
    s_barrier
    ds_read_b64_tr_b16 a[160:161], v2 offset:16384
    ds_read_b64_tr_b16 a[162:163], v2 offset:16896
    ds_read_b64_tr_b16 a[164:165], v3 offset:16384
    ds_read_b64_tr_b16 a[166:167], v3 offset:16896
    v_mfma_f32_32x32x16_bf16 v[40:55], v[12:15], a[120:123], v[40:55]
    ds_read_b64_tr_b16 v[8:9], v2 offset:18432
    ds_read_b64_tr_b16 v[10:11], v2 offset:18944
    v_mfma_f32_32x32x16_bf16 v[24:39], v[16:19], a[124:127], v[24:39]
    ds_read_b64_tr_b16 v[12:13], v3 offset:18432
    ds_read_b64_tr_b16 v[14:15], v3 offset:18944
    v_mfma_f32_32x32x16_bf16 v[40:55], v[20:23], a[124:127], v[40:55]
    ds_read_b64_tr_b16 v[16:17], v2 offset:20480
    ds_read_b64_tr_b16 v[18:19], v2 offset:20992
    s_waitcnt lgkmcnt(8)
    v_mfma_f32_32x32x16_bf16 v[24:39], a[160:163], a[128:131], v[24:39]
    s_add_u32 s51, s65, 2359424
    s_add_u32 m0, s60, 8192
    s_nop 0
    buffer_load_dwordx4 v4, s[44:47], s51 offen offset:0 lds
    ds_read_b64_tr_b16 v[20:21], v3 offset:20480
    ds_read_b64_tr_b16 v[22:23], v3 offset:20992
    s_waitcnt lgkmcnt(8)
    v_mfma_f32_32x32x16_bf16 v[40:55], a[164:167], a[128:131], v[40:55]
    ds_read_b64_tr_b16 a[160:161], v2 offset:22528
    ds_read_b64_tr_b16 a[162:163], v2 offset:23040
    s_waitcnt lgkmcnt(8)
    v_mfma_f32_32x32x16_bf16 v[24:39], v[8:11], a[132:135], v[24:39]
    s_add_u32 s51, s65, 2456704
    buffer_load_dwordx4 v4, s[44:47], s51 offen offset:1024 lds
    ds_read_b64_tr_b16 a[164:165], v3 offset:22528
    ds_read_b64_tr_b16 a[166:167], v3 offset:23040
    s_waitcnt lgkmcnt(8)
    v_mfma_f32_32x32x16_bf16 v[40:55], v[12:15], a[132:135], v[40:55]
    s_waitcnt lgkmcnt(6)
    v_mfma_f32_32x32x16_bf16 v[24:39], v[16:19], a[136:139], v[24:39]
    s_waitcnt lgkmcnt(0)
    s_waitcnt vmcnt(8)
    s_barrier
    ds_read_b64_tr_b16 v[8:9], v2 offset:24576
    ds_read_b64_tr_b16 v[10:11], v2 offset:25088
    ds_read_b64_tr_b16 v[12:13], v3 offset:24576
    ds_read_b64_tr_b16 v[14:15], v3 offset:25088
    v_mfma_f32_32x32x16_bf16 v[40:55], v[20:23], a[136:139], v[40:55]
    ds_read_b64_tr_b16 v[16:17], v2 offset:26624
    ds_read_b64_tr_b16 v[18:19], v2 offset:27136
    v_mfma_f32_32x32x16_bf16 v[24:39], a[160:163], a[140:143], v[24:39]
    ds_read_b64_tr_b16 v[20:21], v3 offset:26624
    ds_read_b64_tr_b16 v[22:23], v3 offset:27136
    v_mfma_f32_32x32x16_bf16 v[40:55], a[164:167], a[140:143], v[40:55]
    ds_read_b64_tr_b16 a[160:161], v2 offset:28672
    ds_read_b64_tr_b16 a[162:163], v2 offset:29184
    s_waitcnt lgkmcnt(8)
    v_mfma_f32_32x32x16_bf16 v[24:39], v[8:11], a[144:147], v[24:39]
    s_add_u32 s51, s65, 3145856
    s_add_u32 m0, s60, 16384
    s_nop 0
    buffer_load_dwordx4 v4, s[44:47], s51 offen offset:0 lds
    ds_read_b64_tr_b16 a[164:165], v3 offset:28672
    ds_read_b64_tr_b16 a[166:167], v3 offset:29184
    s_waitcnt lgkmcnt(8)
    v_mfma_f32_32x32x16_bf16 v[40:55], v[12:15], a[144:147], v[40:55]
    ds_read_b64_tr_b16 v[8:9], v2 offset:30720
    ds_read_b64_tr_b16 v[10:11], v2 offset:31232
    s_waitcnt lgkmcnt(8)
    v_mfma_f32_32x32x16_bf16 v[24:39], v[16:19], a[148:151], v[24:39]
    s_add_u32 s51, s65, 3243136
    buffer_load_dwordx4 v4, s[44:47], s51 offen offset:1024 lds
    ds_read_b64_tr_b16 v[12:13], v3 offset:30720
    ds_read_b64_tr_b16 v[14:15], v3 offset:31232
    s_waitcnt lgkmcnt(8)
    v_mfma_f32_32x32x16_bf16 v[40:55], v[20:23], a[148:151], v[40:55]
    s_waitcnt lgkmcnt(6)
    v_mfma_f32_32x32x16_bf16 v[24:39], a[160:163], a[152:155], v[24:39]
    s_waitcnt lgkmcnt(0)
    s_waitcnt vmcnt(8)
    s_barrier
    ds_read_b64_tr_b16 v[16:17], v2 offset:32768
    ds_read_b64_tr_b16 v[18:19], v2 offset:33280
    ds_read_b64_tr_b16 v[20:21], v3 offset:32768
    ds_read_b64_tr_b16 v[22:23], v3 offset:33280
    v_mfma_f32_32x32x16_bf16 v[40:55], a[164:167], a[152:155], v[40:55]
    ds_read_b64_tr_b16 a[160:161], v2 offset:34816
    ds_read_b64_tr_b16 a[162:163], v2 offset:35328
    v_mfma_f32_32x32x16_bf16 v[24:39], v[8:11], a[156:159], v[24:39]
    ds_read_b64_tr_b16 a[164:165], v3 offset:34816
    ds_read_b64_tr_b16 a[166:167], v3 offset:35328
    v_mfma_f32_32x32x16_bf16 v[40:55], v[12:15], a[156:159], v[40:55]
    ds_read_b64_tr_b16 v[8:9], v2 offset:36864
    ds_read_b64_tr_b16 v[10:11], v2 offset:37376
    s_waitcnt lgkmcnt(8)
    v_mfma_f32_32x32x16_bf16 v[56:71], v[16:19], a[0:3], 0
    s_nop 4
    v_mul_f32 v24, s53, v24
    v_mul_f32 v25, s53, v25
    v_mul_f32 v26, s53, v26
    v_mul_f32 v27, s53, v27
    v_mul_f32 v28, s53, v28
    v_mul_f32 v29, s53, v29
    v_mul_f32 v30, s53, v30
    v_mul_f32 v31, s53, v31
    v_cvt_pk_bf16_f32 v24, v24, v25
    v_cvt_pk_bf16_f32 v25, v26, v27
    v_cvt_pk_bf16_f32 v26, v28, v29
    ds_read_b64_tr_b16 v[12:13], v3 offset:36864
    ds_read_b64_tr_b16 v[14:15], v3 offset:37376
    s_waitcnt lgkmcnt(8)
    v_mfma_f32_32x32x16_bf16 v[72:87], v[20:23], a[0:3], 0
    v_cvt_pk_bf16_f32 v27, v30, v31
    ds_write_b128 v5, v[24:27] offset:0
    v_mul_f32 v32, s53, v32
    v_mul_f32 v33, s53, v33
    v_mul_f32 v34, s53, v34
    v_mul_f32 v35, s53, v35
    v_mul_f32 v36, s53, v36
    v_mul_f32 v37, s53, v37
    v_mul_f32 v38, s53, v38
    v_mul_f32 v39, s53, v39
    v_cvt_pk_bf16_f32 v32, v32, v33
    ds_read_b64_tr_b16 v[16:17], v2 offset:38912
    ds_read_b64_tr_b16 v[18:19], v2 offset:39424
    s_waitcnt lgkmcnt(9)
    v_mfma_f32_32x32x16_bf16 v[56:71], a[160:163], a[4:7], v[56:71]
    v_cvt_pk_bf16_f32 v33, v34, v35
    v_cvt_pk_bf16_f32 v34, v36, v37
    v_cvt_pk_bf16_f32 v35, v38, v39
    ds_write_b128 v5, v[32:35] offset:1024
    s_add_u32 s51, s65, 3932288
    s_add_u32 m0, s60, 24576
    s_nop 0
    buffer_load_dwordx4 v4, s[44:47], s51 offen offset:0 lds
    v_mul_f32 v40, s53, v40
    v_mul_f32 v41, s53, v41
    v_mul_f32 v42, s53, v42
    v_mul_f32 v43, s53, v43
    v_mul_f32 v44, s53, v44
    v_mul_f32 v45, s53, v45
    ds_read_b64_tr_b16 v[20:21], v3 offset:38912
    ds_read_b64_tr_b16 v[22:23], v3 offset:39424
    s_waitcnt lgkmcnt(10)
    v_mfma_f32_32x32x16_bf16 v[72:87], a[164:167], a[4:7], v[72:87]
    v_mul_f32 v46, s53, v46
    v_mul_f32 v47, s53, v47
    v_cvt_pk_bf16_f32 v40, v40, v41
    v_cvt_pk_bf16_f32 v41, v42, v43
    v_cvt_pk_bf16_f32 v42, v44, v45
    v_cvt_pk_bf16_f32 v43, v46, v47
    ds_write_b128 v5, v[40:43] offset:2048
    v_mul_f32 v48, s53, v48
    v_mul_f32 v49, s53, v49
    v_mul_f32 v50, s53, v50
    v_mul_f32 v51, s53, v51
    s_waitcnt lgkmcnt(9)
    v_mfma_f32_32x32x16_bf16 v[56:71], v[8:11], a[8:11], v[56:71]
    v_mul_f32 v52, s53, v52
    v_mul_f32 v53, s53, v53
    v_mul_f32 v54, s53, v54
    v_mul_f32 v55, s53, v55
    v_cvt_pk_bf16_f32 v48, v48, v49
    v_cvt_pk_bf16_f32 v49, v50, v51
    v_cvt_pk_bf16_f32 v50, v52, v53
    v_cvt_pk_bf16_f32 v51, v54, v55
    ds_write_b128 v5, v[48:51] offset:3072
    s_add_u32 s51, s65, 4029568
    buffer_load_dwordx4 v4, s[44:47], s51 offen offset:1024 lds
    s_waitcnt lgkmcnt(0)
    s_waitcnt vmcnt(8)
    s_barrier
    ds_read_b64_tr_b16 a[160:161], v2 offset:40960
    ds_read_b64_tr_b16 a[162:163], v2 offset:41472
    ds_read_b64_tr_b16 a[164:165], v3 offset:40960
    ds_read_b64_tr_b16 a[166:167], v3 offset:41472
    v_mfma_f32_32x32x16_bf16 v[72:87], v[12:15], a[8:11], v[72:87]
    ds_read_b64_tr_b16 v[8:9], v2 offset:43008
    ds_read_b64_tr_b16 v[10:11], v2 offset:43520
    v_mfma_f32_32x32x16_bf16 v[56:71], v[16:19], a[12:15], v[56:71]
    ds_read_b64_tr_b16 v[12:13], v3 offset:43008
    ds_read_b64_tr_b16 v[14:15], v3 offset:43520
    v_mfma_f32_32x32x16_bf16 v[72:87], v[20:23], a[12:15], v[72:87]
    ds_read_b64_tr_b16 v[16:17], v2 offset:45056
    ds_read_b64_tr_b16 v[18:19], v2 offset:45568
    s_waitcnt lgkmcnt(8)
    v_mfma_f32_32x32x16_bf16 v[56:71], a[160:163], a[16:19], v[56:71]
    s_add_u32 s51, s65, 4718720
    s_add_u32 m0, s60, 32768
    s_nop 0
    buffer_load_dwordx4 v4, s[44:47], s51 offen offset:0 lds
    ds_read_b64_tr_b16 v[20:21], v3 offset:45056
    ds_read_b64_tr_b16 v[22:23], v3 offset:45568
    s_waitcnt lgkmcnt(8)
    v_mfma_f32_32x32x16_bf16 v[72:87], a[164:167], a[16:19], v[72:87]
    ds_read_b64_tr_b16 a[160:161], v2 offset:47104
    ds_read_b64_tr_b16 a[162:163], v2 offset:47616
    s_waitcnt lgkmcnt(8)
    v_mfma_f32_32x32x16_bf16 v[56:71], v[8:11], a[20:23], v[56:71]
    s_add_u32 s51, s65, 4816000
    buffer_load_dwordx4 v4, s[44:47], s51 offen offset:1024 lds
    ds_read_b64_tr_b16 a[164:165], v3 offset:47104
    ds_read_b64_tr_b16 a[166:167], v3 offset:47616
    s_waitcnt lgkmcnt(8)
    v_mfma_f32_32x32x16_bf16 v[72:87], v[12:15], a[20:23], v[72:87]
    s_waitcnt lgkmcnt(6)
    v_mfma_f32_32x32x16_bf16 v[56:71], v[16:19], a[24:27], v[56:71]
    s_waitcnt lgkmcnt(0)
    s_waitcnt vmcnt(8)
    s_barrier
    ds_read_b64_tr_b16 v[8:9], v2 offset:0
    ds_read_b64_tr_b16 v[10:11], v2 offset:512
    ds_read_b64_tr_b16 v[12:13], v3 offset:0
    ds_read_b64_tr_b16 v[14:15], v3 offset:512
    v_mfma_f32_32x32x16_bf16 v[72:87], v[20:23], a[24:27], v[72:87]
    ds_read_b64_tr_b16 v[16:17], v2 offset:2048
    ds_read_b64_tr_b16 v[18:19], v2 offset:2560
    v_mfma_f32_32x32x16_bf16 v[56:71], a[160:163], a[28:31], v[56:71]
    ds_read_b64_tr_b16 v[20:21], v3 offset:2048
    ds_read_b64_tr_b16 v[22:23], v3 offset:2560
    v_mfma_f32_32x32x16_bf16 v[72:87], a[164:167], a[28:31], v[72:87]
    ds_read_b64_tr_b16 a[160:161], v2 offset:4096
    ds_read_b64_tr_b16 a[162:163], v2 offset:4608
    s_waitcnt lgkmcnt(8)
    v_mfma_f32_32x32x16_bf16 v[56:71], v[8:11], a[32:35], v[56:71]
    s_add_u32 s51, s65, 5505152
    s_add_u32 m0, s60, 40960
    s_nop 0
    buffer_load_dwordx4 v4, s[44:47], s51 offen offset:0 lds
    ds_read_b64_tr_b16 a[164:165], v3 offset:4096
    ds_read_b64_tr_b16 a[166:167], v3 offset:4608
    s_waitcnt lgkmcnt(8)
    v_mfma_f32_32x32x16_bf16 v[72:87], v[12:15], a[32:35], v[72:87]
    ds_read_b64_tr_b16 v[8:9], v2 offset:6144
    ds_read_b64_tr_b16 v[10:11], v2 offset:6656
    s_waitcnt lgkmcnt(8)
    v_mfma_f32_32x32x16_bf16 v[56:71], v[16:19], a[36:39], v[56:71]
    s_add_u32 s51, s65, 5602432
    buffer_load_dwordx4 v4, s[44:47], s51 offen offset:1024 lds
    ds_read_b64_tr_b16 v[12:13], v3 offset:6144
    ds_read_b64_tr_b16 v[14:15], v3 offset:6656
    s_waitcnt lgkmcnt(8)
    v_mfma_f32_32x32x16_bf16 v[72:87], v[20:23], a[36:39], v[72:87]
    s_waitcnt lgkmcnt(6)
    v_mfma_f32_32x32x16_bf16 v[56:71], a[160:163], a[40:43], v[56:71]
    s_waitcnt lgkmcnt(0)
    s_waitcnt vmcnt(8)
    s_barrier
    ds_read_b64_tr_b16 v[16:17], v2 offset:8192
    ds_read_b64_tr_b16 v[18:19], v2 offset:8704
    ds_read_b64_tr_b16 v[20:21], v3 offset:8192
    ds_read_b64_tr_b16 v[22:23], v3 offset:8704
    v_mfma_f32_32x32x16_bf16 v[72:87], a[164:167], a[40:43], v[72:87]
    ds_read_b64_tr_b16 a[160:161], v2 offset:10240
    ds_read_b64_tr_b16 a[162:163], v2 offset:10752
    v_mfma_f32_32x32x16_bf16 v[56:71], v[8:11], a[44:47], v[56:71]
    ds_read_b64_tr_b16 a[164:165], v3 offset:10240
    ds_read_b64_tr_b16 a[166:167], v3 offset:10752
    v_mfma_f32_32x32x16_bf16 v[72:87], v[12:15], a[44:47], v[72:87]
    ds_read_b64_tr_b16 v[8:9], v2 offset:12288
    ds_read_b64_tr_b16 v[10:11], v2 offset:12800
    s_waitcnt lgkmcnt(8)
    v_mfma_f32_32x32x16_bf16 v[56:71], v[16:19], a[48:51], v[56:71]
    s_add_u32 s51, s65, 6291584
    s_add_u32 m0, s60, 0
    s_nop 0
    buffer_load_dwordx4 v4, s[44:47], s51 offen offset:0 lds
    ds_read_b64_tr_b16 v[12:13], v3 offset:12288
    ds_read_b64_tr_b16 v[14:15], v3 offset:12800
    s_waitcnt lgkmcnt(8)
    v_mfma_f32_32x32x16_bf16 v[72:87], v[20:23], a[48:51], v[72:87]
    ds_read_b64_tr_b16 v[16:17], v2 offset:14336
    ds_read_b64_tr_b16 v[18:19], v2 offset:14848
    s_waitcnt lgkmcnt(8)
    v_mfma_f32_32x32x16_bf16 v[56:71], a[160:163], a[52:55], v[56:71]
    s_add_u32 s51, s65, 6388864
    buffer_load_dwordx4 v4, s[44:47], s51 offen offset:1024 lds
    ds_read_b64_tr_b16 v[20:21], v3 offset:14336
    ds_read_b64_tr_b16 v[22:23], v3 offset:14848
    s_waitcnt lgkmcnt(8)
    v_mfma_f32_32x32x16_bf16 v[72:87], a[164:167], a[52:55], v[72:87]
    s_waitcnt lgkmcnt(6)
    v_mfma_f32_32x32x16_bf16 v[56:71], v[8:11], a[56:59], v[56:71]
    s_waitcnt lgkmcnt(0)
    s_waitcnt vmcnt(8)
    s_barrier
    ds_read_b64_tr_b16 a[160:161], v2 offset:16384
    ds_read_b64_tr_b16 a[162:163], v2 offset:16896
    ds_read_b64_tr_b16 a[164:165], v3 offset:16384
    ds_read_b64_tr_b16 a[166:167], v3 offset:16896
    v_mfma_f32_32x32x16_bf16 v[72:87], v[12:15], a[56:59], v[72:87]
    ds_read_b64_tr_b16 v[8:9], v2 offset:18432
    ds_read_b64_tr_b16 v[10:11], v2 offset:18944
    v_mfma_f32_32x32x16_bf16 v[56:71], v[16:19], a[60:63], v[56:71]
    ds_read_b64_tr_b16 v[12:13], v3 offset:18432
    ds_read_b64_tr_b16 v[14:15], v3 offset:18944
    v_mfma_f32_32x32x16_bf16 v[72:87], v[20:23], a[60:63], v[72:87]
    ds_read_b64_tr_b16 v[16:17], v2 offset:20480
    ds_read_b64_tr_b16 v[18:19], v2 offset:20992
    s_waitcnt lgkmcnt(8)
    v_mfma_f32_32x32x16_bf16 v[56:71], a[160:163], a[64:67], v[56:71]
    s_add_u32 s51, s65, 7078016
    s_add_u32 m0, s60, 8192
    s_nop 0
    buffer_load_dwordx4 v4, s[44:47], s51 offen offset:0 lds
    ds_read_b64_tr_b16 v[20:21], v3 offset:20480
    ds_read_b64_tr_b16 v[22:23], v3 offset:20992
    s_waitcnt lgkmcnt(8)
    v_mfma_f32_32x32x16_bf16 v[72:87], a[164:167], a[64:67], v[72:87]
    ds_read_b64_tr_b16 a[160:161], v2 offset:22528
    ds_read_b64_tr_b16 a[162:163], v2 offset:23040
    s_waitcnt lgkmcnt(8)
    v_mfma_f32_32x32x16_bf16 v[56:71], v[8:11], a[68:71], v[56:71]
    s_add_u32 s51, s65, 7175296
    buffer_load_dwordx4 v4, s[44:47], s51 offen offset:1024 lds
    ds_read_b64_tr_b16 a[164:165], v3 offset:22528
    ds_read_b64_tr_b16 a[166:167], v3 offset:23040
    s_waitcnt lgkmcnt(8)
    v_mfma_f32_32x32x16_bf16 v[72:87], v[12:15], a[68:71], v[72:87]
    s_waitcnt lgkmcnt(6)
    v_mfma_f32_32x32x16_bf16 v[56:71], v[16:19], a[72:75], v[56:71]
    s_waitcnt lgkmcnt(0)
    s_waitcnt vmcnt(8)
    s_barrier
    ds_read_b64_tr_b16 v[8:9], v2 offset:24576
    ds_read_b64_tr_b16 v[10:11], v2 offset:25088
    ds_read_b64_tr_b16 v[12:13], v3 offset:24576
    ds_read_b64_tr_b16 v[14:15], v3 offset:25088
    v_mfma_f32_32x32x16_bf16 v[72:87], v[20:23], a[72:75], v[72:87]
    ds_read_b64_tr_b16 v[16:17], v2 offset:26624
    ds_read_b64_tr_b16 v[18:19], v2 offset:27136
    v_mfma_f32_32x32x16_bf16 v[56:71], a[160:163], a[76:79], v[56:71]
    ds_read_b64_tr_b16 v[20:21], v3 offset:26624
    ds_read_b64_tr_b16 v[22:23], v3 offset:27136
    v_mfma_f32_32x32x16_bf16 v[72:87], a[164:167], a[76:79], v[72:87]
    ds_read_b64_tr_b16 a[160:161], v2 offset:28672
    ds_read_b64_tr_b16 a[162:163], v2 offset:29184
    s_waitcnt lgkmcnt(8)
    v_mfma_f32_32x32x16_bf16 v[56:71], v[8:11], a[80:83], v[56:71]
    s_add_u32 s51, s65, 256
    s_add_u32 m0, s60, 16384
    s_nop 0
    buffer_load_dwordx4 v4, s[44:47], s51 offen offset:0 lds
    ds_read_b64_tr_b16 a[164:165], v3 offset:28672
    ds_read_b64_tr_b16 a[166:167], v3 offset:29184
    s_waitcnt lgkmcnt(8)
    v_mfma_f32_32x32x16_bf16 v[72:87], v[12:15], a[80:83], v[72:87]
    ds_read_b64_tr_b16 v[8:9], v2 offset:30720
    ds_read_b64_tr_b16 v[10:11], v2 offset:31232
    s_waitcnt lgkmcnt(8)
    v_mfma_f32_32x32x16_bf16 v[56:71], v[16:19], a[84:87], v[56:71]
    s_add_u32 s51, s65, 97536
    buffer_load_dwordx4 v4, s[44:47], s51 offen offset:1024 lds
    ds_read_b64_tr_b16 v[12:13], v3 offset:30720
    ds_read_b64_tr_b16 v[14:15], v3 offset:31232
    s_waitcnt lgkmcnt(8)
    v_mfma_f32_32x32x16_bf16 v[72:87], v[20:23], a[84:87], v[72:87]
    s_waitcnt lgkmcnt(6)
    v_mfma_f32_32x32x16_bf16 v[56:71], a[160:163], a[88:91], v[56:71]
    s_waitcnt lgkmcnt(0)
    s_waitcnt vmcnt(8)
    s_barrier
    ds_read_b64_tr_b16 v[16:17], v2 offset:32768
    ds_read_b64_tr_b16 v[18:19], v2 offset:33280
    ds_read_b64_tr_b16 v[20:21], v3 offset:32768
    ds_read_b64_tr_b16 v[22:23], v3 offset:33280
    v_mfma_f32_32x32x16_bf16 v[72:87], a[164:167], a[88:91], v[72:87]
    ds_read_b64_tr_b16 a[160:161], v2 offset:34816
    ds_read_b64_tr_b16 a[162:163], v2 offset:35328
    v_mfma_f32_32x32x16_bf16 v[56:71], v[8:11], a[92:95], v[56:71]
    ds_read_b64_tr_b16 a[164:165], v3 offset:34816
    ds_read_b64_tr_b16 a[166:167], v3 offset:35328
    v_mfma_f32_32x32x16_bf16 v[72:87], v[12:15], a[92:95], v[72:87]
    ds_read_b64_tr_b16 v[8:9], v2 offset:36864
    ds_read_b64_tr_b16 v[10:11], v2 offset:37376
    s_waitcnt lgkmcnt(8)
    v_mfma_f32_32x32x16_bf16 v[56:71], v[16:19], a[96:99], v[56:71]
    s_add_u32 s51, s65, 786688
    s_add_u32 m0, s60, 24576
    s_nop 0
    buffer_load_dwordx4 v4, s[44:47], s51 offen offset:0 lds
    ds_read_b64_tr_b16 v[12:13], v3 offset:36864
    ds_read_b64_tr_b16 v[14:15], v3 offset:37376
    s_waitcnt lgkmcnt(8)
    v_mfma_f32_32x32x16_bf16 v[72:87], v[20:23], a[96:99], v[72:87]
    ds_read_b64_tr_b16 v[16:17], v2 offset:38912
    ds_read_b64_tr_b16 v[18:19], v2 offset:39424
    s_waitcnt lgkmcnt(8)
    v_mfma_f32_32x32x16_bf16 v[56:71], a[160:163], a[100:103], v[56:71]
    s_add_u32 s51, s65, 883968
    buffer_load_dwordx4 v4, s[44:47], s51 offen offset:1024 lds
    ds_read_b64_tr_b16 v[20:21], v3 offset:38912
    ds_read_b64_tr_b16 v[22:23], v3 offset:39424
    s_waitcnt lgkmcnt(8)
    v_mfma_f32_32x32x16_bf16 v[72:87], a[164:167], a[100:103], v[72:87]
    s_waitcnt lgkmcnt(6)
    v_mfma_f32_32x32x16_bf16 v[56:71], v[8:11], a[104:107], v[56:71]
    s_waitcnt lgkmcnt(0)
    s_waitcnt vmcnt(8)
    s_barrier
    ds_read_b64_tr_b16 a[160:161], v2 offset:40960
    ds_read_b64_tr_b16 a[162:163], v2 offset:41472
    ds_read_b64_tr_b16 a[164:165], v3 offset:40960
    ds_read_b64_tr_b16 a[166:167], v3 offset:41472
    v_mfma_f32_32x32x16_bf16 v[72:87], v[12:15], a[104:107], v[72:87]
    ds_read_b64_tr_b16 v[8:9], v2 offset:43008
    ds_read_b64_tr_b16 v[10:11], v2 offset:43520
    v_mfma_f32_32x32x16_bf16 v[56:71], v[16:19], a[108:111], v[56:71]
    ds_read_b64_tr_b16 v[12:13], v3 offset:43008
    ds_read_b64_tr_b16 v[14:15], v3 offset:43520
    v_mfma_f32_32x32x16_bf16 v[72:87], v[20:23], a[108:111], v[72:87]
    ds_read_b64_tr_b16 v[16:17], v2 offset:45056
    ds_read_b64_tr_b16 v[18:19], v2 offset:45568
    s_waitcnt lgkmcnt(8)
    v_mfma_f32_32x32x16_bf16 v[56:71], a[160:163], a[112:115], v[56:71]
    s_add_u32 s51, s65, 1573120
    s_add_u32 m0, s60, 32768
    s_nop 0
    buffer_load_dwordx4 v4, s[44:47], s51 offen offset:0 lds
    ds_read_b64_tr_b16 v[20:21], v3 offset:45056
    ds_read_b64_tr_b16 v[22:23], v3 offset:45568
    s_waitcnt lgkmcnt(8)
    v_mfma_f32_32x32x16_bf16 v[72:87], a[164:167], a[112:115], v[72:87]
    ds_read_b64_tr_b16 a[160:161], v2 offset:47104
    ds_read_b64_tr_b16 a[162:163], v2 offset:47616
    s_waitcnt lgkmcnt(8)
    v_mfma_f32_32x32x16_bf16 v[56:71], v[8:11], a[116:119], v[56:71]
    s_add_u32 s51, s65, 1670400
    buffer_load_dwordx4 v4, s[44:47], s51 offen offset:1024 lds
    ds_read_b64_tr_b16 a[164:165], v3 offset:47104
    ds_read_b64_tr_b16 a[166:167], v3 offset:47616
    s_waitcnt lgkmcnt(8)
    v_mfma_f32_32x32x16_bf16 v[72:87], v[12:15], a[116:119], v[72:87]
    s_waitcnt lgkmcnt(6)
    v_mfma_f32_32x32x16_bf16 v[56:71], v[16:19], a[120:123], v[56:71]
    s_waitcnt lgkmcnt(0)
    s_waitcnt vmcnt(8)
    s_barrier
    ds_read_b64_tr_b16 v[8:9], v2 offset:0
    ds_read_b64_tr_b16 v[10:11], v2 offset:512
    ds_read_b64_tr_b16 v[12:13], v3 offset:0
    ds_read_b64_tr_b16 v[14:15], v3 offset:512
    v_mfma_f32_32x32x16_bf16 v[72:87], v[20:23], a[120:123], v[72:87]
    ds_read_b64_tr_b16 v[16:17], v2 offset:2048
    ds_read_b64_tr_b16 v[18:19], v2 offset:2560
    v_mfma_f32_32x32x16_bf16 v[56:71], a[160:163], a[124:127], v[56:71]
    ds_read_b64_tr_b16 v[20:21], v3 offset:2048
    ds_read_b64_tr_b16 v[22:23], v3 offset:2560
    v_mfma_f32_32x32x16_bf16 v[72:87], a[164:167], a[124:127], v[72:87]
    ds_read_b64_tr_b16 a[160:161], v2 offset:4096
    ds_read_b64_tr_b16 a[162:163], v2 offset:4608
    s_waitcnt lgkmcnt(8)
    v_mfma_f32_32x32x16_bf16 v[56:71], v[8:11], a[128:131], v[56:71]
    s_add_u32 s51, s65, 2359552
    s_add_u32 m0, s60, 40960
    s_nop 0
    buffer_load_dwordx4 v4, s[44:47], s51 offen offset:0 lds
    ds_read_b64_tr_b16 a[164:165], v3 offset:4096
    ds_read_b64_tr_b16 a[166:167], v3 offset:4608
    s_waitcnt lgkmcnt(8)
    v_mfma_f32_32x32x16_bf16 v[72:87], v[12:15], a[128:131], v[72:87]
    ds_read_b64_tr_b16 v[8:9], v2 offset:6144
    ds_read_b64_tr_b16 v[10:11], v2 offset:6656
    s_waitcnt lgkmcnt(8)
    v_mfma_f32_32x32x16_bf16 v[56:71], v[16:19], a[132:135], v[56:71]
    s_add_u32 s51, s65, 2456832
    buffer_load_dwordx4 v4, s[44:47], s51 offen offset:1024 lds
    ds_read_b64_tr_b16 v[12:13], v3 offset:6144
    ds_read_b64_tr_b16 v[14:15], v3 offset:6656
    s_waitcnt lgkmcnt(8)
    v_mfma_f32_32x32x16_bf16 v[72:87], v[20:23], a[132:135], v[72:87]
    s_waitcnt lgkmcnt(6)
    v_mfma_f32_32x32x16_bf16 v[56:71], a[160:163], a[136:139], v[56:71]
    s_waitcnt lgkmcnt(0)
    s_waitcnt vmcnt(8)
    s_barrier
    ds_read_b64_tr_b16 v[16:17], v2 offset:8192
    ds_read_b64_tr_b16 v[18:19], v2 offset:8704
    ds_read_b64_tr_b16 v[20:21], v3 offset:8192
    ds_read_b64_tr_b16 v[22:23], v3 offset:8704
    v_mfma_f32_32x32x16_bf16 v[72:87], a[164:167], a[136:139], v[72:87]
    ds_read_b64_tr_b16 a[160:161], v2 offset:10240
    ds_read_b64_tr_b16 a[162:163], v2 offset:10752
    v_mfma_f32_32x32x16_bf16 v[56:71], v[8:11], a[140:143], v[56:71]
    ds_read_b64_tr_b16 a[164:165], v3 offset:10240
    ds_read_b64_tr_b16 a[166:167], v3 offset:10752
    v_mfma_f32_32x32x16_bf16 v[72:87], v[12:15], a[140:143], v[72:87]
    ds_read_b64_tr_b16 v[8:9], v2 offset:12288
    ds_read_b64_tr_b16 v[10:11], v2 offset:12800
    s_waitcnt lgkmcnt(8)
    v_mfma_f32_32x32x16_bf16 v[56:71], v[16:19], a[144:147], v[56:71]
    s_add_u32 s51, s65, 3145984
    s_add_u32 m0, s60, 0
    s_nop 0
    buffer_load_dwordx4 v4, s[44:47], s51 offen offset:0 lds
    ds_read_b64_tr_b16 v[12:13], v3 offset:12288
    ds_read_b64_tr_b16 v[14:15], v3 offset:12800
    s_waitcnt lgkmcnt(8)
    v_mfma_f32_32x32x16_bf16 v[72:87], v[20:23], a[144:147], v[72:87]
    ds_read_b64_tr_b16 v[16:17], v2 offset:14336
    ds_read_b64_tr_b16 v[18:19], v2 offset:14848
    s_waitcnt lgkmcnt(8)
    v_mfma_f32_32x32x16_bf16 v[56:71], a[160:163], a[148:151], v[56:71]
    s_add_u32 s51, s65, 3243264
    buffer_load_dwordx4 v4, s[44:47], s51 offen offset:1024 lds
    ds_read_b64_tr_b16 v[20:21], v3 offset:14336
    ds_read_b64_tr_b16 v[22:23], v3 offset:14848
    s_waitcnt lgkmcnt(8)
    v_mfma_f32_32x32x16_bf16 v[72:87], a[164:167], a[148:151], v[72:87]
    s_waitcnt lgkmcnt(6)
    v_mfma_f32_32x32x16_bf16 v[56:71], v[8:11], a[152:155], v[56:71]
    s_waitcnt lgkmcnt(0)
    s_waitcnt vmcnt(8)
    s_barrier
    ds_read_b64_tr_b16 a[160:161], v2 offset:16384
    ds_read_b64_tr_b16 a[162:163], v2 offset:16896
    ds_read_b64_tr_b16 a[164:165], v3 offset:16384
    ds_read_b64_tr_b16 a[166:167], v3 offset:16896
    v_mfma_f32_32x32x16_bf16 v[72:87], v[12:15], a[152:155], v[72:87]
    ds_read_b64_tr_b16 v[8:9], v2 offset:18432
    ds_read_b64_tr_b16 v[10:11], v2 offset:18944
    v_mfma_f32_32x32x16_bf16 v[56:71], v[16:19], a[156:159], v[56:71]
    ds_read_b64_tr_b16 v[12:13], v3 offset:18432
    ds_read_b64_tr_b16 v[14:15], v3 offset:18944
    v_mfma_f32_32x32x16_bf16 v[72:87], v[20:23], a[156:159], v[72:87]
    ds_read_b64_tr_b16 v[16:17], v2 offset:20480
    ds_read_b64_tr_b16 v[18:19], v2 offset:20992
    s_waitcnt lgkmcnt(8)
    v_mfma_f32_32x32x16_bf16 v[24:39], a[160:163], a[0:3], 0
    s_nop 4
    v_mul_f32 v56, s53, v56
    v_mul_f32 v57, s53, v57
    v_mul_f32 v58, s53, v58
    v_mul_f32 v59, s53, v59
    v_mul_f32 v60, s53, v60
    v_mul_f32 v61, s53, v61
    v_mul_f32 v62, s53, v62
    v_mul_f32 v63, s53, v63
    v_cvt_pk_bf16_f32 v56, v56, v57
    v_cvt_pk_bf16_f32 v57, v58, v59
    v_cvt_pk_bf16_f32 v58, v60, v61
    ds_read_b64_tr_b16 v[20:21], v3 offset:20480
    ds_read_b64_tr_b16 v[22:23], v3 offset:20992
    s_waitcnt lgkmcnt(8)
    v_mfma_f32_32x32x16_bf16 v[40:55], a[164:167], a[0:3], 0
    v_cvt_pk_bf16_f32 v59, v62, v63
    ds_write_b128 v5, v[56:59] offset:4096
    v_mul_f32 v64, s53, v64
    v_mul_f32 v65, s53, v65
    v_mul_f32 v66, s53, v66
    v_mul_f32 v67, s53, v67
    v_mul_f32 v68, s53, v68
    v_mul_f32 v69, s53, v69
    v_mul_f32 v70, s53, v70
    v_mul_f32 v71, s53, v71
    v_cvt_pk_bf16_f32 v64, v64, v65
    ds_read_b64_tr_b16 a[160:161], v2 offset:22528
    ds_read_b64_tr_b16 a[162:163], v2 offset:23040
    s_waitcnt lgkmcnt(9)
    v_mfma_f32_32x32x16_bf16 v[24:39], v[8:11], a[4:7], v[24:39]
    v_cvt_pk_bf16_f32 v65, v66, v67
    v_cvt_pk_bf16_f32 v66, v68, v69
    v_cvt_pk_bf16_f32 v67, v70, v71
    ds_write_b128 v5, v[64:67] offset:5120
    s_add_u32 s51, s65, 3932416
    s_add_u32 m0, s60, 8192
    s_nop 0
    buffer_load_dwordx4 v4, s[44:47], s51 offen offset:0 lds
    v_mul_f32 v72, s53, v72
    v_mul_f32 v73, s53, v73
    v_mul_f32 v74, s53, v74
    v_mul_f32 v75, s53, v75
    v_mul_f32 v76, s53, v76
    v_mul_f32 v77, s53, v77
    ds_read_b64_tr_b16 a[164:165], v3 offset:22528
    ds_read_b64_tr_b16 a[166:167], v3 offset:23040
    s_waitcnt lgkmcnt(10)
    v_mfma_f32_32x32x16_bf16 v[40:55], v[12:15], a[4:7], v[40:55]
    v_mul_f32 v78, s53, v78
    v_mul_f32 v79, s53, v79
    v_cvt_pk_bf16_f32 v72, v72, v73
    v_cvt_pk_bf16_f32 v73, v74, v75
    v_cvt_pk_bf16_f32 v74, v76, v77
    v_cvt_pk_bf16_f32 v75, v78, v79
    ds_write_b128 v5, v[72:75] offset:6144
    v_mul_f32 v80, s53, v80
    v_mul_f32 v81, s53, v81
    v_mul_f32 v82, s53, v82
    v_mul_f32 v83, s53, v83
    s_waitcnt lgkmcnt(9)
    v_mfma_f32_32x32x16_bf16 v[24:39], v[16:19], a[8:11], v[24:39]
    v_mul_f32 v84, s53, v84
    v_mul_f32 v85, s53, v85
    v_mul_f32 v86, s53, v86
    v_mul_f32 v87, s53, v87
    v_cvt_pk_bf16_f32 v80, v80, v81
    v_cvt_pk_bf16_f32 v81, v82, v83
    v_cvt_pk_bf16_f32 v82, v84, v85
    v_cvt_pk_bf16_f32 v83, v86, v87
    ds_write_b128 v5, v[80:83] offset:7168
    s_add_u32 s51, s65, 4029696
    buffer_load_dwordx4 v4, s[44:47], s51 offen offset:1024 lds
    s_waitcnt lgkmcnt(0)
    s_waitcnt vmcnt(8)
    s_barrier
    ds_read_b64_tr_b16 v[8:9], v2 offset:24576
    ds_read_b64_tr_b16 v[10:11], v2 offset:25088
    ds_read_b64_tr_b16 v[12:13], v3 offset:24576
    ds_read_b64_tr_b16 v[14:15], v3 offset:25088
    v_mfma_f32_32x32x16_bf16 v[40:55], v[20:23], a[8:11], v[40:55]
    ds_read_b64_tr_b16 v[16:17], v2 offset:26624
    ds_read_b64_tr_b16 v[18:19], v2 offset:27136
    v_mfma_f32_32x32x16_bf16 v[24:39], a[160:163], a[12:15], v[24:39]
    ds_read_b64_tr_b16 v[20:21], v3 offset:26624
    ds_read_b64_tr_b16 v[22:23], v3 offset:27136
    v_mfma_f32_32x32x16_bf16 v[40:55], a[164:167], a[12:15], v[40:55]
    ds_read_b64_tr_b16 a[160:161], v2 offset:28672
    ds_read_b64_tr_b16 a[162:163], v2 offset:29184
    s_waitcnt lgkmcnt(8)
    v_mfma_f32_32x32x16_bf16 v[24:39], v[8:11], a[16:19], v[24:39]
    s_add_u32 s51, s65, 4718848
    s_add_u32 m0, s60, 16384
    s_nop 0
    buffer_load_dwordx4 v4, s[44:47], s51 offen offset:0 lds
    ds_read_b64_tr_b16 a[164:165], v3 offset:28672
    ds_read_b64_tr_b16 a[166:167], v3 offset:29184
    s_waitcnt lgkmcnt(8)
    v_mfma_f32_32x32x16_bf16 v[40:55], v[12:15], a[16:19], v[40:55]
    ds_read_b64_tr_b16 v[8:9], v2 offset:30720
    ds_read_b64_tr_b16 v[10:11], v2 offset:31232
    s_waitcnt lgkmcnt(8)
    v_mfma_f32_32x32x16_bf16 v[24:39], v[16:19], a[20:23], v[24:39]
    s_add_u32 s51, s65, 4816128
    buffer_load_dwordx4 v4, s[44:47], s51 offen offset:1024 lds
    ds_read_b64_tr_b16 v[12:13], v3 offset:30720
    ds_read_b64_tr_b16 v[14:15], v3 offset:31232
    s_waitcnt lgkmcnt(8)
    v_mfma_f32_32x32x16_bf16 v[40:55], v[20:23], a[20:23], v[40:55]
    s_waitcnt lgkmcnt(6)
    v_mfma_f32_32x32x16_bf16 v[24:39], a[160:163], a[24:27], v[24:39]
    s_waitcnt lgkmcnt(0)
    s_waitcnt vmcnt(8)
    s_barrier
    ds_read_b64_tr_b16 v[16:17], v2 offset:32768
    ds_read_b64_tr_b16 v[18:19], v2 offset:33280
    ds_read_b64_tr_b16 v[20:21], v3 offset:32768
    ds_read_b64_tr_b16 v[22:23], v3 offset:33280
    v_mfma_f32_32x32x16_bf16 v[40:55], a[164:167], a[24:27], v[40:55]
    ds_read_b64_tr_b16 a[160:161], v2 offset:34816
    ds_read_b64_tr_b16 a[162:163], v2 offset:35328
    v_mfma_f32_32x32x16_bf16 v[24:39], v[8:11], a[28:31], v[24:39]
    ds_read_b64_tr_b16 a[164:165], v3 offset:34816
    ds_read_b64_tr_b16 a[166:167], v3 offset:35328
    v_mfma_f32_32x32x16_bf16 v[40:55], v[12:15], a[28:31], v[40:55]
    ds_read_b64_tr_b16 v[8:9], v2 offset:36864
    ds_read_b64_tr_b16 v[10:11], v2 offset:37376
    s_waitcnt lgkmcnt(8)
    v_mfma_f32_32x32x16_bf16 v[24:39], v[16:19], a[32:35], v[24:39]
    s_add_u32 s51, s65, 5505280
    s_add_u32 m0, s60, 24576
    s_nop 0
    buffer_load_dwordx4 v4, s[44:47], s51 offen offset:0 lds
    ds_read_b64_tr_b16 v[12:13], v3 offset:36864
    ds_read_b64_tr_b16 v[14:15], v3 offset:37376
    s_waitcnt lgkmcnt(8)
    v_mfma_f32_32x32x16_bf16 v[40:55], v[20:23], a[32:35], v[40:55]
    ds_read_b64_tr_b16 v[16:17], v2 offset:38912
    ds_read_b64_tr_b16 v[18:19], v2 offset:39424
    s_waitcnt lgkmcnt(8)
    v_mfma_f32_32x32x16_bf16 v[24:39], a[160:163], a[36:39], v[24:39]
    s_add_u32 s51, s65, 5602560
    buffer_load_dwordx4 v4, s[44:47], s51 offen offset:1024 lds
    ds_read_b64_tr_b16 v[20:21], v3 offset:38912
    ds_read_b64_tr_b16 v[22:23], v3 offset:39424
    s_waitcnt lgkmcnt(8)
    v_mfma_f32_32x32x16_bf16 v[40:55], a[164:167], a[36:39], v[40:55]
    s_waitcnt lgkmcnt(6)
    v_mfma_f32_32x32x16_bf16 v[24:39], v[8:11], a[40:43], v[24:39]
    s_waitcnt lgkmcnt(0)
    s_waitcnt vmcnt(8)
    s_barrier
    ds_read_b64_tr_b16 a[160:161], v2 offset:40960
    ds_read_b64_tr_b16 a[162:163], v2 offset:41472
    ds_read_b64_tr_b16 a[164:165], v3 offset:40960
    ds_read_b64_tr_b16 a[166:167], v3 offset:41472
    v_mfma_f32_32x32x16_bf16 v[40:55], v[12:15], a[40:43], v[40:55]
    ds_read_b64_tr_b16 v[8:9], v2 offset:43008
    ds_read_b64_tr_b16 v[10:11], v2 offset:43520
    v_mfma_f32_32x32x16_bf16 v[24:39], v[16:19], a[44:47], v[24:39]
    ds_read_b64_tr_b16 v[12:13], v3 offset:43008
    ds_read_b64_tr_b16 v[14:15], v3 offset:43520
    v_mfma_f32_32x32x16_bf16 v[40:55], v[20:23], a[44:47], v[40:55]
    ds_read_b64_tr_b16 v[16:17], v2 offset:45056
    ds_read_b64_tr_b16 v[18:19], v2 offset:45568
    s_waitcnt lgkmcnt(8)
    v_mfma_f32_32x32x16_bf16 v[24:39], a[160:163], a[48:51], v[24:39]
    s_add_u32 s51, s65, 6291712
    s_add_u32 m0, s60, 32768
    s_nop 0
    buffer_load_dwordx4 v4, s[44:47], s51 offen offset:0 lds
    ds_read_b64_tr_b16 v[20:21], v3 offset:45056
    ds_read_b64_tr_b16 v[22:23], v3 offset:45568
    s_waitcnt lgkmcnt(8)
    v_mfma_f32_32x32x16_bf16 v[40:55], a[164:167], a[48:51], v[40:55]
    ds_read_b64_tr_b16 a[160:161], v2 offset:47104
    ds_read_b64_tr_b16 a[162:163], v2 offset:47616
    s_waitcnt lgkmcnt(8)
    v_mfma_f32_32x32x16_bf16 v[24:39], v[8:11], a[52:55], v[24:39]
    s_add_u32 s51, s65, 6388992
    buffer_load_dwordx4 v4, s[44:47], s51 offen offset:1024 lds
    ds_read_b64_tr_b16 a[164:165], v3 offset:47104
    ds_read_b64_tr_b16 a[166:167], v3 offset:47616
    s_waitcnt lgkmcnt(8)
    v_mfma_f32_32x32x16_bf16 v[40:55], v[12:15], a[52:55], v[40:55]
    s_waitcnt lgkmcnt(6)
    v_mfma_f32_32x32x16_bf16 v[24:39], v[16:19], a[56:59], v[24:39]
    s_waitcnt lgkmcnt(0)
    s_waitcnt vmcnt(8)
    s_barrier
    ds_read_b64_tr_b16 v[8:9], v2 offset:0
    ds_read_b64_tr_b16 v[10:11], v2 offset:512
    ds_read_b64_tr_b16 v[12:13], v3 offset:0
    ds_read_b64_tr_b16 v[14:15], v3 offset:512
    v_mfma_f32_32x32x16_bf16 v[40:55], v[20:23], a[56:59], v[40:55]
    ds_read_b64_tr_b16 v[16:17], v2 offset:2048
    ds_read_b64_tr_b16 v[18:19], v2 offset:2560
    v_mfma_f32_32x32x16_bf16 v[24:39], a[160:163], a[60:63], v[24:39]
    ds_read_b64_tr_b16 v[20:21], v3 offset:2048
    ds_read_b64_tr_b16 v[22:23], v3 offset:2560
    v_mfma_f32_32x32x16_bf16 v[40:55], a[164:167], a[60:63], v[40:55]
    ds_read_b64_tr_b16 a[160:161], v2 offset:4096
    ds_read_b64_tr_b16 a[162:163], v2 offset:4608
    s_waitcnt lgkmcnt(8)
    v_mfma_f32_32x32x16_bf16 v[24:39], v[8:11], a[64:67], v[24:39]
    s_add_u32 s51, s65, 7078144
    s_add_u32 m0, s60, 40960
    s_nop 0
    buffer_load_dwordx4 v4, s[44:47], s51 offen offset:0 lds
    ds_read_b64_tr_b16 a[164:165], v3 offset:4096
    ds_read_b64_tr_b16 a[166:167], v3 offset:4608
    s_waitcnt lgkmcnt(8)
    v_mfma_f32_32x32x16_bf16 v[40:55], v[12:15], a[64:67], v[40:55]
    ds_read_b64_tr_b16 v[8:9], v2 offset:6144
    ds_read_b64_tr_b16 v[10:11], v2 offset:6656
    s_waitcnt lgkmcnt(8)
    v_mfma_f32_32x32x16_bf16 v[24:39], v[16:19], a[68:71], v[24:39]
    s_add_u32 s51, s65, 7175424
    buffer_load_dwordx4 v4, s[44:47], s51 offen offset:1024 lds
    ds_read_b64_tr_b16 v[12:13], v3 offset:6144
    ds_read_b64_tr_b16 v[14:15], v3 offset:6656
    s_waitcnt lgkmcnt(8)
    v_mfma_f32_32x32x16_bf16 v[40:55], v[20:23], a[68:71], v[40:55]
    s_waitcnt lgkmcnt(6)
    v_mfma_f32_32x32x16_bf16 v[24:39], a[160:163], a[72:75], v[24:39]
    s_waitcnt lgkmcnt(0)
    s_waitcnt vmcnt(8)
    s_barrier
    ds_read_b64_tr_b16 v[16:17], v2 offset:8192
    ds_read_b64_tr_b16 v[18:19], v2 offset:8704
    ds_read_b64_tr_b16 v[20:21], v3 offset:8192
    ds_read_b64_tr_b16 v[22:23], v3 offset:8704
    v_mfma_f32_32x32x16_bf16 v[40:55], a[164:167], a[72:75], v[40:55]
    ds_read_b64_tr_b16 a[160:161], v2 offset:10240
    ds_read_b64_tr_b16 a[162:163], v2 offset:10752
    v_mfma_f32_32x32x16_bf16 v[24:39], v[8:11], a[76:79], v[24:39]
    ds_read_b64_tr_b16 a[164:165], v3 offset:10240
    ds_read_b64_tr_b16 a[166:167], v3 offset:10752
    v_mfma_f32_32x32x16_bf16 v[40:55], v[12:15], a[76:79], v[40:55]
    ds_read_b64_tr_b16 v[8:9], v2 offset:12288
    ds_read_b64_tr_b16 v[10:11], v2 offset:12800
    s_waitcnt lgkmcnt(8)
    v_mfma_f32_32x32x16_bf16 v[24:39], v[16:19], a[80:83], v[24:39]
    s_add_u32 s51, s69, 0
    s_add_u32 m0, s60, 0
    s_nop 0
    buffer_load_dwordx4 v4, s[44:47], s51 offen offset:0 lds
    ds_read_b64_tr_b16 v[12:13], v3 offset:12288
    ds_read_b64_tr_b16 v[14:15], v3 offset:12800
    s_waitcnt lgkmcnt(8)
    v_mfma_f32_32x32x16_bf16 v[40:55], v[20:23], a[80:83], v[40:55]
    ds_read_b64_tr_b16 v[16:17], v2 offset:14336
    ds_read_b64_tr_b16 v[18:19], v2 offset:14848
    s_waitcnt lgkmcnt(8)
    v_mfma_f32_32x32x16_bf16 v[24:39], a[160:163], a[84:87], v[24:39]
    s_add_u32 s51, s69, 97280
    buffer_load_dwordx4 v4, s[44:47], s51 offen offset:1024 lds
    ds_read_b64_tr_b16 v[20:21], v3 offset:14336
    ds_read_b64_tr_b16 v[22:23], v3 offset:14848
    s_waitcnt lgkmcnt(8)
    v_mfma_f32_32x32x16_bf16 v[40:55], a[164:167], a[84:87], v[40:55]
    s_waitcnt lgkmcnt(6)
    v_mfma_f32_32x32x16_bf16 v[24:39], v[8:11], a[88:91], v[24:39]
    s_waitcnt lgkmcnt(0)
    s_waitcnt vmcnt(8)
    s_barrier
    ds_read_b64_tr_b16 a[160:161], v2 offset:16384
    ds_read_b64_tr_b16 a[162:163], v2 offset:16896
    ds_read_b64_tr_b16 a[164:165], v3 offset:16384
    ds_read_b64_tr_b16 a[166:167], v3 offset:16896
    v_mfma_f32_32x32x16_bf16 v[40:55], v[12:15], a[88:91], v[40:55]
    ds_read_b64_tr_b16 v[8:9], v2 offset:18432
    ds_read_b64_tr_b16 v[10:11], v2 offset:18944
    v_mfma_f32_32x32x16_bf16 v[24:39], v[16:19], a[92:95], v[24:39]
    ds_read_b64_tr_b16 v[12:13], v3 offset:18432
    ds_read_b64_tr_b16 v[14:15], v3 offset:18944
    v_mfma_f32_32x32x16_bf16 v[40:55], v[20:23], a[92:95], v[40:55]
    ds_read_b64_tr_b16 v[16:17], v2 offset:20480
    ds_read_b64_tr_b16 v[18:19], v2 offset:20992
    s_waitcnt lgkmcnt(8)
    v_mfma_f32_32x32x16_bf16 v[24:39], a[160:163], a[96:99], v[24:39]
    s_add_u32 s51, s69, 786432
    s_add_u32 m0, s60, 8192
    s_nop 0
    buffer_load_dwordx4 v4, s[44:47], s51 offen offset:0 lds
    ds_read_b64_tr_b16 v[20:21], v3 offset:20480
    ds_read_b64_tr_b16 v[22:23], v3 offset:20992
    s_waitcnt lgkmcnt(8)
    v_mfma_f32_32x32x16_bf16 v[40:55], a[164:167], a[96:99], v[40:55]
    ds_read_b64_tr_b16 a[160:161], v2 offset:22528
    ds_read_b64_tr_b16 a[162:163], v2 offset:23040
    s_waitcnt lgkmcnt(8)
    v_mfma_f32_32x32x16_bf16 v[24:39], v[8:11], a[100:103], v[24:39]
    s_add_u32 s51, s69, 883712
    buffer_load_dwordx4 v4, s[44:47], s51 offen offset:1024 lds
    ds_read_b64_tr_b16 a[164:165], v3 offset:22528
    ds_read_b64_tr_b16 a[166:167], v3 offset:23040
    s_waitcnt lgkmcnt(8)
    v_mfma_f32_32x32x16_bf16 v[40:55], v[12:15], a[100:103], v[40:55]
    s_waitcnt lgkmcnt(6)
    v_mfma_f32_32x32x16_bf16 v[24:39], v[16:19], a[104:107], v[24:39]
    s_waitcnt lgkmcnt(0)
    s_waitcnt vmcnt(8)
    s_barrier
    ds_read_b64_tr_b16 v[8:9], v2 offset:24576
    ds_read_b64_tr_b16 v[10:11], v2 offset:25088
    ds_read_b64_tr_b16 v[12:13], v3 offset:24576
    ds_read_b64_tr_b16 v[14:15], v3 offset:25088
    v_mfma_f32_32x32x16_bf16 v[40:55], v[20:23], a[104:107], v[40:55]
    ds_read_b64_tr_b16 v[16:17], v2 offset:26624
    ds_read_b64_tr_b16 v[18:19], v2 offset:27136
    v_mfma_f32_32x32x16_bf16 v[24:39], a[160:163], a[108:111], v[24:39]
    ds_read_b64_tr_b16 v[20:21], v3 offset:26624
    ds_read_b64_tr_b16 v[22:23], v3 offset:27136
    v_mfma_f32_32x32x16_bf16 v[40:55], a[164:167], a[108:111], v[40:55]
    ds_read_b64_tr_b16 a[160:161], v2 offset:28672
    ds_read_b64_tr_b16 a[162:163], v2 offset:29184
    s_waitcnt lgkmcnt(8)
    v_mfma_f32_32x32x16_bf16 v[24:39], v[8:11], a[112:115], v[24:39]
    s_add_u32 s51, s69, 1572864
    s_add_u32 m0, s60, 16384
    s_nop 0
    buffer_load_dwordx4 v4, s[44:47], s51 offen offset:0 lds
    ds_read_b64_tr_b16 a[164:165], v3 offset:28672
    ds_read_b64_tr_b16 a[166:167], v3 offset:29184
    s_waitcnt lgkmcnt(8)
    v_mfma_f32_32x32x16_bf16 v[40:55], v[12:15], a[112:115], v[40:55]
    ds_read_b64_tr_b16 v[8:9], v2 offset:30720
    ds_read_b64_tr_b16 v[10:11], v2 offset:31232
    s_waitcnt lgkmcnt(8)
    v_mfma_f32_32x32x16_bf16 v[24:39], v[16:19], a[116:119], v[24:39]
    s_add_u32 s51, s69, 1670144
    buffer_load_dwordx4 v4, s[44:47], s51 offen offset:1024 lds
    ds_read_b64_tr_b16 v[12:13], v3 offset:30720
    ds_read_b64_tr_b16 v[14:15], v3 offset:31232
    s_waitcnt lgkmcnt(8)
    v_mfma_f32_32x32x16_bf16 v[40:55], v[20:23], a[116:119], v[40:55]
    s_waitcnt lgkmcnt(6)
    v_mfma_f32_32x32x16_bf16 v[24:39], a[160:163], a[120:123], v[24:39]
    s_waitcnt lgkmcnt(0)
    s_waitcnt vmcnt(8)
    s_barrier
    ds_read_b64_tr_b16 v[16:17], v2 offset:32768
    ds_read_b64_tr_b16 v[18:19], v2 offset:33280
    ds_read_b64_tr_b16 v[20:21], v3 offset:32768
    ds_read_b64_tr_b16 v[22:23], v3 offset:33280
    v_mfma_f32_32x32x16_bf16 v[40:55], a[164:167], a[120:123], v[40:55]
    ds_read_b64_tr_b16 a[160:161], v2 offset:34816
    ds_read_b64_tr_b16 a[162:163], v2 offset:35328
    v_mfma_f32_32x32x16_bf16 v[24:39], v[8:11], a[124:127], v[24:39]
    ds_read_b64_tr_b16 a[164:165], v3 offset:34816
    ds_read_b64_tr_b16 a[166:167], v3 offset:35328
    v_mfma_f32_32x32x16_bf16 v[40:55], v[12:15], a[124:127], v[40:55]
    ds_read_b64_tr_b16 v[8:9], v2 offset:36864
    ds_read_b64_tr_b16 v[10:11], v2 offset:37376
    s_waitcnt lgkmcnt(8)
    v_mfma_f32_32x32x16_bf16 v[24:39], v[16:19], a[128:131], v[24:39]
    s_add_u32 s51, s69, 2359296
    s_add_u32 m0, s60, 24576
    s_nop 0
    buffer_load_dwordx4 v4, s[44:47], s51 offen offset:0 lds
    ds_read_b64_tr_b16 v[12:13], v3 offset:36864
    ds_read_b64_tr_b16 v[14:15], v3 offset:37376
    s_waitcnt lgkmcnt(8)
    v_mfma_f32_32x32x16_bf16 v[40:55], v[20:23], a[128:131], v[40:55]
    ds_read_b64_tr_b16 v[16:17], v2 offset:38912
    ds_read_b64_tr_b16 v[18:19], v2 offset:39424
    s_waitcnt lgkmcnt(8)
    v_mfma_f32_32x32x16_bf16 v[24:39], a[160:163], a[132:135], v[24:39]
    s_add_u32 s51, s69, 2456576
    buffer_load_dwordx4 v4, s[44:47], s51 offen offset:1024 lds
    ds_read_b64_tr_b16 v[20:21], v3 offset:38912
    ds_read_b64_tr_b16 v[22:23], v3 offset:39424
    s_waitcnt lgkmcnt(8)
    v_mfma_f32_32x32x16_bf16 v[40:55], a[164:167], a[132:135], v[40:55]
    s_waitcnt lgkmcnt(6)
    v_mfma_f32_32x32x16_bf16 v[24:39], v[8:11], a[136:139], v[24:39]
    s_waitcnt lgkmcnt(0)
    s_waitcnt vmcnt(8)
    s_barrier
    ds_read_b64_tr_b16 a[160:161], v2 offset:40960
    ds_read_b64_tr_b16 a[162:163], v2 offset:41472
    ds_read_b64_tr_b16 a[164:165], v3 offset:40960
    ds_read_b64_tr_b16 a[166:167], v3 offset:41472
    v_mfma_f32_32x32x16_bf16 v[40:55], v[12:15], a[136:139], v[40:55]
    ds_read_b64_tr_b16 v[8:9], v2 offset:43008
    ds_read_b64_tr_b16 v[10:11], v2 offset:43520
    v_mfma_f32_32x32x16_bf16 v[24:39], v[16:19], a[140:143], v[24:39]
    ds_read_b64_tr_b16 v[12:13], v3 offset:43008
    ds_read_b64_tr_b16 v[14:15], v3 offset:43520
    v_mfma_f32_32x32x16_bf16 v[40:55], v[20:23], a[140:143], v[40:55]
    ds_read_b64_tr_b16 v[16:17], v2 offset:45056
    ds_read_b64_tr_b16 v[18:19], v2 offset:45568
    s_waitcnt lgkmcnt(8)
    v_mfma_f32_32x32x16_bf16 v[24:39], a[160:163], a[144:147], v[24:39]
    s_add_u32 s51, s69, 3145728
    s_add_u32 m0, s60, 32768
    s_nop 0
    buffer_load_dwordx4 v4, s[44:47], s51 offen offset:0 lds
    ds_read_b64_tr_b16 v[20:21], v3 offset:45056
    ds_read_b64_tr_b16 v[22:23], v3 offset:45568
    s_waitcnt lgkmcnt(8)
    v_mfma_f32_32x32x16_bf16 v[40:55], a[164:167], a[144:147], v[40:55]
    ds_read_b64_tr_b16 a[160:161], v2 offset:47104
    ds_read_b64_tr_b16 a[162:163], v2 offset:47616
    s_waitcnt lgkmcnt(8)
    v_mfma_f32_32x32x16_bf16 v[24:39], v[8:11], a[148:151], v[24:39]
    s_add_u32 s51, s69, 3243008
    buffer_load_dwordx4 v4, s[44:47], s51 offen offset:1024 lds
    ds_read_b64_tr_b16 a[164:165], v3 offset:47104
    ds_read_b64_tr_b16 a[166:167], v3 offset:47616
    s_waitcnt lgkmcnt(8)
    v_mfma_f32_32x32x16_bf16 v[40:55], v[12:15], a[148:151], v[40:55]
    s_waitcnt lgkmcnt(6)
    v_mfma_f32_32x32x16_bf16 v[24:39], v[16:19], a[152:155], v[24:39]
    s_waitcnt lgkmcnt(0)
    s_barrier
    v_mfma_f32_32x32x16_bf16 v[40:55], v[20:23], a[152:155], v[40:55]
    v_mfma_f32_32x32x16_bf16 v[24:39], a[160:163], a[156:159], v[24:39]
    v_mfma_f32_32x32x16_bf16 v[40:55], a[164:167], a[156:159], v[40:55]
    s_nop 7
    s_nop 2
    v_mul_f32 v24, s53, v24
    v_mul_f32 v25, s53, v25
    v_mul_f32 v26, s53, v26
    v_mul_f32 v27, s53, v27
    v_mul_f32 v28, s53, v28
    v_mul_f32 v29, s53, v29
    v_mul_f32 v30, s53, v30
    v_mul_f32 v31, s53, v31
    v_cvt_pk_bf16_f32 v24, v24, v25
    v_cvt_pk_bf16_f32 v25, v26, v27
    v_cvt_pk_bf16_f32 v26, v28, v29
    v_cvt_pk_bf16_f32 v27, v30, v31
    ds_write_b128 v5, v[24:27] offset:8192
    v_mul_f32 v32, s53, v32
    v_mul_f32 v33, s53, v33
    v_mul_f32 v34, s53, v34
    v_mul_f32 v35, s53, v35
    v_mul_f32 v36, s53, v36
    v_mul_f32 v37, s53, v37
    v_mul_f32 v38, s53, v38
    v_mul_f32 v39, s53, v39
    v_cvt_pk_bf16_f32 v32, v32, v33
    v_cvt_pk_bf16_f32 v33, v34, v35
    v_cvt_pk_bf16_f32 v34, v36, v37
    v_cvt_pk_bf16_f32 v35, v38, v39
    ds_write_b128 v5, v[32:35] offset:9216
    v_mul_f32 v40, s53, v40
    v_mul_f32 v41, s53, v41
    v_mul_f32 v42, s53, v42
    v_mul_f32 v43, s53, v43
    v_mul_f32 v44, s53, v44
    v_mul_f32 v45, s53, v45
    v_mul_f32 v46, s53, v46
    v_mul_f32 v47, s53, v47
    v_cvt_pk_bf16_f32 v40, v40, v41
    v_cvt_pk_bf16_f32 v41, v42, v43
    v_cvt_pk_bf16_f32 v42, v44, v45
    v_cvt_pk_bf16_f32 v43, v46, v47
    ds_write_b128 v5, v[40:43] offset:10240
    v_mul_f32 v48, s53, v48
    v_mul_f32 v49, s53, v49
    v_mul_f32 v50, s53, v50
    v_mul_f32 v51, s53, v51
    v_mul_f32 v52, s53, v52
    v_mul_f32 v53, s53, v53
    v_mul_f32 v54, s53, v54
    v_mul_f32 v55, s53, v55
    v_cvt_pk_bf16_f32 v48, v48, v49
    v_cvt_pk_bf16_f32 v49, v50, v51
    v_cvt_pk_bf16_f32 v50, v52, v53
    v_cvt_pk_bf16_f32 v51, v54, v55
    ds_write_b128 v5, v[48:51] offset:11264
    s_waitcnt lgkmcnt(0)
    s_barrier
    s_mov_b32 s65, s69
    s_add_u32 s69, s69, 1536
    s_add_u32 s50, s50, 1
    s_cmp_eq_u32 s50, 3
    s_cselect_b32 s69, 0x7f000000, s69
    s_cmp_lt_u32 s50, 4
    s_cbranch_scc1 attn_GLOOP
    s_waitcnt vmcnt(0)
    s_bfe_u32 s51, s2, 0x10002
    s_lshl_b32 s51, s51, 3
    s_lshr_b32 s52, s2, 5
    s_add_u32 s51, s51, s52
    s_lshl_b32 s51, s51, 2
    s_and_b32 s52, s2, 3
    s_add_u32 s51, s51, s52
    s_lshl_b32 s52, s51, 2
    v_mov_b32 v24, s52
    s_lshl_b32 s52, s51, 7
    v_mov_b32 v25, s52
    s_mov_b32 s44, s16
    s_mov_b32 s45, s17
    s_mov_b32 s46, 7864320
    s_mov_b32 s47, 0x00020000
    v_lshrrev_b32 v32, 2, v0
    v_mul_u32_u24 v32, 1280, v32
    v_and_b32 v33, 3, v0
    v_min_u32 v33, 2, v33
    v_lshl_add_u32 v32, v33, 7, v32
    s_bfe_u32 s51, s2, 0x10001
    s_lshl_b32 s51, s51, 4
    s_and_b32 s52, s2, 1
    s_lshl_b32 s52, s52, 1
    s_add_u32 s51, s51, s52
    s_lshl_b32 s52, s22, 2
    s_add_u32 s51, s51, s52
    s_mul_i32 s51, s51, 192
    s_lshr_b32 s52, s2, 5
    s_lshl_b32 s52, s52, 4
    s_add_u32 s51, s51, s52
    s_mul_i32 s51, s51, 1280
    s_bfe_u32 s52, s2, 0x20003
    s_mul_i32 s52, s52, 320
    s_andn2_b32 s52, s52, 127
    s_add_u32 s51, s51, s52
    v_add_u32 v32, s51, v32
    s_barrier
    s_barrier
    s_barrier
    s_barrier
    s_barrier
    v_mov_b32 v7, 3
    s_mov_b64 exec, 1
    buffer_store_dword v7, v1, s[24:27], 0 offen sc1
    s_mov_b64 exec, -1
    s_barrier
    s_barrier
    s_barrier
    s_barrier
    s_barrier
    s_barrier
    s_barrier
    s_barrier
    s_barrier
    s_barrier
    s_barrier
    s_barrier
attn_HS:
    buffer_load_dword v26, v24, s[84:87], 0 offen sc1
    s_waitcnt vmcnt(0)
    v_readfirstlane_b32 s52, v26
    s_nop 3
    s_cmp_ge_u32 s52, 0x400
    s_cbranch_scc0 attn_HS
    s_barrier
    s_barrier
    s_mov_b32 s51, 0
    buffer_load_dword v34, v32, s[44:47], s51 offen
    s_mov_b32 s51, 163840
    buffer_load_dword v35, v32, s[44:47], s51 offen
    s_mov_b32 s51, 327680
    buffer_load_dword v36, v32, s[44:47], s51 offen
    s_barrier
    s_barrier
    s_barrier
    s_barrier
    s_barrier
    s_barrier
    s_barrier
    s_barrier
    s_barrier
    s_barrier
    s_barrier
    s_barrier
    s_barrier
attn_F3:
    buffer_load_dwordx4 v[28:31], v25, s[24:27], 0 offen sc1
    s_waitcnt vmcnt(0)
    v_min_u32 v28, v28, v29
    v_min_u32 v30, v30, v31
    v_min_u32 v28, v28, v30
    s_nop 1
    v_readfirstlane_b32 s52, v28
    s_nop 3
    s_cmp_ge_u32 s52, 3
    s_cbranch_scc0 attn_F3
    s_waitcnt vmcnt(0)
attn_K2:
    s_nop 7
    s_nop 7
    s_barrier
    s_lshl_b32 s75, s23, 2
    s_add_u32 s75, s75, s22
    s_and_b32 s72, s2, 3
    s_bfe_u32 s63, s2, 0x10002
    s_bfe_u32 s62, s2, 0x20003
    s_lshr_b32 s73, s2, 5
    s_mov_b32 s24, s20
    s_mov_b32 s25, s21
    s_add_u32 s24, s24, 201326592
    s_addc_u32 s25, s25, 0
    s_mov_b32 s26, 8192
    s_mov_b32 s27, 0x00020000
    s_mov_b32 s84, s80
    s_mov_b32 s85, s81
    s_mov_b32 s86, 256
    s_mov_b32 s87, 0x00020000
    s_cmp_lg_u32 s75, 4
    s_cbranch_scc1 oproj_NOSIG
    v_mov_b32 v14, 4
    s_mov_b64 exec, 1
    buffer_store_dword v14, v1, s[24:27], 0 offen sc1
    s_mov_b64 exec, -1
oproj_NOSIG:
    s_lshl_b32 s51, s63, 3
    s_add_u32 s51, s51, s73
    s_lshl_b32 s51, s51, 2
    s_add_u32 s51, s51, s72
    s_lshl_b32 s51, s51, 7
    v_mov_b32 v1, s51
    s_mul_i32 s4, s63, 40
    s_add_u32 s4, s0, s4
    s_addc_u32 s5, s1, 0
    s_load_dwordx2 s[16:17], s[4:5], 32
    s_mul_i32 s53, s75, 20480
    v_add_u32 v56, 0, v0
    s_mov_b32 s52, 3277
    v_mul_lo_u32 v57, v56, s52
    v_lshrrev_b32 v57, 16, v57
    v_mul_u32_u24 v58, 20, v57
    v_sub_u32 v58, v56, v58
    v_mul_u32_u24 v57, 1280, v57
    v_lshl_add_u32 v3, v58, 4, v57
    v_add_u32 v3, s53, v3
    v_add_u32 v56, 64, v0
    s_mov_b32 s52, 3277
    v_mul_lo_u32 v57, v56, s52
    v_lshrrev_b32 v57, 16, v57
    v_mul_u32_u24 v58, 20, v57
    v_sub_u32 v58, v56, v58
    v_mul_u32_u24 v57, 1280, v57
    v_lshl_add_u32 v4, v58, 4, v57
    v_add_u32 v4, s53, v4
    v_subrev_u32 v4, 1024, v4
    v_add_u32 v56, 128, v0
    s_mov_b32 s52, 3277
    v_mul_lo_u32 v57, v56, s52
    v_lshrrev_b32 v57, 16, v57
    v_mul_u32_u24 v58, 20, v57
    v_sub_u32 v58, v56, v58
    v_mul_u32_u24 v57, 1280, v57
    v_lshl_add_u32 v5, v58, 4, v57
    v_add_u32 v5, s53, v5
    v_subrev_u32 v5, 2048, v5
    v_add_u32 v56, 192, v0
    s_mov_b32 s52, 3277
    v_mul_lo_u32 v57, v56, s52
    v_lshrrev_b32 v57, 16, v57
    v_mul_u32_u24 v58, 20, v57
    v_sub_u32 v58, v56, v58
    v_mul_u32_u24 v57, 1280, v57
    v_lshl_add_u32 v6, v58, 4, v57
    v_add_u32 v6, s53, v6
    v_subrev_u32 v6, 3072, v6
    v_add_u32 v56, 256, v0
    s_mov_b32 s52, 3277
    v_mul_lo_u32 v57, v56, s52
    v_lshrrev_b32 v57, 16, v57
    v_mul_u32_u24 v58, 20, v57
    v_sub_u32 v58, v56, v58
    v_mul_u32_u24 v57, 1280, v57
    v_lshl_add_u32 v7, v58, 4, v57
    v_add_u32 v7, s53, v7
    v_lshlrev_b32 v8, 4, v0
    s_waitcnt lgkmcnt(0)
    s_mov_b32 s44, s16
    s_mov_b32 s45, s17
    s_mov_b32 s46, 7864320
    s_mov_b32 s47, 0x00020000
    s_mov_b32 s32, s20
    s_mov_b32 s33, s21
    s_add_u32 s32, s32, 67108864
    s_addc_u32 s33, s33, 0
    s_mov_b32 s34, 52428800
    s_mov_b32 s35, 0x00020000
    s_lshl_b32 s61, s73, 1
    s_add_u32 s61, s61, s23
    s_lshl_b32 s51, s63, 4
    s_add_u32 s51, s51, s61
    s_mul_i32 s77, s51, 0
    s_lshl_b32 s51, s51, 5
    s_lshr_b32 s52, s72, 1
    s_lshl_b32 s52, s52, 4
    s_and_b32 s53, s72, 1
    s_lshl_b32 s53, s53, 1
    s_add_u32 s52, s52, s53
    s_add_u32 s51, s51, s52
    s_mul_i32 s70, s51, 49152
    s_mul_i32 s51, s22, 12288
    s_add_u32 s70, s70, s51
    s_add_u32 s70, s70, s77
    s_mul_i32 s71, s52, 245760
    s_mul_i32 s52, s62, 320
    s_add_u32 s71, s71, s52
    s_mul_i32 s60, s75, 5120
    s_add_u32 m0, s60, 0
    s_add_u32 s51, s71, 0
    buffer_load_dwordx4 v3, s[44:47], s51 offen offset:0 lds
    buffer_load_dwordx4 v4, s[44:47], s51 offen offset:1024 lds
    buffer_load_dwordx4 v5, s[44:47], s51 offen offset:2048 lds
    buffer_load_dwordx4 v6, s[44:47], s51 offen offset:3072 lds
    s_add_u32 m0, s60, 4096
    s_nop 0
    buffer_load_dwordx4 v7, s[44:47], s51 offen offset:0 lds
    s_add_u32 m0, s60, 40960
    s_add_u32 s51, s71, 163840
    buffer_load_dwordx4 v3, s[44:47], s51 offen offset:0 lds
    buffer_load_dwordx4 v4, s[44:47], s51 offen offset:1024 lds
    buffer_load_dwordx4 v5, s[44:47], s51 offen offset:2048 lds
    buffer_load_dwordx4 v6, s[44:47], s51 offen offset:3072 lds
    s_add_u32 m0, s60, 45056
    s_nop 0
    buffer_load_dwordx4 v7, s[44:47], s51 offen offset:0 lds
    s_add_u32 m0, s60, 81920
    s_add_u32 s51, s71, 327680
    buffer_load_dwordx4 v3, s[44:47], s51 offen offset:0 lds
    buffer_load_dwordx4 v4, s[44:47], s51 offen offset:1024 lds
    buffer_load_dwordx4 v5, s[44:47], s51 offen offset:2048 lds
    buffer_load_dwordx4 v6, s[44:47], s51 offen offset:3072 lds
    s_add_u32 m0, s60, 86016
    s_nop 0
    buffer_load_dwordx4 v7, s[44:47], s51 offen offset:0 lds
    v_lshrrev_b32 v56, 5, v0
    v_bfe_u32 v57, v0, 4, 1
    v_and_b32 v58, 3, v0
    v_bfe_u32 v59, v0, 2, 2
    v_lshl_add_u32 v59, v56, 2, v59
    v_mul_u32_u24 v59, 320, v59
    v_lshl_add_u32 v59, v58, 3, v59
    v_lshl_add_u32 v2, v57, 5, v59
    v_add_u32 v11, 40960, v2
    v_add_u32 v12, 81920, v2
    v_add_u32 v13, 122880, v2
    s_mov_b32 s36, s18
    s_mov_b32 s37, s19
    s_mov_b32 s38, 5242880
    s_mov_b32 s39, 0x00020000
    s_lshl_b32 s51, s61, 7
    s_lshl_b32 s52, s22, 5
    s_add_u32 s51, s51, s52
    v_and_b32 v60, 31, v0
    v_add_u32 v60, s51, v60
    v_mul_u32_u24 v60, 2560, v60
    v_lshl_add_u32 v60, v56, 3, v60
    s_mul_i32 s51, s63, 1280
    s_mul_i32 s52, s62, 320
    s_add_u32 s51, s51, s52
    v_add_u32 v9, s51, v60
    s_lshl_b32 s74, s63, 3
    s_add_u32 s74, s74, s73
    s_lshl_b32 s74, s74, 2
    s_add_u32 s74, s74, s62
    s_mul_i32 s51, s74, 491520
    s_add_u32 s51, s51, s60
    v_add_u32 v10, s51, v8
    v_accvgpr_write_b32 a0, 0
    v_accvgpr_write_b32 a1, 0
    v_accvgpr_write_b32 a2, 0
    v_accvgpr_write_b32 a3, 0
    v_accvgpr_write_b32 a4, 0
    v_accvgpr_write_b32 a5, 0
    v_accvgpr_write_b32 a6, 0
    v_accvgpr_write_b32 a7, 0
    v_accvgpr_write_b32 a8, 0
    v_accvgpr_write_b32 a9, 0
    v_accvgpr_write_b32 a10, 0
    v_accvgpr_write_b32 a11, 0
    v_accvgpr_write_b32 a12, 0
    v_accvgpr_write_b32 a13, 0
    v_accvgpr_write_b32 a14, 0
    v_accvgpr_write_b32 a15, 0
    v_accvgpr_write_b32 a16, 0
    v_accvgpr_write_b32 a17, 0
    v_accvgpr_write_b32 a18, 0
    v_accvgpr_write_b32 a19, 0
    v_accvgpr_write_b32 a20, 0
    v_accvgpr_write_b32 a21, 0
    v_accvgpr_write_b32 a22, 0
    v_accvgpr_write_b32 a23, 0
    v_accvgpr_write_b32 a24, 0
    v_accvgpr_write_b32 a25, 0
    v_accvgpr_write_b32 a26, 0
    v_accvgpr_write_b32 a27, 0
    v_accvgpr_write_b32 a28, 0
    v_accvgpr_write_b32 a29, 0
    v_accvgpr_write_b32 a30, 0
    v_accvgpr_write_b32 a31, 0
    v_accvgpr_write_b32 a32, 0
    v_accvgpr_write_b32 a33, 0
    v_accvgpr_write_b32 a34, 0
    v_accvgpr_write_b32 a35, 0
    v_accvgpr_write_b32 a36, 0
    v_accvgpr_write_b32 a37, 0
    v_accvgpr_write_b32 a38, 0
    v_accvgpr_write_b32 a39, 0
    v_accvgpr_write_b32 a40, 0
    v_accvgpr_write_b32 a41, 0
    v_accvgpr_write_b32 a42, 0
    v_accvgpr_write_b32 a43, 0
    v_accvgpr_write_b32 a44, 0
    v_accvgpr_write_b32 a45, 0
    v_accvgpr_write_b32 a46, 0
    v_accvgpr_write_b32 a47, 0
    v_accvgpr_write_b32 a48, 0
    v_accvgpr_write_b32 a49, 0
    v_accvgpr_write_b32 a50, 0
    v_accvgpr_write_b32 a51, 0
    v_accvgpr_write_b32 a52, 0
    v_accvgpr_write_b32 a53, 0
    v_accvgpr_write_b32 a54, 0
    v_accvgpr_write_b32 a55, 0
    v_accvgpr_write_b32 a56, 0
    v_accvgpr_write_b32 a57, 0
    v_accvgpr_write_b32 a58, 0
    v_accvgpr_write_b32 a59, 0
    v_accvgpr_write_b32 a60, 0
    v_accvgpr_write_b32 a61, 0
    v_accvgpr_write_b32 a62, 0
    v_accvgpr_write_b32 a63, 0
    v_accvgpr_write_b32 a64, 0
    v_accvgpr_write_b32 a65, 0
    v_accvgpr_write_b32 a66, 0
    v_accvgpr_write_b32 a67, 0
    v_accvgpr_write_b32 a68, 0
    v_accvgpr_write_b32 a69, 0
    v_accvgpr_write_b32 a70, 0
    v_accvgpr_write_b32 a71, 0
    v_accvgpr_write_b32 a72, 0
    v_accvgpr_write_b32 a73, 0
    v_accvgpr_write_b32 a74, 0
    v_accvgpr_write_b32 a75, 0
    v_accvgpr_write_b32 a76, 0
    v_accvgpr_write_b32 a77, 0
    v_accvgpr_write_b32 a78, 0
    v_accvgpr_write_b32 a79, 0
    s_waitcnt vmcnt(10)
    s_barrier
    s_add_u32 s52, s70, 0
    buffer_load_dwordx4 v[56:59], v8, s[32:35], s52 offen offset:0
    buffer_load_dwordx4 v[60:63], v8, s[32:35], s52 offen offset:1024
    buffer_load_dwordx4 v[64:67], v8, s[32:35], s52 offen offset:2048
    buffer_load_dwordx4 v[68:71], v8, s[32:35], s52 offen offset:3072
    s_add_u32 s52, s70, 4096
    buffer_load_dwordx4 v[72:75], v8, s[32:35], s52 offen offset:0
    buffer_load_dwordx4 v[76:79], v8, s[32:35], s52 offen offset:1024
    buffer_load_dwordx4 v[80:83], v8, s[32:35], s52 offen offset:2048
    buffer_load_dwordx4 v[84:87], v8, s[32:35], s52 offen offset:3072
    s_add_u32 s52, s70, 8192
    buffer_load_dwordx4 a[112:115], v8, s[32:35], s52 offen offset:0
    buffer_load_dwordx4 a[116:119], v8, s[32:35], s52 offen offset:1024
    buffer_load_dwordx4 a[120:123], v8, s[32:35], s52 offen offset:2048
    buffer_load_dwordx4 a[124:127], v8, s[32:35], s52 offen offset:3072
    s_add_u32 s52, s70, 49152
    buffer_load_dwordx4 a[128:131], v8, s[32:35], s52 offen offset:0
    buffer_load_dwordx4 a[132:135], v8, s[32:35], s52 offen offset:1024
    buffer_load_dwordx4 a[136:139], v8, s[32:35], s52 offen offset:2048
    buffer_load_dwordx4 a[140:143], v8, s[32:35], s52 offen offset:3072
    ds_read_b64_tr_b16 v[16:17], v2 offset:0
    ds_read_b64_tr_b16 v[18:19], v2 offset:2560
    ds_read_b64_tr_b16 v[20:21], v2 offset:64
    ds_read_b64_tr_b16 v[22:23], v2 offset:2624
    ds_read_b64_tr_b16 v[24:25], v2 offset:128
    ds_read_b64_tr_b16 v[26:27], v2 offset:2688
    ds_read_b64_tr_b16 v[28:29], v2 offset:192
    ds_read_b64_tr_b16 v[30:31], v2 offset:2752
    ds_read_b64_tr_b16 v[32:33], v2 offset:256
    ds_read_b64_tr_b16 v[34:35], v2 offset:2816
    s_waitcnt vmcnt(8)
    s_barrier
    s_waitcnt lgkmcnt(8)
    v_mfma_f32_32x32x16_bf16 a[0:15], v[16:19], v[56:59], a[0:15]
    ds_read_b64_tr_b16 v[36:37], v2 offset:5120
    ds_read_b64_tr_b16 v[38:39], v2 offset:7680
    s_waitcnt lgkmcnt(8)
    v_mfma_f32_32x32x16_bf16 a[16:31], v[20:23], v[56:59], a[16:31]
    ds_read_b64_tr_b16 v[40:41], v2 offset:5184
    ds_read_b64_tr_b16 v[42:43], v2 offset:7744
    s_add_u32 m0, s60, 122880
    s_add_u32 s51, s71, 983040
    buffer_load_dwordx4 v3, s[44:47], s51 offen offset:0 lds
    s_waitcnt lgkmcnt(8)
    v_mfma_f32_32x32x16_bf16 a[32:47], v[24:27], v[56:59], a[32:47]
    ds_read_b64_tr_b16 v[44:45], v2 offset:5248
    ds_read_b64_tr_b16 v[46:47], v2 offset:7808
    s_waitcnt lgkmcnt(8)
    v_mfma_f32_32x32x16_bf16 a[48:63], v[28:31], v[56:59], a[48:63]
    ds_read_b64_tr_b16 v[48:49], v2 offset:5312
    ds_read_b64_tr_b16 v[50:51], v2 offset:7872
    s_waitcnt lgkmcnt(8)
    v_mfma_f32_32x32x16_bf16 a[64:79], v[32:35], v[56:59], a[64:79]
    ds_read_b64_tr_b16 v[52:53], v2 offset:5376
    ds_read_b64_tr_b16 v[54:55], v2 offset:7936
    s_add_u32 s52, s70, 53248
    buffer_load_dwordx4 a[80:83], v8, s[32:35], s52 offen offset:0
    s_waitcnt lgkmcnt(8)
    v_mfma_f32_32x32x16_bf16 a[0:15], v[36:39], v[60:63], a[0:15]
    ds_read_b64_tr_b16 v[16:17], v2 offset:10240
    ds_read_b64_tr_b16 v[18:19], v2 offset:12800
    s_waitcnt lgkmcnt(8)
    v_mfma_f32_32x32x16_bf16 a[16:31], v[40:43], v[60:63], a[16:31]
    ds_read_b64_tr_b16 v[20:21], v2 offset:10304
    ds_read_b64_tr_b16 v[22:23], v2 offset:12864
    s_waitcnt lgkmcnt(8)
    v_mfma_f32_32x32x16_bf16 a[32:47], v[44:47], v[60:63], a[32:47]
    ds_read_b64_tr_b16 v[24:25], v2 offset:10368
    ds_read_b64_tr_b16 v[26:27], v2 offset:12928
    buffer_load_dwordx4 a[84:87], v8, s[32:35], s52 offen offset:1024
    s_waitcnt lgkmcnt(8)
    v_mfma_f32_32x32x16_bf16 a[48:63], v[48:51], v[60:63], a[48:63]
    ds_read_b64_tr_b16 v[28:29], v2 offset:10432
    ds_read_b64_tr_b16 v[30:31], v2 offset:12992
    s_waitcnt lgkmcnt(8)
    v_mfma_f32_32x32x16_bf16 a[64:79], v[52:55], v[60:63], a[64:79]
    ds_read_b64_tr_b16 v[32:33], v2 offset:10496
    ds_read_b64_tr_b16 v[34:35], v2 offset:13056
    s_waitcnt lgkmcnt(8)
    v_mfma_f32_32x32x16_bf16 a[0:15], v[16:19], v[64:67], a[0:15]
    ds_read_b64_tr_b16 v[36:37], v2 offset:15360
    ds_read_b64_tr_b16 v[38:39], v2 offset:17920
    buffer_load_dwordx4 v4, s[44:47], s51 offen offset:1024 lds
    s_waitcnt lgkmcnt(8)
    v_mfma_f32_32x32x16_bf16 a[16:31], v[20:23], v[64:67], a[16:31]
    ds_read_b64_tr_b16 v[40:41], v2 offset:15424
    ds_read_b64_tr_b16 v[42:43], v2 offset:17984
    s_waitcnt lgkmcnt(8)
    v_mfma_f32_32x32x16_bf16 a[32:47], v[24:27], v[64:67], a[32:47]
    ds_read_b64_tr_b16 v[44:45], v2 offset:15488
    ds_read_b64_tr_b16 v[46:47], v2 offset:18048
    s_waitcnt lgkmcnt(8)
    v_mfma_f32_32x32x16_bf16 a[48:63], v[28:31], v[64:67], a[48:63]
    ds_read_b64_tr_b16 v[48:49], v2 offset:15552
    ds_read_b64_tr_b16 v[50:51], v2 offset:18112
    buffer_load_dwordx4 a[88:91], v8, s[32:35], s52 offen offset:2048
    s_waitcnt lgkmcnt(8)
    v_mfma_f32_32x32x16_bf16 a[64:79], v[32:35], v[64:67], a[64:79]
    ds_read_b64_tr_b16 v[52:53], v2 offset:15616
    ds_read_b64_tr_b16 v[54:55], v2 offset:18176
    s_waitcnt lgkmcnt(8)
    v_mfma_f32_32x32x16_bf16 a[0:15], v[36:39], v[68:71], a[0:15]
    ds_read_b64_tr_b16 v[16:17], v2 offset:20480
    ds_read_b64_tr_b16 v[18:19], v2 offset:23040
    s_waitcnt lgkmcnt(8)
    v_mfma_f32_32x32x16_bf16 a[16:31], v[40:43], v[68:71], a[16:31]
    ds_read_b64_tr_b16 v[20:21], v2 offset:20544
    ds_read_b64_tr_b16 v[22:23], v2 offset:23104
    buffer_load_dwordx4 a[92:95], v8, s[32:35], s52 offen offset:3072
    s_waitcnt lgkmcnt(8)
    v_mfma_f32_32x32x16_bf16 a[32:47], v[44:47], v[68:71], a[32:47]
    ds_read_b64_tr_b16 v[24:25], v2 offset:20608
    ds_read_b64_tr_b16 v[26:27], v2 offset:23168
    s_waitcnt lgkmcnt(8)
    v_mfma_f32_32x32x16_bf16 a[48:63], v[48:51], v[68:71], a[48:63]
    ds_read_b64_tr_b16 v[28:29], v2 offset:20672
    ds_read_b64_tr_b16 v[30:31], v2 offset:23232
    s_waitcnt lgkmcnt(8)
    v_mfma_f32_32x32x16_bf16 a[64:79], v[52:55], v[68:71], a[64:79]
    ds_read_b64_tr_b16 v[32:33], v2 offset:20736
    ds_read_b64_tr_b16 v[34:35], v2 offset:23296
    buffer_load_dwordx4 v5, s[44:47], s51 offen offset:2048 lds
    s_waitcnt lgkmcnt(8)
    v_mfma_f32_32x32x16_bf16 a[0:15], v[16:19], v[72:75], a[0:15]
    ds_read_b64_tr_b16 v[36:37], v2 offset:25600
    ds_read_b64_tr_b16 v[38:39], v2 offset:28160
    s_waitcnt lgkmcnt(8)
    v_mfma_f32_32x32x16_bf16 a[16:31], v[20:23], v[72:75], a[16:31]
    ds_read_b64_tr_b16 v[40:41], v2 offset:25664
    ds_read_b64_tr_b16 v[42:43], v2 offset:28224
    s_waitcnt lgkmcnt(8)
    v_mfma_f32_32x32x16_bf16 a[32:47], v[24:27], v[72:75], a[32:47]
    ds_read_b64_tr_b16 v[44:45], v2 offset:25728
    ds_read_b64_tr_b16 v[46:47], v2 offset:28288
    s_add_u32 s52, s70, 57344
    buffer_load_dwordx4 a[96:99], v8, s[32:35], s52 offen offset:0
    s_waitcnt lgkmcnt(8)
    v_mfma_f32_32x32x16_bf16 a[48:63], v[28:31], v[72:75], a[48:63]
    ds_read_b64_tr_b16 v[48:49], v2 offset:25792
    ds_read_b64_tr_b16 v[50:51], v2 offset:28352
    s_waitcnt lgkmcnt(8)
    v_mfma_f32_32x32x16_bf16 a[64:79], v[32:35], v[72:75], a[64:79]
    ds_read_b64_tr_b16 v[52:53], v2 offset:25856
    ds_read_b64_tr_b16 v[54:55], v2 offset:28416
    s_waitcnt lgkmcnt(8)
    v_mfma_f32_32x32x16_bf16 a[0:15], v[36:39], v[76:79], a[0:15]
    ds_read_b64_tr_b16 v[16:17], v2 offset:30720
    ds_read_b64_tr_b16 v[18:19], v2 offset:33280
    buffer_load_dwordx4 a[100:103], v8, s[32:35], s52 offen offset:1024
    s_waitcnt lgkmcnt(8)
    v_mfma_f32_32x32x16_bf16 a[16:31], v[40:43], v[76:79], a[16:31]
    ds_read_b64_tr_b16 v[20:21], v2 offset:30784
    ds_read_b64_tr_b16 v[22:23], v2 offset:33344
    s_waitcnt lgkmcnt(8)
    v_mfma_f32_32x32x16_bf16 a[32:47], v[44:47], v[76:79], a[32:47]
    ds_read_b64_tr_b16 v[24:25], v2 offset:30848
    ds_read_b64_tr_b16 v[26:27], v2 offset:33408
    s_waitcnt lgkmcnt(8)
    v_mfma_f32_32x32x16_bf16 a[48:63], v[48:51], v[76:79], a[48:63]
    ds_read_b64_tr_b16 v[28:29], v2 offset:30912
    ds_read_b64_tr_b16 v[30:31], v2 offset:33472
    buffer_load_dwordx4 v6, s[44:47], s51 offen offset:3072 lds
    s_waitcnt lgkmcnt(8)
    v_mfma_f32_32x32x16_bf16 a[64:79], v[52:55], v[76:79], a[64:79]
    ds_read_b64_tr_b16 v[32:33], v2 offset:30976
    ds_read_b64_tr_b16 v[34:35], v2 offset:33536
    s_waitcnt lgkmcnt(8)
    v_mfma_f32_32x32x16_bf16 a[0:15], v[16:19], v[80:83], a[0:15]
    ds_read_b64_tr_b16 v[36:37], v2 offset:35840
    ds_read_b64_tr_b16 v[38:39], v2 offset:38400
    s_waitcnt lgkmcnt(8)
    v_mfma_f32_32x32x16_bf16 a[16:31], v[20:23], v[80:83], a[16:31]
    ds_read_b64_tr_b16 v[40:41], v2 offset:35904
    ds_read_b64_tr_b16 v[42:43], v2 offset:38464
    buffer_load_dwordx4 a[104:107], v8, s[32:35], s52 offen offset:2048
    s_waitcnt lgkmcnt(8)
    v_mfma_f32_32x32x16_bf16 a[32:47], v[24:27], v[80:83], a[32:47]
    ds_read_b64_tr_b16 v[44:45], v2 offset:35968
    ds_read_b64_tr_b16 v[46:47], v2 offset:38528
    s_waitcnt lgkmcnt(8)
    v_mfma_f32_32x32x16_bf16 a[48:63], v[28:31], v[80:83], a[48:63]
    ds_read_b64_tr_b16 v[48:49], v2 offset:36032
    ds_read_b64_tr_b16 v[50:51], v2 offset:38592
    s_waitcnt lgkmcnt(8)
    v_mfma_f32_32x32x16_bf16 a[64:79], v[32:35], v[80:83], a[64:79]
    ds_read_b64_tr_b16 v[52:53], v2 offset:36096
    ds_read_b64_tr_b16 v[54:55], v2 offset:38656
    buffer_load_dwordx4 a[108:111], v8, s[32:35], s52 offen offset:3072
    s_waitcnt lgkmcnt(8)
    v_mfma_f32_32x32x16_bf16 a[0:15], v[36:39], v[84:87], a[0:15]
    ds_read_b64_tr_b16 v[16:17], v11 offset:0
    ds_read_b64_tr_b16 v[18:19], v11 offset:2560
    s_waitcnt lgkmcnt(8)
    v_mfma_f32_32x32x16_bf16 a[16:31], v[40:43], v[84:87], a[16:31]
    ds_read_b64_tr_b16 v[20:21], v11 offset:64
    ds_read_b64_tr_b16 v[22:23], v11 offset:2624
    s_waitcnt lgkmcnt(8)
    v_mfma_f32_32x32x16_bf16 a[32:47], v[44:47], v[84:87], a[32:47]
    ds_read_b64_tr_b16 v[24:25], v11 offset:128
    ds_read_b64_tr_b16 v[26:27], v11 offset:2688
    s_add_u32 m0, s60, 126976
    s_nop 0
    buffer_load_dwordx4 v7, s[44:47], s51 offen offset:0 lds
    s_waitcnt lgkmcnt(8)
    v_mfma_f32_32x32x16_bf16 a[48:63], v[48:51], v[84:87], a[48:63]
    ds_read_b64_tr_b16 v[28:29], v11 offset:192
    ds_read_b64_tr_b16 v[30:31], v11 offset:2752
    s_waitcnt lgkmcnt(8)
    v_mfma_f32_32x32x16_bf16 a[64:79], v[52:55], v[84:87], a[64:79]
    ds_read_b64_tr_b16 v[32:33], v11 offset:256
    ds_read_b64_tr_b16 v[34:35], v11 offset:2816
    s_waitcnt vmcnt(13)
    s_barrier
    s_waitcnt lgkmcnt(8)
    v_mfma_f32_32x32x16_bf16 a[0:15], v[16:19], a[112:115], a[0:15]
    ds_read_b64_tr_b16 v[36:37], v11 offset:5120
    ds_read_b64_tr_b16 v[38:39], v11 offset:7680
    s_waitcnt lgkmcnt(8)
    v_mfma_f32_32x32x16_bf16 a[16:31], v[20:23], a[112:115], a[16:31]
    ds_read_b64_tr_b16 v[40:41], v11 offset:5184
    ds_read_b64_tr_b16 v[42:43], v11 offset:7744
    s_add_u32 m0, s60, 0
    s_add_u32 s51, s71, 1146880
    buffer_load_dwordx4 v3, s[44:47], s51 offen offset:0 lds
    s_waitcnt lgkmcnt(8)
    v_mfma_f32_32x32x16_bf16 a[32:47], v[24:27], a[112:115], a[32:47]
    ds_read_b64_tr_b16 v[44:45], v11 offset:5248
    ds_read_b64_tr_b16 v[46:47], v11 offset:7808
    s_waitcnt lgkmcnt(8)
    v_mfma_f32_32x32x16_bf16 a[48:63], v[28:31], a[112:115], a[48:63]
    ds_read_b64_tr_b16 v[48:49], v11 offset:5312
    ds_read_b64_tr_b16 v[50:51], v11 offset:7872
    s_waitcnt lgkmcnt(8)
    v_mfma_f32_32x32x16_bf16 a[64:79], v[32:35], a[112:115], a[64:79]
    ds_read_b64_tr_b16 v[52:53], v11 offset:5376
    ds_read_b64_tr_b16 v[54:55], v11 offset:7936
    s_add_u32 s52, s70, 196608
    buffer_load_dwordx4 v[56:59], v8, s[32:35], s52 offen offset:0
    s_waitcnt lgkmcnt(8)
    v_mfma_f32_32x32x16_bf16 a[0:15], v[36:39], a[116:119], a[0:15]
    ds_read_b64_tr_b16 v[16:17], v11 offset:10240
    ds_read_b64_tr_b16 v[18:19], v11 offset:12800
    s_waitcnt lgkmcnt(8)
    v_mfma_f32_32x32x16_bf16 a[16:31], v[40:43], a[116:119], a[16:31]
    ds_read_b64_tr_b16 v[20:21], v11 offset:10304
    ds_read_b64_tr_b16 v[22:23], v11 offset:12864
    s_waitcnt lgkmcnt(8)
    v_mfma_f32_32x32x16_bf16 a[32:47], v[44:47], a[116:119], a[32:47]
    ds_read_b64_tr_b16 v[24:25], v11 offset:10368
    ds_read_b64_tr_b16 v[26:27], v11 offset:12928
    buffer_load_dwordx4 v[60:63], v8, s[32:35], s52 offen offset:1024
    s_waitcnt lgkmcnt(8)
    v_mfma_f32_32x32x16_bf16 a[48:63], v[48:51], a[116:119], a[48:63]
    ds_read_b64_tr_b16 v[28:29], v11 offset:10432
    ds_read_b64_tr_b16 v[30:31], v11 offset:12992
    s_waitcnt lgkmcnt(8)
    v_mfma_f32_32x32x16_bf16 a[64:79], v[52:55], a[116:119], a[64:79]
    ds_read_b64_tr_b16 v[32:33], v11 offset:10496
    ds_read_b64_tr_b16 v[34:35], v11 offset:13056
    s_waitcnt lgkmcnt(8)
    v_mfma_f32_32x32x16_bf16 a[0:15], v[16:19], a[120:123], a[0:15]
    ds_read_b64_tr_b16 v[36:37], v11 offset:15360
    ds_read_b64_tr_b16 v[38:39], v11 offset:17920
    buffer_load_dwordx4 v4, s[44:47], s51 offen offset:1024 lds
    s_waitcnt lgkmcnt(8)
    v_mfma_f32_32x32x16_bf16 a[16:31], v[20:23], a[120:123], a[16:31]
    ds_read_b64_tr_b16 v[40:41], v11 offset:15424
    ds_read_b64_tr_b16 v[42:43], v11 offset:17984
    s_waitcnt lgkmcnt(8)
    v_mfma_f32_32x32x16_bf16 a[32:47], v[24:27], a[120:123], a[32:47]
    ds_read_b64_tr_b16 v[44:45], v11 offset:15488
    ds_read_b64_tr_b16 v[46:47], v11 offset:18048
    s_waitcnt lgkmcnt(8)
    v_mfma_f32_32x32x16_bf16 a[48:63], v[28:31], a[120:123], a[48:63]
    ds_read_b64_tr_b16 v[48:49], v11 offset:15552
    ds_read_b64_tr_b16 v[50:51], v11 offset:18112
    buffer_load_dwordx4 v[64:67], v8, s[32:35], s52 offen offset:2048
    s_waitcnt lgkmcnt(8)
    v_mfma_f32_32x32x16_bf16 a[64:79], v[32:35], a[120:123], a[64:79]
    ds_read_b64_tr_b16 v[52:53], v11 offset:15616
    ds_read_b64_tr_b16 v[54:55], v11 offset:18176
    s_waitcnt lgkmcnt(8)
    v_mfma_f32_32x32x16_bf16 a[0:15], v[36:39], a[124:127], a[0:15]
    ds_read_b64_tr_b16 v[16:17], v11 offset:20480
    ds_read_b64_tr_b16 v[18:19], v11 offset:23040
    s_waitcnt lgkmcnt(8)
    v_mfma_f32_32x32x16_bf16 a[16:31], v[40:43], a[124:127], a[16:31]
    ds_read_b64_tr_b16 v[20:21], v11 offset:20544
    ds_read_b64_tr_b16 v[22:23], v11 offset:23104
    buffer_load_dwordx4 v[68:71], v8, s[32:35], s52 offen offset:3072
    s_waitcnt lgkmcnt(8)
    v_mfma_f32_32x32x16_bf16 a[32:47], v[44:47], a[124:127], a[32:47]
    ds_read_b64_tr_b16 v[24:25], v11 offset:20608
    ds_read_b64_tr_b16 v[26:27], v11 offset:23168
    s_waitcnt lgkmcnt(8)
    v_mfma_f32_32x32x16_bf16 a[48:63], v[48:51], a[124:127], a[48:63]
    ds_read_b64_tr_b16 v[28:29], v11 offset:20672
    ds_read_b64_tr_b16 v[30:31], v11 offset:23232
    s_waitcnt lgkmcnt(8)
    v_mfma_f32_32x32x16_bf16 a[64:79], v[52:55], a[124:127], a[64:79]
    ds_read_b64_tr_b16 v[32:33], v11 offset:20736
    ds_read_b64_tr_b16 v[34:35], v11 offset:23296
    buffer_load_dwordx4 v5, s[44:47], s51 offen offset:2048 lds
    s_waitcnt lgkmcnt(8)
    v_mfma_f32_32x32x16_bf16 a[0:15], v[16:19], a[128:131], a[0:15]
    ds_read_b64_tr_b16 v[36:37], v11 offset:25600
    ds_read_b64_tr_b16 v[38:39], v11 offset:28160
    s_waitcnt lgkmcnt(8)
    v_mfma_f32_32x32x16_bf16 a[16:31], v[20:23], a[128:131], a[16:31]
    ds_read_b64_tr_b16 v[40:41], v11 offset:25664
    ds_read_b64_tr_b16 v[42:43], v11 offset:28224
    s_waitcnt lgkmcnt(8)
    v_mfma_f32_32x32x16_bf16 a[32:47], v[24:27], a[128:131], a[32:47]
    ds_read_b64_tr_b16 v[44:45], v11 offset:25728
    ds_read_b64_tr_b16 v[46:47], v11 offset:28288
    s_add_u32 s52, s70, 200704
    buffer_load_dwordx4 v[72:75], v8, s[32:35], s52 offen offset:0
    s_waitcnt lgkmcnt(8)
    v_mfma_f32_32x32x16_bf16 a[48:63], v[28:31], a[128:131], a[48:63]
    ds_read_b64_tr_b16 v[48:49], v11 offset:25792
    ds_read_b64_tr_b16 v[50:51], v11 offset:28352
    s_waitcnt lgkmcnt(8)
    v_mfma_f32_32x32x16_bf16 a[64:79], v[32:35], a[128:131], a[64:79]
    ds_read_b64_tr_b16 v[52:53], v11 offset:25856
    ds_read_b64_tr_b16 v[54:55], v11 offset:28416
    s_waitcnt lgkmcnt(8)
    v_mfma_f32_32x32x16_bf16 a[0:15], v[36:39], a[132:135], a[0:15]
    ds_read_b64_tr_b16 v[16:17], v11 offset:30720
    ds_read_b64_tr_b16 v[18:19], v11 offset:33280
    buffer_load_dwordx4 v[76:79], v8, s[32:35], s52 offen offset:1024
    s_waitcnt lgkmcnt(8)
    v_mfma_f32_32x32x16_bf16 a[16:31], v[40:43], a[132:135], a[16:31]
    ds_read_b64_tr_b16 v[20:21], v11 offset:30784
    ds_read_b64_tr_b16 v[22:23], v11 offset:33344
    s_waitcnt lgkmcnt(8)
    v_mfma_f32_32x32x16_bf16 a[32:47], v[44:47], a[132:135], a[32:47]
    ds_read_b64_tr_b16 v[24:25], v11 offset:30848
    ds_read_b64_tr_b16 v[26:27], v11 offset:33408
    s_waitcnt lgkmcnt(8)
    v_mfma_f32_32x32x16_bf16 a[48:63], v[48:51], a[132:135], a[48:63]
    ds_read_b64_tr_b16 v[28:29], v11 offset:30912
    ds_read_b64_tr_b16 v[30:31], v11 offset:33472
    buffer_load_dwordx4 v6, s[44:47], s51 offen offset:3072 lds
    s_waitcnt lgkmcnt(8)
    v_mfma_f32_32x32x16_bf16 a[64:79], v[52:55], a[132:135], a[64:79]
    ds_read_b64_tr_b16 v[32:33], v11 offset:30976
    ds_read_b64_tr_b16 v[34:35], v11 offset:33536
    s_waitcnt lgkmcnt(8)
    v_mfma_f32_32x32x16_bf16 a[0:15], v[16:19], a[136:139], a[0:15]
    ds_read_b64_tr_b16 v[36:37], v11 offset:35840
    ds_read_b64_tr_b16 v[38:39], v11 offset:38400
    s_waitcnt lgkmcnt(8)
    v_mfma_f32_32x32x16_bf16 a[16:31], v[20:23], a[136:139], a[16:31]
    ds_read_b64_tr_b16 v[40:41], v11 offset:35904
    ds_read_b64_tr_b16 v[42:43], v11 offset:38464
    buffer_load_dwordx4 v[80:83], v8, s[32:35], s52 offen offset:2048
    s_waitcnt lgkmcnt(8)
    v_mfma_f32_32x32x16_bf16 a[32:47], v[24:27], a[136:139], a[32:47]
    ds_read_b64_tr_b16 v[44:45], v11 offset:35968
    ds_read_b64_tr_b16 v[46:47], v11 offset:38528
    s_waitcnt lgkmcnt(8)
    v_mfma_f32_32x32x16_bf16 a[48:63], v[28:31], a[136:139], a[48:63]
    ds_read_b64_tr_b16 v[48:49], v11 offset:36032
    ds_read_b64_tr_b16 v[50:51], v11 offset:38592
    s_waitcnt lgkmcnt(8)
    v_mfma_f32_32x32x16_bf16 a[64:79], v[32:35], a[136:139], a[64:79]
    ds_read_b64_tr_b16 v[52:53], v11 offset:36096
    ds_read_b64_tr_b16 v[54:55], v11 offset:38656
    buffer_load_dwordx4 v[84:87], v8, s[32:35], s52 offen offset:3072
    s_waitcnt lgkmcnt(8)
    v_mfma_f32_32x32x16_bf16 a[0:15], v[36:39], a[140:143], a[0:15]
    ds_read_b64_tr_b16 v[16:17], v12 offset:0
    ds_read_b64_tr_b16 v[18:19], v12 offset:2560
    s_waitcnt lgkmcnt(8)
    v_mfma_f32_32x32x16_bf16 a[16:31], v[40:43], a[140:143], a[16:31]
    ds_read_b64_tr_b16 v[20:21], v12 offset:64
    ds_read_b64_tr_b16 v[22:23], v12 offset:2624
    s_waitcnt lgkmcnt(8)
    v_mfma_f32_32x32x16_bf16 a[32:47], v[44:47], a[140:143], a[32:47]
    ds_read_b64_tr_b16 v[24:25], v12 offset:128
    ds_read_b64_tr_b16 v[26:27], v12 offset:2688
    s_add_u32 m0, s60, 4096
    s_nop 0
    buffer_load_dwordx4 v7, s[44:47], s51 offen offset:0 lds
    s_waitcnt lgkmcnt(8)
    v_mfma_f32_32x32x16_bf16 a[48:63], v[48:51], a[140:143], a[48:63]
    ds_read_b64_tr_b16 v[28:29], v12 offset:192
    ds_read_b64_tr_b16 v[30:31], v12 offset:2752
    s_waitcnt lgkmcnt(8)
    v_mfma_f32_32x32x16_bf16 a[64:79], v[52:55], a[140:143], a[64:79]
    ds_read_b64_tr_b16 v[32:33], v12 offset:256
    ds_read_b64_tr_b16 v[34:35], v12 offset:2816
    s_waitcnt vmcnt(13)
    s_barrier
    s_waitcnt lgkmcnt(8)
    v_mfma_f32_32x32x16_bf16 a[0:15], v[16:19], a[80:83], a[0:15]
    ds_read_b64_tr_b16 v[36:37], v12 offset:5120
    ds_read_b64_tr_b16 v[38:39], v12 offset:7680
    s_waitcnt lgkmcnt(8)
    v_mfma_f32_32x32x16_bf16 a[16:31], v[20:23], a[80:83], a[16:31]
    ds_read_b64_tr_b16 v[40:41], v12 offset:5184
    ds_read_b64_tr_b16 v[42:43], v12 offset:7744
    s_add_u32 m0, s60, 40960
    s_add_u32 s51, s71, 1310720
    buffer_load_dwordx4 v3, s[44:47], s51 offen offset:0 lds
    s_waitcnt lgkmcnt(8)
    v_mfma_f32_32x32x16_bf16 a[32:47], v[24:27], a[80:83], a[32:47]
    ds_read_b64_tr_b16 v[44:45], v12 offset:5248
    ds_read_b64_tr_b16 v[46:47], v12 offset:7808
    s_waitcnt lgkmcnt(8)
    v_mfma_f32_32x32x16_bf16 a[48:63], v[28:31], a[80:83], a[48:63]
    ds_read_b64_tr_b16 v[48:49], v12 offset:5312
    ds_read_b64_tr_b16 v[50:51], v12 offset:7872
    s_waitcnt lgkmcnt(8)
    v_mfma_f32_32x32x16_bf16 a[64:79], v[32:35], a[80:83], a[64:79]
    ds_read_b64_tr_b16 v[52:53], v12 offset:5376
    ds_read_b64_tr_b16 v[54:55], v12 offset:7936
    s_add_u32 s52, s70, 204800
    buffer_load_dwordx4 a[112:115], v8, s[32:35], s52 offen offset:0
    s_waitcnt lgkmcnt(8)
    v_mfma_f32_32x32x16_bf16 a[0:15], v[36:39], a[84:87], a[0:15]
    ds_read_b64_tr_b16 v[16:17], v12 offset:10240
    ds_read_b64_tr_b16 v[18:19], v12 offset:12800
    s_waitcnt lgkmcnt(8)
    v_mfma_f32_32x32x16_bf16 a[16:31], v[40:43], a[84:87], a[16:31]
    ds_read_b64_tr_b16 v[20:21], v12 offset:10304
    ds_read_b64_tr_b16 v[22:23], v12 offset:12864
    s_waitcnt lgkmcnt(8)
    v_mfma_f32_32x32x16_bf16 a[32:47], v[44:47], a[84:87], a[32:47]
    ds_read_b64_tr_b16 v[24:25], v12 offset:10368
    ds_read_b64_tr_b16 v[26:27], v12 offset:12928
    buffer_load_dwordx4 a[116:119], v8, s[32:35], s52 offen offset:1024
    s_waitcnt lgkmcnt(8)
    v_mfma_f32_32x32x16_bf16 a[48:63], v[48:51], a[84:87], a[48:63]
    ds_read_b64_tr_b16 v[28:29], v12 offset:10432
    ds_read_b64_tr_b16 v[30:31], v12 offset:12992
    s_waitcnt lgkmcnt(8)
    v_mfma_f32_32x32x16_bf16 a[64:79], v[52:55], a[84:87], a[64:79]
    ds_read_b64_tr_b16 v[32:33], v12 offset:10496
    ds_read_b64_tr_b16 v[34:35], v12 offset:13056
    s_waitcnt lgkmcnt(8)
    v_mfma_f32_32x32x16_bf16 a[0:15], v[16:19], a[88:91], a[0:15]
    ds_read_b64_tr_b16 v[36:37], v12 offset:15360
    ds_read_b64_tr_b16 v[38:39], v12 offset:17920
    buffer_load_dwordx4 v4, s[44:47], s51 offen offset:1024 lds
    s_waitcnt lgkmcnt(8)
    v_mfma_f32_32x32x16_bf16 a[16:31], v[20:23], a[88:91], a[16:31]
    ds_read_b64_tr_b16 v[40:41], v12 offset:15424
    ds_read_b64_tr_b16 v[42:43], v12 offset:17984
    s_waitcnt lgkmcnt(8)
    v_mfma_f32_32x32x16_bf16 a[32:47], v[24:27], a[88:91], a[32:47]
    ds_read_b64_tr_b16 v[44:45], v12 offset:15488
    ds_read_b64_tr_b16 v[46:47], v12 offset:18048
    s_waitcnt lgkmcnt(8)
    v_mfma_f32_32x32x16_bf16 a[48:63], v[28:31], a[88:91], a[48:63]
    ds_read_b64_tr_b16 v[48:49], v12 offset:15552
    ds_read_b64_tr_b16 v[50:51], v12 offset:18112
    buffer_load_dwordx4 a[120:123], v8, s[32:35], s52 offen offset:2048
    s_waitcnt lgkmcnt(8)
    v_mfma_f32_32x32x16_bf16 a[64:79], v[32:35], a[88:91], a[64:79]
    ds_read_b64_tr_b16 v[52:53], v12 offset:15616
    ds_read_b64_tr_b16 v[54:55], v12 offset:18176
    s_waitcnt lgkmcnt(8)
    v_mfma_f32_32x32x16_bf16 a[0:15], v[36:39], a[92:95], a[0:15]
    ds_read_b64_tr_b16 v[16:17], v12 offset:20480
    ds_read_b64_tr_b16 v[18:19], v12 offset:23040
    s_waitcnt lgkmcnt(8)
    v_mfma_f32_32x32x16_bf16 a[16:31], v[40:43], a[92:95], a[16:31]
    ds_read_b64_tr_b16 v[20:21], v12 offset:20544
    ds_read_b64_tr_b16 v[22:23], v12 offset:23104
    buffer_load_dwordx4 a[124:127], v8, s[32:35], s52 offen offset:3072
    s_waitcnt lgkmcnt(8)
    v_mfma_f32_32x32x16_bf16 a[32:47], v[44:47], a[92:95], a[32:47]
    ds_read_b64_tr_b16 v[24:25], v12 offset:20608
    ds_read_b64_tr_b16 v[26:27], v12 offset:23168
    s_waitcnt lgkmcnt(8)
    v_mfma_f32_32x32x16_bf16 a[48:63], v[48:51], a[92:95], a[48:63]
    ds_read_b64_tr_b16 v[28:29], v12 offset:20672
    ds_read_b64_tr_b16 v[30:31], v12 offset:23232
    s_waitcnt lgkmcnt(8)
    v_mfma_f32_32x32x16_bf16 a[64:79], v[52:55], a[92:95], a[64:79]
    ds_read_b64_tr_b16 v[32:33], v12 offset:20736
    ds_read_b64_tr_b16 v[34:35], v12 offset:23296
    buffer_load_dwordx4 v5, s[44:47], s51 offen offset:2048 lds
    s_waitcnt lgkmcnt(8)
    v_mfma_f32_32x32x16_bf16 a[0:15], v[16:19], a[96:99], a[0:15]
    ds_read_b64_tr_b16 v[36:37], v12 offset:25600
    ds_read_b64_tr_b16 v[38:39], v12 offset:28160
    s_waitcnt lgkmcnt(8)
    v_mfma_f32_32x32x16_bf16 a[16:31], v[20:23], a[96:99], a[16:31]
    ds_read_b64_tr_b16 v[40:41], v12 offset:25664
    ds_read_b64_tr_b16 v[42:43], v12 offset:28224
    s_waitcnt lgkmcnt(8)
    v_mfma_f32_32x32x16_bf16 a[32:47], v[24:27], a[96:99], a[32:47]
    ds_read_b64_tr_b16 v[44:45], v12 offset:25728
    ds_read_b64_tr_b16 v[46:47], v12 offset:28288
    s_add_u32 s52, s70, 245760
    buffer_load_dwordx4 a[128:131], v8, s[32:35], s52 offen offset:0
    s_waitcnt lgkmcnt(8)
    v_mfma_f32_32x32x16_bf16 a[48:63], v[28:31], a[96:99], a[48:63]
    ds_read_b64_tr_b16 v[48:49], v12 offset:25792
    ds_read_b64_tr_b16 v[50:51], v12 offset:28352
    s_waitcnt lgkmcnt(8)
    v_mfma_f32_32x32x16_bf16 a[64:79], v[32:35], a[96:99], a[64:79]
    ds_read_b64_tr_b16 v[52:53], v12 offset:25856
    ds_read_b64_tr_b16 v[54:55], v12 offset:28416
    s_waitcnt lgkmcnt(8)
    v_mfma_f32_32x32x16_bf16 a[0:15], v[36:39], a[100:103], a[0:15]
    ds_read_b64_tr_b16 v[16:17], v12 offset:30720
    ds_read_b64_tr_b16 v[18:19], v12 offset:33280
    buffer_load_dwordx4 a[132:135], v8, s[32:35], s52 offen offset:1024
    s_waitcnt lgkmcnt(8)
    v_mfma_f32_32x32x16_bf16 a[16:31], v[40:43], a[100:103], a[16:31]
    ds_read_b64_tr_b16 v[20:21], v12 offset:30784
    ds_read_b64_tr_b16 v[22:23], v12 offset:33344
    s_waitcnt lgkmcnt(8)
    v_mfma_f32_32x32x16_bf16 a[32:47], v[44:47], a[100:103], a[32:47]
    ds_read_b64_tr_b16 v[24:25], v12 offset:30848
    ds_read_b64_tr_b16 v[26:27], v12 offset:33408
    s_waitcnt lgkmcnt(8)
    v_mfma_f32_32x32x16_bf16 a[48:63], v[48:51], a[100:103], a[48:63]
    ds_read_b64_tr_b16 v[28:29], v12 offset:30912
    ds_read_b64_tr_b16 v[30:31], v12 offset:33472
    buffer_load_dwordx4 v6, s[44:47], s51 offen offset:3072 lds
    s_waitcnt lgkmcnt(8)
    v_mfma_f32_32x32x16_bf16 a[64:79], v[52:55], a[100:103], a[64:79]
    ds_read_b64_tr_b16 v[32:33], v12 offset:30976
    ds_read_b64_tr_b16 v[34:35], v12 offset:33536
    s_waitcnt lgkmcnt(8)
    v_mfma_f32_32x32x16_bf16 a[0:15], v[16:19], a[104:107], a[0:15]
    ds_read_b64_tr_b16 v[36:37], v12 offset:35840
    ds_read_b64_tr_b16 v[38:39], v12 offset:38400
    s_waitcnt lgkmcnt(8)
    v_mfma_f32_32x32x16_bf16 a[16:31], v[20:23], a[104:107], a[16:31]
    ds_read_b64_tr_b16 v[40:41], v12 offset:35904
    ds_read_b64_tr_b16 v[42:43], v12 offset:38464
    buffer_load_dwordx4 a[136:139], v8, s[32:35], s52 offen offset:2048
    s_waitcnt lgkmcnt(8)
    v_mfma_f32_32x32x16_bf16 a[32:47], v[24:27], a[104:107], a[32:47]
    ds_read_b64_tr_b16 v[44:45], v12 offset:35968
    ds_read_b64_tr_b16 v[46:47], v12 offset:38528
    s_waitcnt lgkmcnt(8)
    v_mfma_f32_32x32x16_bf16 a[48:63], v[28:31], a[104:107], a[48:63]
    ds_read_b64_tr_b16 v[48:49], v12 offset:36032
    ds_read_b64_tr_b16 v[50:51], v12 offset:38592
    s_waitcnt lgkmcnt(8)
    v_mfma_f32_32x32x16_bf16 a[64:79], v[32:35], a[104:107], a[64:79]
    ds_read_b64_tr_b16 v[52:53], v12 offset:36096
    ds_read_b64_tr_b16 v[54:55], v12 offset:38656
    buffer_load_dwordx4 a[140:143], v8, s[32:35], s52 offen offset:3072
    s_waitcnt lgkmcnt(8)
    v_mfma_f32_32x32x16_bf16 a[0:15], v[36:39], a[108:111], a[0:15]
    ds_read_b64_tr_b16 v[16:17], v13 offset:0
    ds_read_b64_tr_b16 v[18:19], v13 offset:2560
    s_waitcnt lgkmcnt(8)
    v_mfma_f32_32x32x16_bf16 a[16:31], v[40:43], a[108:111], a[16:31]
    ds_read_b64_tr_b16 v[20:21], v13 offset:64
    ds_read_b64_tr_b16 v[22:23], v13 offset:2624
    s_waitcnt lgkmcnt(8)
    v_mfma_f32_32x32x16_bf16 a[32:47], v[44:47], a[108:111], a[32:47]
    ds_read_b64_tr_b16 v[24:25], v13 offset:128
    ds_read_b64_tr_b16 v[26:27], v13 offset:2688
    s_add_u32 m0, s60, 45056
    s_nop 0
    buffer_load_dwordx4 v7, s[44:47], s51 offen offset:0 lds
    s_waitcnt lgkmcnt(8)
    v_mfma_f32_32x32x16_bf16 a[48:63], v[48:51], a[108:111], a[48:63]
    ds_read_b64_tr_b16 v[28:29], v13 offset:192
    ds_read_b64_tr_b16 v[30:31], v13 offset:2752
    s_waitcnt lgkmcnt(8)
    v_mfma_f32_32x32x16_bf16 a[64:79], v[52:55], a[108:111], a[64:79]
    ds_read_b64_tr_b16 v[32:33], v13 offset:256
    ds_read_b64_tr_b16 v[34:35], v13 offset:2816
    s_waitcnt vmcnt(13)
    s_barrier
    s_waitcnt lgkmcnt(8)
    v_mfma_f32_32x32x16_bf16 a[0:15], v[16:19], v[56:59], a[0:15]
    ds_read_b64_tr_b16 v[36:37], v13 offset:5120
    ds_read_b64_tr_b16 v[38:39], v13 offset:7680
    s_waitcnt lgkmcnt(8)
    v_mfma_f32_32x32x16_bf16 a[16:31], v[20:23], v[56:59], a[16:31]
    ds_read_b64_tr_b16 v[40:41], v13 offset:5184
    ds_read_b64_tr_b16 v[42:43], v13 offset:7744
    s_add_u32 m0, s60, 81920
    s_add_u32 s51, s71, 1966080
    buffer_load_dwordx4 v3, s[44:47], s51 offen offset:0 lds
    s_waitcnt lgkmcnt(8)
    v_mfma_f32_32x32x16_bf16 a[32:47], v[24:27], v[56:59], a[32:47]
    ds_read_b64_tr_b16 v[44:45], v13 offset:5248
    ds_read_b64_tr_b16 v[46:47], v13 offset:7808
    s_waitcnt lgkmcnt(8)
    v_mfma_f32_32x32x16_bf16 a[48:63], v[28:31], v[56:59], a[48:63]
    ds_read_b64_tr_b16 v[48:49], v13 offset:5312
    ds_read_b64_tr_b16 v[50:51], v13 offset:7872
    s_waitcnt lgkmcnt(8)
    v_mfma_f32_32x32x16_bf16 a[64:79], v[32:35], v[56:59], a[64:79]
    ds_read_b64_tr_b16 v[52:53], v13 offset:5376
    ds_read_b64_tr_b16 v[54:55], v13 offset:7936
    s_add_u32 s52, s70, 249856
    buffer_load_dwordx4 a[80:83], v8, s[32:35], s52 offen offset:0
    s_waitcnt lgkmcnt(8)
    v_mfma_f32_32x32x16_bf16 a[0:15], v[36:39], v[60:63], a[0:15]
    ds_read_b64_tr_b16 v[16:17], v13 offset:10240
    ds_read_b64_tr_b16 v[18:19], v13 offset:12800
    s_waitcnt lgkmcnt(8)
    v_mfma_f32_32x32x16_bf16 a[16:31], v[40:43], v[60:63], a[16:31]
    ds_read_b64_tr_b16 v[20:21], v13 offset:10304
    ds_read_b64_tr_b16 v[22:23], v13 offset:12864
    s_waitcnt lgkmcnt(8)
    v_mfma_f32_32x32x16_bf16 a[32:47], v[44:47], v[60:63], a[32:47]
    ds_read_b64_tr_b16 v[24:25], v13 offset:10368
    ds_read_b64_tr_b16 v[26:27], v13 offset:12928
    buffer_load_dwordx4 a[84:87], v8, s[32:35], s52 offen offset:1024
    s_waitcnt lgkmcnt(8)
    v_mfma_f32_32x32x16_bf16 a[48:63], v[48:51], v[60:63], a[48:63]
    ds_read_b64_tr_b16 v[28:29], v13 offset:10432
    ds_read_b64_tr_b16 v[30:31], v13 offset:12992
    s_waitcnt lgkmcnt(8)
    v_mfma_f32_32x32x16_bf16 a[64:79], v[52:55], v[60:63], a[64:79]
    ds_read_b64_tr_b16 v[32:33], v13 offset:10496
    ds_read_b64_tr_b16 v[34:35], v13 offset:13056
    s_waitcnt lgkmcnt(8)
    v_mfma_f32_32x32x16_bf16 a[0:15], v[16:19], v[64:67], a[0:15]
    ds_read_b64_tr_b16 v[36:37], v13 offset:15360
    ds_read_b64_tr_b16 v[38:39], v13 offset:17920
    buffer_load_dwordx4 v4, s[44:47], s51 offen offset:1024 lds
    s_waitcnt lgkmcnt(8)
    v_mfma_f32_32x32x16_bf16 a[16:31], v[20:23], v[64:67], a[16:31]
    ds_read_b64_tr_b16 v[40:41], v13 offset:15424
    ds_read_b64_tr_b16 v[42:43], v13 offset:17984
    s_waitcnt lgkmcnt(8)
    v_mfma_f32_32x32x16_bf16 a[32:47], v[24:27], v[64:67], a[32:47]
    ds_read_b64_tr_b16 v[44:45], v13 offset:15488
    ds_read_b64_tr_b16 v[46:47], v13 offset:18048
    s_waitcnt lgkmcnt(8)
    v_mfma_f32_32x32x16_bf16 a[48:63], v[28:31], v[64:67], a[48:63]
    ds_read_b64_tr_b16 v[48:49], v13 offset:15552
    ds_read_b64_tr_b16 v[50:51], v13 offset:18112
    buffer_load_dwordx4 a[88:91], v8, s[32:35], s52 offen offset:2048
    s_waitcnt lgkmcnt(8)
    v_mfma_f32_32x32x16_bf16 a[64:79], v[32:35], v[64:67], a[64:79]
    ds_read_b64_tr_b16 v[52:53], v13 offset:15616
    ds_read_b64_tr_b16 v[54:55], v13 offset:18176
    s_waitcnt lgkmcnt(8)
    v_mfma_f32_32x32x16_bf16 a[0:15], v[36:39], v[68:71], a[0:15]
    ds_read_b64_tr_b16 v[16:17], v13 offset:20480
    ds_read_b64_tr_b16 v[18:19], v13 offset:23040
    s_waitcnt lgkmcnt(8)
    v_mfma_f32_32x32x16_bf16 a[16:31], v[40:43], v[68:71], a[16:31]
    ds_read_b64_tr_b16 v[20:21], v13 offset:20544
    ds_read_b64_tr_b16 v[22:23], v13 offset:23104
    buffer_load_dwordx4 a[92:95], v8, s[32:35], s52 offen offset:3072
    s_waitcnt lgkmcnt(8)
    v_mfma_f32_32x32x16_bf16 a[32:47], v[44:47], v[68:71], a[32:47]
    ds_read_b64_tr_b16 v[24:25], v13 offset:20608
    ds_read_b64_tr_b16 v[26:27], v13 offset:23168
    s_waitcnt lgkmcnt(8)
    v_mfma_f32_32x32x16_bf16 a[48:63], v[48:51], v[68:71], a[48:63]
    ds_read_b64_tr_b16 v[28:29], v13 offset:20672
    ds_read_b64_tr_b16 v[30:31], v13 offset:23232
    s_waitcnt lgkmcnt(8)
    v_mfma_f32_32x32x16_bf16 a[64:79], v[52:55], v[68:71], a[64:79]
    ds_read_b64_tr_b16 v[32:33], v13 offset:20736
    ds_read_b64_tr_b16 v[34:35], v13 offset:23296
    buffer_load_dwordx4 v5, s[44:47], s51 offen offset:2048 lds
    s_waitcnt lgkmcnt(8)
    v_mfma_f32_32x32x16_bf16 a[0:15], v[16:19], v[72:75], a[0:15]
    ds_read_b64_tr_b16 v[36:37], v13 offset:25600
    ds_read_b64_tr_b16 v[38:39], v13 offset:28160
    s_waitcnt lgkmcnt(8)
    v_mfma_f32_32x32x16_bf16 a[16:31], v[20:23], v[72:75], a[16:31]
    ds_read_b64_tr_b16 v[40:41], v13 offset:25664
    ds_read_b64_tr_b16 v[42:43], v13 offset:28224
    s_waitcnt lgkmcnt(8)
    v_mfma_f32_32x32x16_bf16 a[32:47], v[24:27], v[72:75], a[32:47]
    ds_read_b64_tr_b16 v[44:45], v13 offset:25728
    ds_read_b64_tr_b16 v[46:47], v13 offset:28288
    s_add_u32 s52, s70, 253952
    buffer_load_dwordx4 a[96:99], v8, s[32:35], s52 offen offset:0
    s_waitcnt lgkmcnt(8)
    v_mfma_f32_32x32x16_bf16 a[48:63], v[28:31], v[72:75], a[48:63]
    ds_read_b64_tr_b16 v[48:49], v13 offset:25792
    ds_read_b64_tr_b16 v[50:51], v13 offset:28352
    s_waitcnt lgkmcnt(8)
    v_mfma_f32_32x32x16_bf16 a[64:79], v[32:35], v[72:75], a[64:79]
    ds_read_b64_tr_b16 v[52:53], v13 offset:25856
    ds_read_b64_tr_b16 v[54:55], v13 offset:28416
    s_waitcnt lgkmcnt(8)
    v_mfma_f32_32x32x16_bf16 a[0:15], v[36:39], v[76:79], a[0:15]
    ds_read_b64_tr_b16 v[16:17], v13 offset:30720
    ds_read_b64_tr_b16 v[18:19], v13 offset:33280
    buffer_load_dwordx4 a[100:103], v8, s[32:35], s52 offen offset:1024
    s_waitcnt lgkmcnt(8)
    v_mfma_f32_32x32x16_bf16 a[16:31], v[40:43], v[76:79], a[16:31]
    ds_read_b64_tr_b16 v[20:21], v13 offset:30784
    ds_read_b64_tr_b16 v[22:23], v13 offset:33344
    s_waitcnt lgkmcnt(8)
    v_mfma_f32_32x32x16_bf16 a[32:47], v[44:47], v[76:79], a[32:47]
    ds_read_b64_tr_b16 v[24:25], v13 offset:30848
    ds_read_b64_tr_b16 v[26:27], v13 offset:33408
    s_waitcnt lgkmcnt(8)
    v_mfma_f32_32x32x16_bf16 a[48:63], v[48:51], v[76:79], a[48:63]
    ds_read_b64_tr_b16 v[28:29], v13 offset:30912
    ds_read_b64_tr_b16 v[30:31], v13 offset:33472
    buffer_load_dwordx4 v6, s[44:47], s51 offen offset:3072 lds
    s_waitcnt lgkmcnt(8)
    v_mfma_f32_32x32x16_bf16 a[64:79], v[52:55], v[76:79], a[64:79]
    ds_read_b64_tr_b16 v[32:33], v13 offset:30976
    ds_read_b64_tr_b16 v[34:35], v13 offset:33536
    s_waitcnt lgkmcnt(8)
    v_mfma_f32_32x32x16_bf16 a[0:15], v[16:19], v[80:83], a[0:15]
    ds_read_b64_tr_b16 v[36:37], v13 offset:35840
    ds_read_b64_tr_b16 v[38:39], v13 offset:38400
    s_waitcnt lgkmcnt(8)
    v_mfma_f32_32x32x16_bf16 a[16:31], v[20:23], v[80:83], a[16:31]
    ds_read_b64_tr_b16 v[40:41], v13 offset:35904
    ds_read_b64_tr_b16 v[42:43], v13 offset:38464
    buffer_load_dwordx4 a[104:107], v8, s[32:35], s52 offen offset:2048
    s_waitcnt lgkmcnt(8)
    v_mfma_f32_32x32x16_bf16 a[32:47], v[24:27], v[80:83], a[32:47]
    ds_read_b64_tr_b16 v[44:45], v13 offset:35968
    ds_read_b64_tr_b16 v[46:47], v13 offset:38528
    s_waitcnt lgkmcnt(8)
    v_mfma_f32_32x32x16_bf16 a[48:63], v[28:31], v[80:83], a[48:63]
    ds_read_b64_tr_b16 v[48:49], v13 offset:36032
    ds_read_b64_tr_b16 v[50:51], v13 offset:38592
    s_waitcnt lgkmcnt(8)
    v_mfma_f32_32x32x16_bf16 a[64:79], v[32:35], v[80:83], a[64:79]
    ds_read_b64_tr_b16 v[52:53], v13 offset:36096
    ds_read_b64_tr_b16 v[54:55], v13 offset:38656
    buffer_load_dwordx4 a[108:111], v8, s[32:35], s52 offen offset:3072
    s_waitcnt lgkmcnt(8)
    v_mfma_f32_32x32x16_bf16 a[0:15], v[36:39], v[84:87], a[0:15]
    ds_read_b64_tr_b16 v[16:17], v2 offset:0
    ds_read_b64_tr_b16 v[18:19], v2 offset:2560
    s_waitcnt lgkmcnt(8)
    v_mfma_f32_32x32x16_bf16 a[16:31], v[40:43], v[84:87], a[16:31]
    ds_read_b64_tr_b16 v[20:21], v2 offset:64
    ds_read_b64_tr_b16 v[22:23], v2 offset:2624
    s_waitcnt lgkmcnt(8)
    v_mfma_f32_32x32x16_bf16 a[32:47], v[44:47], v[84:87], a[32:47]
    ds_read_b64_tr_b16 v[24:25], v2 offset:128
    ds_read_b64_tr_b16 v[26:27], v2 offset:2688
    s_add_u32 m0, s60, 86016
    s_nop 0
    buffer_load_dwordx4 v7, s[44:47], s51 offen offset:0 lds
    s_waitcnt lgkmcnt(8)
    v_mfma_f32_32x32x16_bf16 a[48:63], v[48:51], v[84:87], a[48:63]
    ds_read_b64_tr_b16 v[28:29], v2 offset:192
    ds_read_b64_tr_b16 v[30:31], v2 offset:2752
    s_waitcnt lgkmcnt(8)
    v_mfma_f32_32x32x16_bf16 a[64:79], v[52:55], v[84:87], a[64:79]
    ds_read_b64_tr_b16 v[32:33], v2 offset:256
    ds_read_b64_tr_b16 v[34:35], v2 offset:2816
    s_waitcnt vmcnt(13)
    s_barrier
    s_waitcnt lgkmcnt(8)
    v_mfma_f32_32x32x16_bf16 a[0:15], v[16:19], a[112:115], a[0:15]
    ds_read_b64_tr_b16 v[36:37], v2 offset:5120
    ds_read_b64_tr_b16 v[38:39], v2 offset:7680
    s_waitcnt lgkmcnt(8)
    v_mfma_f32_32x32x16_bf16 a[16:31], v[20:23], a[112:115], a[16:31]
    ds_read_b64_tr_b16 v[40:41], v2 offset:5184
    ds_read_b64_tr_b16 v[42:43], v2 offset:7744
    s_add_u32 m0, s60, 122880
    s_add_u32 s51, s71, 2129920
    buffer_load_dwordx4 v3, s[44:47], s51 offen offset:0 lds
    s_waitcnt lgkmcnt(8)
    v_mfma_f32_32x32x16_bf16 a[32:47], v[24:27], a[112:115], a[32:47]
    ds_read_b64_tr_b16 v[44:45], v2 offset:5248
    ds_read_b64_tr_b16 v[46:47], v2 offset:7808
    s_waitcnt lgkmcnt(8)
    v_mfma_f32_32x32x16_bf16 a[48:63], v[28:31], a[112:115], a[48:63]
    ds_read_b64_tr_b16 v[48:49], v2 offset:5312
    ds_read_b64_tr_b16 v[50:51], v2 offset:7872
    s_waitcnt lgkmcnt(8)
    v_mfma_f32_32x32x16_bf16 a[64:79], v[32:35], a[112:115], a[64:79]
    ds_read_b64_tr_b16 v[52:53], v2 offset:5376
    ds_read_b64_tr_b16 v[54:55], v2 offset:7936
    s_add_u32 s52, s70, 393216
    buffer_load_dwordx4 v[56:59], v8, s[32:35], s52 offen offset:0
    s_waitcnt lgkmcnt(8)
    v_mfma_f32_32x32x16_bf16 a[0:15], v[36:39], a[116:119], a[0:15]
    ds_read_b64_tr_b16 v[16:17], v2 offset:10240
    ds_read_b64_tr_b16 v[18:19], v2 offset:12800
    s_waitcnt lgkmcnt(8)
    v_mfma_f32_32x32x16_bf16 a[16:31], v[40:43], a[116:119], a[16:31]
    ds_read_b64_tr_b16 v[20:21], v2 offset:10304
    ds_read_b64_tr_b16 v[22:23], v2 offset:12864
    s_waitcnt lgkmcnt(8)
    v_mfma_f32_32x32x16_bf16 a[32:47], v[44:47], a[116:119], a[32:47]
    ds_read_b64_tr_b16 v[24:25], v2 offset:10368
    ds_read_b64_tr_b16 v[26:27], v2 offset:12928
    buffer_load_dwordx4 v[60:63], v8, s[32:35], s52 offen offset:1024
    s_waitcnt lgkmcnt(8)
    v_mfma_f32_32x32x16_bf16 a[48:63], v[48:51], a[116:119], a[48:63]
    ds_read_b64_tr_b16 v[28:29], v2 offset:10432
    ds_read_b64_tr_b16 v[30:31], v2 offset:12992
    s_waitcnt lgkmcnt(8)
    v_mfma_f32_32x32x16_bf16 a[64:79], v[52:55], a[116:119], a[64:79]
    ds_read_b64_tr_b16 v[32:33], v2 offset:10496
    ds_read_b64_tr_b16 v[34:35], v2 offset:13056
    s_waitcnt lgkmcnt(8)
    v_mfma_f32_32x32x16_bf16 a[0:15], v[16:19], a[120:123], a[0:15]
    ds_read_b64_tr_b16 v[36:37], v2 offset:15360
    ds_read_b64_tr_b16 v[38:39], v2 offset:17920
    buffer_load_dwordx4 v4, s[44:47], s51 offen offset:1024 lds
    s_waitcnt lgkmcnt(8)
    v_mfma_f32_32x32x16_bf16 a[16:31], v[20:23], a[120:123], a[16:31]
    ds_read_b64_tr_b16 v[40:41], v2 offset:15424
    ds_read_b64_tr_b16 v[42:43], v2 offset:17984
    s_waitcnt lgkmcnt(8)
    v_mfma_f32_32x32x16_bf16 a[32:47], v[24:27], a[120:123], a[32:47]
    ds_read_b64_tr_b16 v[44:45], v2 offset:15488
    ds_read_b64_tr_b16 v[46:47], v2 offset:18048
    s_waitcnt lgkmcnt(8)
    v_mfma_f32_32x32x16_bf16 a[48:63], v[28:31], a[120:123], a[48:63]
    ds_read_b64_tr_b16 v[48:49], v2 offset:15552
    ds_read_b64_tr_b16 v[50:51], v2 offset:18112
    buffer_load_dwordx4 v[64:67], v8, s[32:35], s52 offen offset:2048
    s_waitcnt lgkmcnt(8)
    v_mfma_f32_32x32x16_bf16 a[64:79], v[32:35], a[120:123], a[64:79]
    ds_read_b64_tr_b16 v[52:53], v2 offset:15616
    ds_read_b64_tr_b16 v[54:55], v2 offset:18176
    s_waitcnt lgkmcnt(8)
    v_mfma_f32_32x32x16_bf16 a[0:15], v[36:39], a[124:127], a[0:15]
    ds_read_b64_tr_b16 v[16:17], v2 offset:20480
    ds_read_b64_tr_b16 v[18:19], v2 offset:23040
    s_waitcnt lgkmcnt(8)
    v_mfma_f32_32x32x16_bf16 a[16:31], v[40:43], a[124:127], a[16:31]
    ds_read_b64_tr_b16 v[20:21], v2 offset:20544
    ds_read_b64_tr_b16 v[22:23], v2 offset:23104
    buffer_load_dwordx4 v[68:71], v8, s[32:35], s52 offen offset:3072
    s_waitcnt lgkmcnt(8)
    v_mfma_f32_32x32x16_bf16 a[32:47], v[44:47], a[124:127], a[32:47]
    ds_read_b64_tr_b16 v[24:25], v2 offset:20608
    ds_read_b64_tr_b16 v[26:27], v2 offset:23168
    s_waitcnt lgkmcnt(8)
    v_mfma_f32_32x32x16_bf16 a[48:63], v[48:51], a[124:127], a[48:63]
    ds_read_b64_tr_b16 v[28:29], v2 offset:20672
    ds_read_b64_tr_b16 v[30:31], v2 offset:23232
    s_waitcnt lgkmcnt(8)
    v_mfma_f32_32x32x16_bf16 a[64:79], v[52:55], a[124:127], a[64:79]
    ds_read_b64_tr_b16 v[32:33], v2 offset:20736
    ds_read_b64_tr_b16 v[34:35], v2 offset:23296
    buffer_load_dwordx4 v5, s[44:47], s51 offen offset:2048 lds
    s_waitcnt lgkmcnt(8)
    v_mfma_f32_32x32x16_bf16 a[0:15], v[16:19], a[128:131], a[0:15]
    ds_read_b64_tr_b16 v[36:37], v2 offset:25600
    ds_read_b64_tr_b16 v[38:39], v2 offset:28160
    s_waitcnt lgkmcnt(8)
    v_mfma_f32_32x32x16_bf16 a[16:31], v[20:23], a[128:131], a[16:31]
    ds_read_b64_tr_b16 v[40:41], v2 offset:25664
    ds_read_b64_tr_b16 v[42:43], v2 offset:28224
    s_waitcnt lgkmcnt(8)
    v_mfma_f32_32x32x16_bf16 a[32:47], v[24:27], a[128:131], a[32:47]
    ds_read_b64_tr_b16 v[44:45], v2 offset:25728
    ds_read_b64_tr_b16 v[46:47], v2 offset:28288
    s_add_u32 s52, s70, 397312
    buffer_load_dwordx4 v[72:75], v8, s[32:35], s52 offen offset:0
    s_waitcnt lgkmcnt(8)
    v_mfma_f32_32x32x16_bf16 a[48:63], v[28:31], a[128:131], a[48:63]
    ds_read_b64_tr_b16 v[48:49], v2 offset:25792
    ds_read_b64_tr_b16 v[50:51], v2 offset:28352
    s_waitcnt lgkmcnt(8)
    v_mfma_f32_32x32x16_bf16 a[64:79], v[32:35], a[128:131], a[64:79]
    ds_read_b64_tr_b16 v[52:53], v2 offset:25856
    ds_read_b64_tr_b16 v[54:55], v2 offset:28416
    s_waitcnt lgkmcnt(8)
    v_mfma_f32_32x32x16_bf16 a[0:15], v[36:39], a[132:135], a[0:15]
    ds_read_b64_tr_b16 v[16:17], v2 offset:30720
    ds_read_b64_tr_b16 v[18:19], v2 offset:33280
    buffer_load_dwordx4 v[76:79], v8, s[32:35], s52 offen offset:1024
    s_waitcnt lgkmcnt(8)
    v_mfma_f32_32x32x16_bf16 a[16:31], v[40:43], a[132:135], a[16:31]
    ds_read_b64_tr_b16 v[20:21], v2 offset:30784
    ds_read_b64_tr_b16 v[22:23], v2 offset:33344
    s_waitcnt lgkmcnt(8)
    v_mfma_f32_32x32x16_bf16 a[32:47], v[44:47], a[132:135], a[32:47]
    ds_read_b64_tr_b16 v[24:25], v2 offset:30848
    ds_read_b64_tr_b16 v[26:27], v2 offset:33408
    s_waitcnt lgkmcnt(8)
    v_mfma_f32_32x32x16_bf16 a[48:63], v[48:51], a[132:135], a[48:63]
    ds_read_b64_tr_b16 v[28:29], v2 offset:30912
    ds_read_b64_tr_b16 v[30:31], v2 offset:33472
    buffer_load_dwordx4 v6, s[44:47], s51 offen offset:3072 lds
    s_waitcnt lgkmcnt(8)
    v_mfma_f32_32x32x16_bf16 a[64:79], v[52:55], a[132:135], a[64:79]
    ds_read_b64_tr_b16 v[32:33], v2 offset:30976
    ds_read_b64_tr_b16 v[34:35], v2 offset:33536
    s_waitcnt lgkmcnt(8)
    v_mfma_f32_32x32x16_bf16 a[0:15], v[16:19], a[136:139], a[0:15]
    ds_read_b64_tr_b16 v[36:37], v2 offset:35840
    ds_read_b64_tr_b16 v[38:39], v2 offset:38400
    s_waitcnt lgkmcnt(8)
    v_mfma_f32_32x32x16_bf16 a[16:31], v[20:23], a[136:139], a[16:31]
    ds_read_b64_tr_b16 v[40:41], v2 offset:35904
    ds_read_b64_tr_b16 v[42:43], v2 offset:38464
    buffer_load_dwordx4 v[80:83], v8, s[32:35], s52 offen offset:2048
    s_waitcnt lgkmcnt(8)
    v_mfma_f32_32x32x16_bf16 a[32:47], v[24:27], a[136:139], a[32:47]
    ds_read_b64_tr_b16 v[44:45], v2 offset:35968
    ds_read_b64_tr_b16 v[46:47], v2 offset:38528
    s_waitcnt lgkmcnt(8)
    v_mfma_f32_32x32x16_bf16 a[48:63], v[28:31], a[136:139], a[48:63]
    ds_read_b64_tr_b16 v[48:49], v2 offset:36032
    ds_read_b64_tr_b16 v[50:51], v2 offset:38592
    s_waitcnt lgkmcnt(8)
    v_mfma_f32_32x32x16_bf16 a[64:79], v[32:35], a[136:139], a[64:79]
    ds_read_b64_tr_b16 v[52:53], v2 offset:36096
    ds_read_b64_tr_b16 v[54:55], v2 offset:38656
    buffer_load_dwordx4 v[84:87], v8, s[32:35], s52 offen offset:3072
    s_waitcnt lgkmcnt(8)
    v_mfma_f32_32x32x16_bf16 a[0:15], v[36:39], a[140:143], a[0:15]
    ds_read_b64_tr_b16 v[16:17], v11 offset:0
    ds_read_b64_tr_b16 v[18:19], v11 offset:2560
    s_waitcnt lgkmcnt(8)
    v_mfma_f32_32x32x16_bf16 a[16:31], v[40:43], a[140:143], a[16:31]
    ds_read_b64_tr_b16 v[20:21], v11 offset:64
    ds_read_b64_tr_b16 v[22:23], v11 offset:2624
    s_waitcnt lgkmcnt(8)
    v_mfma_f32_32x32x16_bf16 a[32:47], v[44:47], a[140:143], a[32:47]
    ds_read_b64_tr_b16 v[24:25], v11 offset:128
    ds_read_b64_tr_b16 v[26:27], v11 offset:2688
    s_add_u32 m0, s60, 126976
    s_nop 0
    buffer_load_dwordx4 v7, s[44:47], s51 offen offset:0 lds
    s_waitcnt lgkmcnt(8)
    v_mfma_f32_32x32x16_bf16 a[48:63], v[48:51], a[140:143], a[48:63]
    ds_read_b64_tr_b16 v[28:29], v11 offset:192
    ds_read_b64_tr_b16 v[30:31], v11 offset:2752
    s_waitcnt lgkmcnt(8)
    v_mfma_f32_32x32x16_bf16 a[64:79], v[52:55], a[140:143], a[64:79]
    ds_read_b64_tr_b16 v[32:33], v11 offset:256
    ds_read_b64_tr_b16 v[34:35], v11 offset:2816
    s_waitcnt vmcnt(13)
    s_barrier
    buffer_load_dwordx4 a[144:147], v1, s[24:27], 0 offen sc1
    s_waitcnt lgkmcnt(8)
    v_mfma_f32_32x32x16_bf16 a[0:15], v[16:19], a[80:83], a[0:15]
    ds_read_b64_tr_b16 v[36:37], v11 offset:5120
    ds_read_b64_tr_b16 v[38:39], v11 offset:7680
    s_waitcnt lgkmcnt(8)
    v_mfma_f32_32x32x16_bf16 a[16:31], v[20:23], a[80:83], a[16:31]
    ds_read_b64_tr_b16 v[40:41], v11 offset:5184
    ds_read_b64_tr_b16 v[42:43], v11 offset:7744
    s_add_u32 m0, s60, 0
    s_add_u32 s51, s71, 2293760
    buffer_load_dwordx4 v3, s[44:47], s51 offen offset:0 lds
    s_waitcnt lgkmcnt(8)
    v_mfma_f32_32x32x16_bf16 a[32:47], v[24:27], a[80:83], a[32:47]
    ds_read_b64_tr_b16 v[44:45], v11 offset:5248
    ds_read_b64_tr_b16 v[46:47], v11 offset:7808
    s_waitcnt lgkmcnt(8)
    v_mfma_f32_32x32x16_bf16 a[48:63], v[28:31], a[80:83], a[48:63]
    ds_read_b64_tr_b16 v[48:49], v11 offset:5312
    ds_read_b64_tr_b16 v[50:51], v11 offset:7872
    s_waitcnt lgkmcnt(8)
    v_mfma_f32_32x32x16_bf16 a[64:79], v[32:35], a[80:83], a[64:79]
    ds_read_b64_tr_b16 v[52:53], v11 offset:5376
    ds_read_b64_tr_b16 v[54:55], v11 offset:7936
    s_add_u32 s52, s70, 401408
    buffer_load_dwordx4 a[112:115], v8, s[32:35], s52 offen offset:0
    s_waitcnt lgkmcnt(8)
    v_mfma_f32_32x32x16_bf16 a[0:15], v[36:39], a[84:87], a[0:15]
    ds_read_b64_tr_b16 v[16:17], v11 offset:10240
    ds_read_b64_tr_b16 v[18:19], v11 offset:12800
    s_waitcnt lgkmcnt(8)
    v_mfma_f32_32x32x16_bf16 a[16:31], v[40:43], a[84:87], a[16:31]
    ds_read_b64_tr_b16 v[20:21], v11 offset:10304
    ds_read_b64_tr_b16 v[22:23], v11 offset:12864
    s_waitcnt lgkmcnt(8)
    v_mfma_f32_32x32x16_bf16 a[32:47], v[44:47], a[84:87], a[32:47]
    ds_read_b64_tr_b16 v[24:25], v11 offset:10368
    ds_read_b64_tr_b16 v[26:27], v11 offset:12928
    buffer_load_dwordx4 a[116:119], v8, s[32:35], s52 offen offset:1024
    s_waitcnt lgkmcnt(8)
    v_mfma_f32_32x32x16_bf16 a[48:63], v[48:51], a[84:87], a[48:63]
    ds_read_b64_tr_b16 v[28:29], v11 offset:10432
    ds_read_b64_tr_b16 v[30:31], v11 offset:12992
    s_waitcnt lgkmcnt(8)
    v_mfma_f32_32x32x16_bf16 a[64:79], v[52:55], a[84:87], a[64:79]
    ds_read_b64_tr_b16 v[32:33], v11 offset:10496
    ds_read_b64_tr_b16 v[34:35], v11 offset:13056
    s_waitcnt lgkmcnt(8)
    v_mfma_f32_32x32x16_bf16 a[0:15], v[16:19], a[88:91], a[0:15]
    ds_read_b64_tr_b16 v[36:37], v11 offset:15360
    ds_read_b64_tr_b16 v[38:39], v11 offset:17920
    buffer_load_dwordx4 v4, s[44:47], s51 offen offset:1024 lds
    s_waitcnt lgkmcnt(8)
    v_mfma_f32_32x32x16_bf16 a[16:31], v[20:23], a[88:91], a[16:31]
    ds_read_b64_tr_b16 v[40:41], v11 offset:15424
    ds_read_b64_tr_b16 v[42:43], v11 offset:17984
    s_waitcnt lgkmcnt(8)
    v_mfma_f32_32x32x16_bf16 a[32:47], v[24:27], a[88:91], a[32:47]
    ds_read_b64_tr_b16 v[44:45], v11 offset:15488
    ds_read_b64_tr_b16 v[46:47], v11 offset:18048
    s_waitcnt lgkmcnt(8)
    v_mfma_f32_32x32x16_bf16 a[48:63], v[28:31], a[88:91], a[48:63]
    ds_read_b64_tr_b16 v[48:49], v11 offset:15552
    ds_read_b64_tr_b16 v[50:51], v11 offset:18112
    buffer_load_dwordx4 a[120:123], v8, s[32:35], s52 offen offset:2048
    s_waitcnt lgkmcnt(8)
    v_mfma_f32_32x32x16_bf16 a[64:79], v[32:35], a[88:91], a[64:79]
    ds_read_b64_tr_b16 v[52:53], v11 offset:15616
    ds_read_b64_tr_b16 v[54:55], v11 offset:18176
    s_waitcnt lgkmcnt(8)
    v_mfma_f32_32x32x16_bf16 a[0:15], v[36:39], a[92:95], a[0:15]
    ds_read_b64_tr_b16 v[16:17], v11 offset:20480
    ds_read_b64_tr_b16 v[18:19], v11 offset:23040
    s_waitcnt lgkmcnt(8)
    v_mfma_f32_32x32x16_bf16 a[16:31], v[40:43], a[92:95], a[16:31]
    ds_read_b64_tr_b16 v[20:21], v11 offset:20544
    ds_read_b64_tr_b16 v[22:23], v11 offset:23104
    buffer_load_dwordx4 a[124:127], v8, s[32:35], s52 offen offset:3072
    s_waitcnt lgkmcnt(8)
    v_mfma_f32_32x32x16_bf16 a[32:47], v[44:47], a[92:95], a[32:47]
    ds_read_b64_tr_b16 v[24:25], v11 offset:20608
    ds_read_b64_tr_b16 v[26:27], v11 offset:23168
    s_waitcnt lgkmcnt(8)
    v_mfma_f32_32x32x16_bf16 a[48:63], v[48:51], a[92:95], a[48:63]
    ds_read_b64_tr_b16 v[28:29], v11 offset:20672
    ds_read_b64_tr_b16 v[30:31], v11 offset:23232
    s_waitcnt lgkmcnt(8)
    v_mfma_f32_32x32x16_bf16 a[64:79], v[52:55], a[92:95], a[64:79]
    ds_read_b64_tr_b16 v[32:33], v11 offset:20736
    ds_read_b64_tr_b16 v[34:35], v11 offset:23296
    buffer_load_dwordx4 v5, s[44:47], s51 offen offset:2048 lds
    s_waitcnt lgkmcnt(8)
    v_mfma_f32_32x32x16_bf16 a[0:15], v[16:19], a[96:99], a[0:15]
    ds_read_b64_tr_b16 v[36:37], v11 offset:25600
    ds_read_b64_tr_b16 v[38:39], v11 offset:28160
    s_waitcnt lgkmcnt(8)
    v_mfma_f32_32x32x16_bf16 a[16:31], v[20:23], a[96:99], a[16:31]
    ds_read_b64_tr_b16 v[40:41], v11 offset:25664
    ds_read_b64_tr_b16 v[42:43], v11 offset:28224
    s_waitcnt lgkmcnt(8)
    v_mfma_f32_32x32x16_bf16 a[32:47], v[24:27], a[96:99], a[32:47]
    ds_read_b64_tr_b16 v[44:45], v11 offset:25728
    ds_read_b64_tr_b16 v[46:47], v11 offset:28288
    s_add_u32 s52, s70, 442368
    buffer_load_dwordx4 a[128:131], v8, s[32:35], s52 offen offset:0
    s_waitcnt lgkmcnt(8)
    v_mfma_f32_32x32x16_bf16 a[48:63], v[28:31], a[96:99], a[48:63]
    ds_read_b64_tr_b16 v[48:49], v11 offset:25792
    ds_read_b64_tr_b16 v[50:51], v11 offset:28352
    s_waitcnt lgkmcnt(8)
    v_mfma_f32_32x32x16_bf16 a[64:79], v[32:35], a[96:99], a[64:79]
    ds_read_b64_tr_b16 v[52:53], v11 offset:25856
    ds_read_b64_tr_b16 v[54:55], v11 offset:28416
    s_waitcnt lgkmcnt(8)
    v_mfma_f32_32x32x16_bf16 a[0:15], v[36:39], a[100:103], a[0:15]
    ds_read_b64_tr_b16 v[16:17], v11 offset:30720
    ds_read_b64_tr_b16 v[18:19], v11 offset:33280
    buffer_load_dwordx4 a[132:135], v8, s[32:35], s52 offen offset:1024
    s_waitcnt lgkmcnt(8)
    v_mfma_f32_32x32x16_bf16 a[16:31], v[40:43], a[100:103], a[16:31]
    ds_read_b64_tr_b16 v[20:21], v11 offset:30784
    ds_read_b64_tr_b16 v[22:23], v11 offset:33344
    s_waitcnt lgkmcnt(8)
    v_mfma_f32_32x32x16_bf16 a[32:47], v[44:47], a[100:103], a[32:47]
    ds_read_b64_tr_b16 v[24:25], v11 offset:30848
    ds_read_b64_tr_b16 v[26:27], v11 offset:33408
    s_waitcnt lgkmcnt(8)
    v_mfma_f32_32x32x16_bf16 a[48:63], v[48:51], a[100:103], a[48:63]
    ds_read_b64_tr_b16 v[28:29], v11 offset:30912
    ds_read_b64_tr_b16 v[30:31], v11 offset:33472
    buffer_load_dwordx4 v6, s[44:47], s51 offen offset:3072 lds
    s_waitcnt lgkmcnt(8)
    v_mfma_f32_32x32x16_bf16 a[64:79], v[52:55], a[100:103], a[64:79]
    ds_read_b64_tr_b16 v[32:33], v11 offset:30976
    ds_read_b64_tr_b16 v[34:35], v11 offset:33536
    s_waitcnt lgkmcnt(8)
    v_mfma_f32_32x32x16_bf16 a[0:15], v[16:19], a[104:107], a[0:15]
    ds_read_b64_tr_b16 v[36:37], v11 offset:35840
    ds_read_b64_tr_b16 v[38:39], v11 offset:38400
    s_waitcnt lgkmcnt(8)
    v_mfma_f32_32x32x16_bf16 a[16:31], v[20:23], a[104:107], a[16:31]
    ds_read_b64_tr_b16 v[40:41], v11 offset:35904
    ds_read_b64_tr_b16 v[42:43], v11 offset:38464
    buffer_load_dwordx4 a[136:139], v8, s[32:35], s52 offen offset:2048
    s_waitcnt lgkmcnt(8)
    v_mfma_f32_32x32x16_bf16 a[32:47], v[24:27], a[104:107], a[32:47]
    ds_read_b64_tr_b16 v[44:45], v11 offset:35968
    ds_read_b64_tr_b16 v[46:47], v11 offset:38528
    s_waitcnt lgkmcnt(8)
    v_mfma_f32_32x32x16_bf16 a[48:63], v[28:31], a[104:107], a[48:63]
    ds_read_b64_tr_b16 v[48:49], v11 offset:36032
    ds_read_b64_tr_b16 v[50:51], v11 offset:38592
    s_waitcnt lgkmcnt(8)
    v_mfma_f32_32x32x16_bf16 a[64:79], v[32:35], a[104:107], a[64:79]
    ds_read_b64_tr_b16 v[52:53], v11 offset:36096
    ds_read_b64_tr_b16 v[54:55], v11 offset:38656
    buffer_load_dwordx4 a[140:143], v8, s[32:35], s52 offen offset:3072
    s_waitcnt lgkmcnt(8)
    v_mfma_f32_32x32x16_bf16 a[0:15], v[36:39], a[108:111], a[0:15]
    ds_read_b64_tr_b16 v[16:17], v12 offset:0
    ds_read_b64_tr_b16 v[18:19], v12 offset:2560
    s_waitcnt lgkmcnt(8)
    v_mfma_f32_32x32x16_bf16 a[16:31], v[40:43], a[108:111], a[16:31]
    ds_read_b64_tr_b16 v[20:21], v12 offset:64
    ds_read_b64_tr_b16 v[22:23], v12 offset:2624
    s_waitcnt lgkmcnt(8)
    v_mfma_f32_32x32x16_bf16 a[32:47], v[44:47], a[108:111], a[32:47]
    ds_read_b64_tr_b16 v[24:25], v12 offset:128
    ds_read_b64_tr_b16 v[26:27], v12 offset:2688
    s_add_u32 m0, s60, 4096
    s_nop 0
    buffer_load_dwordx4 v7, s[44:47], s51 offen offset:0 lds
    s_waitcnt lgkmcnt(8)
    v_mfma_f32_32x32x16_bf16 a[48:63], v[48:51], a[108:111], a[48:63]
    ds_read_b64_tr_b16 v[28:29], v12 offset:192
    ds_read_b64_tr_b16 v[30:31], v12 offset:2752
    s_waitcnt lgkmcnt(8)
    v_mfma_f32_32x32x16_bf16 a[64:79], v[52:55], a[108:111], a[64:79]
    ds_read_b64_tr_b16 v[32:33], v12 offset:256
    ds_read_b64_tr_b16 v[34:35], v12 offset:2816
    s_waitcnt vmcnt(14)
    s_barrier
    s_waitcnt lgkmcnt(8)
    v_mfma_f32_32x32x16_bf16 a[0:15], v[16:19], v[56:59], a[0:15]
    ds_read_b64_tr_b16 v[36:37], v12 offset:5120
    ds_read_b64_tr_b16 v[38:39], v12 offset:7680
    s_waitcnt lgkmcnt(8)
    v_mfma_f32_32x32x16_bf16 a[16:31], v[20:23], v[56:59], a[16:31]
    ds_read_b64_tr_b16 v[40:41], v12 offset:5184
    ds_read_b64_tr_b16 v[42:43], v12 offset:7744
    s_add_u32 m0, s60, 40960
    s_add_u32 s51, s71, 2949120
    buffer_load_dwordx4 v3, s[44:47], s51 offen offset:0 lds
    s_waitcnt lgkmcnt(8)
    v_mfma_f32_32x32x16_bf16 a[32:47], v[24:27], v[56:59], a[32:47]
    ds_read_b64_tr_b16 v[44:45], v12 offset:5248
    ds_read_b64_tr_b16 v[46:47], v12 offset:7808
    s_waitcnt lgkmcnt(8)
    v_mfma_f32_32x32x16_bf16 a[48:63], v[28:31], v[56:59], a[48:63]
    ds_read_b64_tr_b16 v[48:49], v12 offset:5312
    ds_read_b64_tr_b16 v[50:51], v12 offset:7872
    s_waitcnt lgkmcnt(8)
    v_mfma_f32_32x32x16_bf16 a[64:79], v[32:35], v[56:59], a[64:79]
    ds_read_b64_tr_b16 v[52:53], v12 offset:5376
    ds_read_b64_tr_b16 v[54:55], v12 offset:7936
    s_add_u32 s52, s70, 446464
    buffer_load_dwordx4 a[80:83], v8, s[32:35], s52 offen offset:0
    s_waitcnt lgkmcnt(8)
    v_mfma_f32_32x32x16_bf16 a[0:15], v[36:39], v[60:63], a[0:15]
    ds_read_b64_tr_b16 v[16:17], v12 offset:10240
    ds_read_b64_tr_b16 v[18:19], v12 offset:12800
    s_waitcnt lgkmcnt(8)
    v_mfma_f32_32x32x16_bf16 a[16:31], v[40:43], v[60:63], a[16:31]
    ds_read_b64_tr_b16 v[20:21], v12 offset:10304
    ds_read_b64_tr_b16 v[22:23], v12 offset:12864
    s_waitcnt lgkmcnt(8)
    v_mfma_f32_32x32x16_bf16 a[32:47], v[44:47], v[60:63], a[32:47]
    ds_read_b64_tr_b16 v[24:25], v12 offset:10368
    ds_read_b64_tr_b16 v[26:27], v12 offset:12928
    buffer_load_dwordx4 a[84:87], v8, s[32:35], s52 offen offset:1024
    s_waitcnt lgkmcnt(8)
    v_mfma_f32_32x32x16_bf16 a[48:63], v[48:51], v[60:63], a[48:63]
    ds_read_b64_tr_b16 v[28:29], v12 offset:10432
    ds_read_b64_tr_b16 v[30:31], v12 offset:12992
    s_waitcnt lgkmcnt(8)
    v_mfma_f32_32x32x16_bf16 a[64:79], v[52:55], v[60:63], a[64:79]
    ds_read_b64_tr_b16 v[32:33], v12 offset:10496
    ds_read_b64_tr_b16 v[34:35], v12 offset:13056
    s_waitcnt lgkmcnt(8)
    v_mfma_f32_32x32x16_bf16 a[0:15], v[16:19], v[64:67], a[0:15]
    ds_read_b64_tr_b16 v[36:37], v12 offset:15360
    ds_read_b64_tr_b16 v[38:39], v12 offset:17920
    buffer_load_dwordx4 v4, s[44:47], s51 offen offset:1024 lds
    s_waitcnt lgkmcnt(8)
    v_mfma_f32_32x32x16_bf16 a[16:31], v[20:23], v[64:67], a[16:31]
    ds_read_b64_tr_b16 v[40:41], v12 offset:15424
    ds_read_b64_tr_b16 v[42:43], v12 offset:17984
    s_waitcnt lgkmcnt(8)
    v_mfma_f32_32x32x16_bf16 a[32:47], v[24:27], v[64:67], a[32:47]
    ds_read_b64_tr_b16 v[44:45], v12 offset:15488
    ds_read_b64_tr_b16 v[46:47], v12 offset:18048
    s_waitcnt lgkmcnt(8)
    v_mfma_f32_32x32x16_bf16 a[48:63], v[28:31], v[64:67], a[48:63]
    ds_read_b64_tr_b16 v[48:49], v12 offset:15552
    ds_read_b64_tr_b16 v[50:51], v12 offset:18112
    buffer_load_dwordx4 a[88:91], v8, s[32:35], s52 offen offset:2048
    s_waitcnt lgkmcnt(8)
    v_mfma_f32_32x32x16_bf16 a[64:79], v[32:35], v[64:67], a[64:79]
    ds_read_b64_tr_b16 v[52:53], v12 offset:15616
    ds_read_b64_tr_b16 v[54:55], v12 offset:18176
    s_waitcnt lgkmcnt(8)
    v_mfma_f32_32x32x16_bf16 a[0:15], v[36:39], v[68:71], a[0:15]
    ds_read_b64_tr_b16 v[16:17], v12 offset:20480
    ds_read_b64_tr_b16 v[18:19], v12 offset:23040
    s_waitcnt lgkmcnt(8)
    v_mfma_f32_32x32x16_bf16 a[16:31], v[40:43], v[68:71], a[16:31]
    ds_read_b64_tr_b16 v[20:21], v12 offset:20544
    ds_read_b64_tr_b16 v[22:23], v12 offset:23104
    buffer_load_dwordx4 a[92:95], v8, s[32:35], s52 offen offset:3072
    s_waitcnt lgkmcnt(8)
    v_mfma_f32_32x32x16_bf16 a[32:47], v[44:47], v[68:71], a[32:47]
    ds_read_b64_tr_b16 v[24:25], v12 offset:20608
    ds_read_b64_tr_b16 v[26:27], v12 offset:23168
    s_waitcnt lgkmcnt(8)
    v_mfma_f32_32x32x16_bf16 a[48:63], v[48:51], v[68:71], a[48:63]
    ds_read_b64_tr_b16 v[28:29], v12 offset:20672
    ds_read_b64_tr_b16 v[30:31], v12 offset:23232
    s_waitcnt lgkmcnt(8)
    v_mfma_f32_32x32x16_bf16 a[64:79], v[52:55], v[68:71], a[64:79]
    ds_read_b64_tr_b16 v[32:33], v12 offset:20736
    ds_read_b64_tr_b16 v[34:35], v12 offset:23296
    buffer_load_dwordx4 v5, s[44:47], s51 offen offset:2048 lds
    s_waitcnt lgkmcnt(8)
    v_mfma_f32_32x32x16_bf16 a[0:15], v[16:19], v[72:75], a[0:15]
    ds_read_b64_tr_b16 v[36:37], v12 offset:25600
    ds_read_b64_tr_b16 v[38:39], v12 offset:28160
    s_waitcnt lgkmcnt(8)
    v_mfma_f32_32x32x16_bf16 a[16:31], v[20:23], v[72:75], a[16:31]
    ds_read_b64_tr_b16 v[40:41], v12 offset:25664
    ds_read_b64_tr_b16 v[42:43], v12 offset:28224
    s_waitcnt lgkmcnt(8)
    v_mfma_f32_32x32x16_bf16 a[32:47], v[24:27], v[72:75], a[32:47]
    ds_read_b64_tr_b16 v[44:45], v12 offset:25728
    ds_read_b64_tr_b16 v[46:47], v12 offset:28288
    s_add_u32 s52, s70, 450560
    buffer_load_dwordx4 a[96:99], v8, s[32:35], s52 offen offset:0
    s_waitcnt lgkmcnt(8)
    v_mfma_f32_32x32x16_bf16 a[48:63], v[28:31], v[72:75], a[48:63]
    ds_read_b64_tr_b16 v[48:49], v12 offset:25792
    ds_read_b64_tr_b16 v[50:51], v12 offset:28352
    s_waitcnt lgkmcnt(8)
    v_mfma_f32_32x32x16_bf16 a[64:79], v[32:35], v[72:75], a[64:79]
    ds_read_b64_tr_b16 v[52:53], v12 offset:25856
    ds_read_b64_tr_b16 v[54:55], v12 offset:28416
    s_waitcnt lgkmcnt(8)
    v_mfma_f32_32x32x16_bf16 a[0:15], v[36:39], v[76:79], a[0:15]
    ds_read_b64_tr_b16 v[16:17], v12 offset:30720
    ds_read_b64_tr_b16 v[18:19], v12 offset:33280
    buffer_load_dwordx4 a[100:103], v8, s[32:35], s52 offen offset:1024
    s_waitcnt lgkmcnt(8)
    v_mfma_f32_32x32x16_bf16 a[16:31], v[40:43], v[76:79], a[16:31]
    ds_read_b64_tr_b16 v[20:21], v12 offset:30784
    ds_read_b64_tr_b16 v[22:23], v12 offset:33344
    s_waitcnt lgkmcnt(8)
    v_mfma_f32_32x32x16_bf16 a[32:47], v[44:47], v[76:79], a[32:47]
    ds_read_b64_tr_b16 v[24:25], v12 offset:30848
    ds_read_b64_tr_b16 v[26:27], v12 offset:33408
    s_waitcnt lgkmcnt(8)
    v_mfma_f32_32x32x16_bf16 a[48:63], v[48:51], v[76:79], a[48:63]
    ds_read_b64_tr_b16 v[28:29], v12 offset:30912
    ds_read_b64_tr_b16 v[30:31], v12 offset:33472
    buffer_load_dwordx4 v6, s[44:47], s51 offen offset:3072 lds
    s_waitcnt lgkmcnt(8)
    v_mfma_f32_32x32x16_bf16 a[64:79], v[52:55], v[76:79], a[64:79]
    ds_read_b64_tr_b16 v[32:33], v12 offset:30976
    ds_read_b64_tr_b16 v[34:35], v12 offset:33536
    s_waitcnt lgkmcnt(8)
    v_mfma_f32_32x32x16_bf16 a[0:15], v[16:19], v[80:83], a[0:15]
    ds_read_b64_tr_b16 v[36:37], v12 offset:35840
    ds_read_b64_tr_b16 v[38:39], v12 offset:38400
    s_waitcnt lgkmcnt(8)
    v_mfma_f32_32x32x16_bf16 a[16:31], v[20:23], v[80:83], a[16:31]
    ds_read_b64_tr_b16 v[40:41], v12 offset:35904
    ds_read_b64_tr_b16 v[42:43], v12 offset:38464
    buffer_load_dwordx4 a[104:107], v8, s[32:35], s52 offen offset:2048
    s_waitcnt lgkmcnt(8)
    v_mfma_f32_32x32x16_bf16 a[32:47], v[24:27], v[80:83], a[32:47]
    ds_read_b64_tr_b16 v[44:45], v12 offset:35968
    ds_read_b64_tr_b16 v[46:47], v12 offset:38528
    s_waitcnt lgkmcnt(8)
    v_mfma_f32_32x32x16_bf16 a[48:63], v[28:31], v[80:83], a[48:63]
    ds_read_b64_tr_b16 v[48:49], v12 offset:36032
    ds_read_b64_tr_b16 v[50:51], v12 offset:38592
    s_waitcnt lgkmcnt(8)
    v_mfma_f32_32x32x16_bf16 a[64:79], v[32:35], v[80:83], a[64:79]
    ds_read_b64_tr_b16 v[52:53], v12 offset:36096
    ds_read_b64_tr_b16 v[54:55], v12 offset:38656
    buffer_load_dwordx4 a[108:111], v8, s[32:35], s52 offen offset:3072
    s_waitcnt lgkmcnt(8)
    v_mfma_f32_32x32x16_bf16 a[0:15], v[36:39], v[84:87], a[0:15]
    ds_read_b64_tr_b16 v[16:17], v13 offset:0
    ds_read_b64_tr_b16 v[18:19], v13 offset:2560
    s_waitcnt lgkmcnt(8)
    v_mfma_f32_32x32x16_bf16 a[16:31], v[40:43], v[84:87], a[16:31]
    ds_read_b64_tr_b16 v[20:21], v13 offset:64
    ds_read_b64_tr_b16 v[22:23], v13 offset:2624
    s_waitcnt lgkmcnt(8)
    v_mfma_f32_32x32x16_bf16 a[32:47], v[44:47], v[84:87], a[32:47]
    ds_read_b64_tr_b16 v[24:25], v13 offset:128
    ds_read_b64_tr_b16 v[26:27], v13 offset:2688
    s_add_u32 m0, s60, 45056
    s_nop 0
    buffer_load_dwordx4 v7, s[44:47], s51 offen offset:0 lds
    s_waitcnt lgkmcnt(8)
    v_mfma_f32_32x32x16_bf16 a[48:63], v[48:51], v[84:87], a[48:63]
    ds_read_b64_tr_b16 v[28:29], v13 offset:192
    ds_read_b64_tr_b16 v[30:31], v13 offset:2752
    s_waitcnt lgkmcnt(8)
    v_mfma_f32_32x32x16_bf16 a[64:79], v[52:55], v[84:87], a[64:79]
    ds_read_b64_tr_b16 v[32:33], v13 offset:256
    ds_read_b64_tr_b16 v[34:35], v13 offset:2816
    s_waitcnt vmcnt(13)
    v_accvgpr_read_b32 v15, a144
    s_nop 0
    v_readfirstlane_b32 s52, v15
    v_accvgpr_read_b32 v15, a145
    s_nop 0
    v_readfirstlane_b32 s53, v15
    s_nop 1
    s_min_u32 s52, s52, s53
    v_accvgpr_read_b32 v15, a146
    s_nop 0
    v_readfirstlane_b32 s53, v15
    s_nop 1
    s_min_u32 s52, s52, s53
    v_accvgpr_read_b32 v15, a147
    s_nop 0
    v_readfirstlane_b32 s53, v15
    s_nop 1
    s_min_u32 s52, s52, s53
    s_cmp_lt_u32 s52, 4
    s_cbranch_scc1 oproj_SPIN1
oproj_RET1:
    s_barrier
    s_waitcnt lgkmcnt(8)
    v_mfma_f32_32x32x16_bf16 a[0:15], v[16:19], a[112:115], a[0:15]
    ds_read_b64_tr_b16 v[36:37], v13 offset:5120
    ds_read_b64_tr_b16 v[38:39], v13 offset:7680
    s_waitcnt lgkmcnt(8)
    v_mfma_f32_32x32x16_bf16 a[16:31], v[20:23], a[112:115], a[16:31]
    ds_read_b64_tr_b16 v[40:41], v13 offset:5184
    ds_read_b64_tr_b16 v[42:43], v13 offset:7744
    s_add_u32 m0, s60, 81920
    s_add_u32 s51, s71, 3112960
    buffer_load_dwordx4 v3, s[44:47], s51 offen offset:0 lds
    s_waitcnt lgkmcnt(8)
    v_mfma_f32_32x32x16_bf16 a[32:47], v[24:27], a[112:115], a[32:47]
    ds_read_b64_tr_b16 v[44:45], v13 offset:5248
    ds_read_b64_tr_b16 v[46:47], v13 offset:7808
    s_waitcnt lgkmcnt(8)
    v_mfma_f32_32x32x16_bf16 a[48:63], v[28:31], a[112:115], a[48:63]
    ds_read_b64_tr_b16 v[48:49], v13 offset:5312
    ds_read_b64_tr_b16 v[50:51], v13 offset:7872
    s_waitcnt lgkmcnt(8)
    v_mfma_f32_32x32x16_bf16 a[64:79], v[32:35], a[112:115], a[64:79]
    ds_read_b64_tr_b16 v[52:53], v13 offset:5376
    ds_read_b64_tr_b16 v[54:55], v13 offset:7936
    s_add_u32 s52, s70, 589824
    buffer_load_dwordx4 v[56:59], v8, s[32:35], s52 offen offset:0
    s_waitcnt lgkmcnt(8)
    v_mfma_f32_32x32x16_bf16 a[0:15], v[36:39], a[116:119], a[0:15]
    ds_read_b64_tr_b16 v[16:17], v13 offset:10240
    ds_read_b64_tr_b16 v[18:19], v13 offset:12800
    s_waitcnt lgkmcnt(8)
    v_mfma_f32_32x32x16_bf16 a[16:31], v[40:43], a[116:119], a[16:31]
    ds_read_b64_tr_b16 v[20:21], v13 offset:10304
    ds_read_b64_tr_b16 v[22:23], v13 offset:12864
    s_waitcnt lgkmcnt(8)
    v_mfma_f32_32x32x16_bf16 a[32:47], v[44:47], a[116:119], a[32:47]
    ds_read_b64_tr_b16 v[24:25], v13 offset:10368
    ds_read_b64_tr_b16 v[26:27], v13 offset:12928
    buffer_load_dwordx4 v[60:63], v8, s[32:35], s52 offen offset:1024
    s_waitcnt lgkmcnt(8)
    v_mfma_f32_32x32x16_bf16 a[48:63], v[48:51], a[116:119], a[48:63]
    ds_read_b64_tr_b16 v[28:29], v13 offset:10432
    ds_read_b64_tr_b16 v[30:31], v13 offset:12992
    s_waitcnt lgkmcnt(8)
    v_mfma_f32_32x32x16_bf16 a[64:79], v[52:55], a[116:119], a[64:79]
    ds_read_b64_tr_b16 v[32:33], v13 offset:10496
    ds_read_b64_tr_b16 v[34:35], v13 offset:13056
    s_waitcnt lgkmcnt(8)
    v_mfma_f32_32x32x16_bf16 a[0:15], v[16:19], a[120:123], a[0:15]
    ds_read_b64_tr_b16 v[36:37], v13 offset:15360
    ds_read_b64_tr_b16 v[38:39], v13 offset:17920
    buffer_load_dwordx4 v4, s[44:47], s51 offen offset:1024 lds
    s_waitcnt lgkmcnt(8)
    v_mfma_f32_32x32x16_bf16 a[16:31], v[20:23], a[120:123], a[16:31]
    ds_read_b64_tr_b16 v[40:41], v13 offset:15424
    ds_read_b64_tr_b16 v[42:43], v13 offset:17984
    s_waitcnt lgkmcnt(8)
    v_mfma_f32_32x32x16_bf16 a[32:47], v[24:27], a[120:123], a[32:47]
    ds_read_b64_tr_b16 v[44:45], v13 offset:15488
    ds_read_b64_tr_b16 v[46:47], v13 offset:18048
    s_waitcnt lgkmcnt(8)
    v_mfma_f32_32x32x16_bf16 a[48:63], v[28:31], a[120:123], a[48:63]
    ds_read_b64_tr_b16 v[48:49], v13 offset:15552
    ds_read_b64_tr_b16 v[50:51], v13 offset:18112
    buffer_load_dwordx4 v[64:67], v8, s[32:35], s52 offen offset:2048
    s_waitcnt lgkmcnt(8)
    v_mfma_f32_32x32x16_bf16 a[64:79], v[32:35], a[120:123], a[64:79]
    ds_read_b64_tr_b16 v[52:53], v13 offset:15616
    ds_read_b64_tr_b16 v[54:55], v13 offset:18176
    s_waitcnt lgkmcnt(8)
    v_mfma_f32_32x32x16_bf16 a[0:15], v[36:39], a[124:127], a[0:15]
    ds_read_b64_tr_b16 v[16:17], v13 offset:20480
    ds_read_b64_tr_b16 v[18:19], v13 offset:23040
    s_waitcnt lgkmcnt(8)
    v_mfma_f32_32x32x16_bf16 a[16:31], v[40:43], a[124:127], a[16:31]
    ds_read_b64_tr_b16 v[20:21], v13 offset:20544
    ds_read_b64_tr_b16 v[22:23], v13 offset:23104
    buffer_load_dwordx4 v[68:71], v8, s[32:35], s52 offen offset:3072
    s_waitcnt lgkmcnt(8)
    v_mfma_f32_32x32x16_bf16 a[32:47], v[44:47], a[124:127], a[32:47]
    ds_read_b64_tr_b16 v[24:25], v13 offset:20608
    ds_read_b64_tr_b16 v[26:27], v13 offset:23168
    s_waitcnt lgkmcnt(8)
    v_mfma_f32_32x32x16_bf16 a[48:63], v[48:51], a[124:127], a[48:63]
    ds_read_b64_tr_b16 v[28:29], v13 offset:20672
    ds_read_b64_tr_b16 v[30:31], v13 offset:23232
    s_waitcnt lgkmcnt(8)
    v_mfma_f32_32x32x16_bf16 a[64:79], v[52:55], a[124:127], a[64:79]
    ds_read_b64_tr_b16 v[32:33], v13 offset:20736
    ds_read_b64_tr_b16 v[34:35], v13 offset:23296
    buffer_load_dwordx4 v5, s[44:47], s51 offen offset:2048 lds
    s_waitcnt lgkmcnt(8)
    v_mfma_f32_32x32x16_bf16 a[0:15], v[16:19], a[128:131], a[0:15]
    ds_read_b64_tr_b16 v[36:37], v13 offset:25600
    ds_read_b64_tr_b16 v[38:39], v13 offset:28160
    s_waitcnt lgkmcnt(8)
    v_mfma_f32_32x32x16_bf16 a[16:31], v[20:23], a[128:131], a[16:31]
    ds_read_b64_tr_b16 v[40:41], v13 offset:25664
    ds_read_b64_tr_b16 v[42:43], v13 offset:28224
    s_waitcnt lgkmcnt(8)
    v_mfma_f32_32x32x16_bf16 a[32:47], v[24:27], a[128:131], a[32:47]
    ds_read_b64_tr_b16 v[44:45], v13 offset:25728
    ds_read_b64_tr_b16 v[46:47], v13 offset:28288
    s_add_u32 s52, s70, 593920
    buffer_load_dwordx4 v[72:75], v8, s[32:35], s52 offen offset:0
    s_waitcnt lgkmcnt(8)
    v_mfma_f32_32x32x16_bf16 a[48:63], v[28:31], a[128:131], a[48:63]
    ds_read_b64_tr_b16 v[48:49], v13 offset:25792
    ds_read_b64_tr_b16 v[50:51], v13 offset:28352
    s_waitcnt lgkmcnt(8)
    v_mfma_f32_32x32x16_bf16 a[64:79], v[32:35], a[128:131], a[64:79]
    ds_read_b64_tr_b16 v[52:53], v13 offset:25856
    ds_read_b64_tr_b16 v[54:55], v13 offset:28416
    s_waitcnt lgkmcnt(8)
    v_mfma_f32_32x32x16_bf16 a[0:15], v[36:39], a[132:135], a[0:15]
    ds_read_b64_tr_b16 v[16:17], v13 offset:30720
    ds_read_b64_tr_b16 v[18:19], v13 offset:33280
    buffer_load_dwordx4 v[76:79], v8, s[32:35], s52 offen offset:1024
    s_waitcnt lgkmcnt(8)
    v_mfma_f32_32x32x16_bf16 a[16:31], v[40:43], a[132:135], a[16:31]
    ds_read_b64_tr_b16 v[20:21], v13 offset:30784
    ds_read_b64_tr_b16 v[22:23], v13 offset:33344
    s_waitcnt lgkmcnt(8)
    v_mfma_f32_32x32x16_bf16 a[32:47], v[44:47], a[132:135], a[32:47]
    ds_read_b64_tr_b16 v[24:25], v13 offset:30848
    ds_read_b64_tr_b16 v[26:27], v13 offset:33408
    s_waitcnt lgkmcnt(8)
    v_mfma_f32_32x32x16_bf16 a[48:63], v[48:51], a[132:135], a[48:63]
    ds_read_b64_tr_b16 v[28:29], v13 offset:30912
    ds_read_b64_tr_b16 v[30:31], v13 offset:33472
    buffer_load_dwordx4 v6, s[44:47], s51 offen offset:3072 lds
    s_waitcnt lgkmcnt(8)
    v_mfma_f32_32x32x16_bf16 a[64:79], v[52:55], a[132:135], a[64:79]
    ds_read_b64_tr_b16 v[32:33], v13 offset:30976
    ds_read_b64_tr_b16 v[34:35], v13 offset:33536
    s_waitcnt lgkmcnt(8)
    v_mfma_f32_32x32x16_bf16 a[0:15], v[16:19], a[136:139], a[0:15]
    ds_read_b64_tr_b16 v[36:37], v13 offset:35840
    ds_read_b64_tr_b16 v[38:39], v13 offset:38400
    s_waitcnt lgkmcnt(8)
    v_mfma_f32_32x32x16_bf16 a[16:31], v[20:23], a[136:139], a[16:31]
    ds_read_b64_tr_b16 v[40:41], v13 offset:35904
    ds_read_b64_tr_b16 v[42:43], v13 offset:38464
    buffer_load_dwordx4 v[80:83], v8, s[32:35], s52 offen offset:2048
    s_waitcnt lgkmcnt(8)
    v_mfma_f32_32x32x16_bf16 a[32:47], v[24:27], a[136:139], a[32:47]
    ds_read_b64_tr_b16 v[44:45], v13 offset:35968
    ds_read_b64_tr_b16 v[46:47], v13 offset:38528
    s_waitcnt lgkmcnt(8)
    v_mfma_f32_32x32x16_bf16 a[48:63], v[28:31], a[136:139], a[48:63]
    ds_read_b64_tr_b16 v[48:49], v13 offset:36032
    ds_read_b64_tr_b16 v[50:51], v13 offset:38592
    s_waitcnt lgkmcnt(8)
    v_mfma_f32_32x32x16_bf16 a[64:79], v[32:35], a[136:139], a[64:79]
    ds_read_b64_tr_b16 v[52:53], v13 offset:36096
    ds_read_b64_tr_b16 v[54:55], v13 offset:38656
    buffer_load_dwordx4 v[84:87], v8, s[32:35], s52 offen offset:3072
    s_waitcnt lgkmcnt(8)
    v_mfma_f32_32x32x16_bf16 a[0:15], v[36:39], a[140:143], a[0:15]
    ds_read_b64_tr_b16 v[16:17], v2 offset:0
    ds_read_b64_tr_b16 v[18:19], v2 offset:2560
    s_waitcnt lgkmcnt(8)
    v_mfma_f32_32x32x16_bf16 a[16:31], v[40:43], a[140:143], a[16:31]
    ds_read_b64_tr_b16 v[20:21], v2 offset:64
    ds_read_b64_tr_b16 v[22:23], v2 offset:2624
    s_waitcnt lgkmcnt(8)
    v_mfma_f32_32x32x16_bf16 a[32:47], v[44:47], a[140:143], a[32:47]
    ds_read_b64_tr_b16 v[24:25], v2 offset:128
    ds_read_b64_tr_b16 v[26:27], v2 offset:2688
    s_add_u32 m0, s60, 86016
    s_nop 0
    buffer_load_dwordx4 v7, s[44:47], s51 offen offset:0 lds
    s_waitcnt lgkmcnt(8)
    v_mfma_f32_32x32x16_bf16 a[48:63], v[48:51], a[140:143], a[48:63]
    ds_read_b64_tr_b16 v[28:29], v2 offset:192
    ds_read_b64_tr_b16 v[30:31], v2 offset:2752
    s_waitcnt lgkmcnt(8)
    v_mfma_f32_32x32x16_bf16 a[64:79], v[52:55], a[140:143], a[64:79]
    ds_read_b64_tr_b16 v[32:33], v2 offset:256
    ds_read_b64_tr_b16 v[34:35], v2 offset:2816
    s_waitcnt vmcnt(13)
    s_barrier
    s_waitcnt lgkmcnt(8)
    v_mfma_f32_32x32x16_bf16 a[0:15], v[16:19], a[80:83], a[0:15]
    ds_read_b64_tr_b16 v[36:37], v2 offset:5120
    ds_read_b64_tr_b16 v[38:39], v2 offset:7680
    s_waitcnt lgkmcnt(8)
    v_mfma_f32_32x32x16_bf16 a[16:31], v[20:23], a[80:83], a[16:31]
    ds_read_b64_tr_b16 v[40:41], v2 offset:5184
    ds_read_b64_tr_b16 v[42:43], v2 offset:7744
    s_add_u32 m0, s60, 122880
    s_add_u32 s51, s71, 3276800
    buffer_load_dwordx4 v3, s[44:47], s51 offen offset:0 lds
    s_waitcnt lgkmcnt(8)
    v_mfma_f32_32x32x16_bf16 a[32:47], v[24:27], a[80:83], a[32:47]
    ds_read_b64_tr_b16 v[44:45], v2 offset:5248
    ds_read_b64_tr_b16 v[46:47], v2 offset:7808
    s_waitcnt lgkmcnt(8)
    v_mfma_f32_32x32x16_bf16 a[48:63], v[28:31], a[80:83], a[48:63]
    ds_read_b64_tr_b16 v[48:49], v2 offset:5312
    ds_read_b64_tr_b16 v[50:51], v2 offset:7872
    s_waitcnt lgkmcnt(8)
    v_mfma_f32_32x32x16_bf16 a[64:79], v[32:35], a[80:83], a[64:79]
    ds_read_b64_tr_b16 v[52:53], v2 offset:5376
    ds_read_b64_tr_b16 v[54:55], v2 offset:7936
    s_add_u32 s52, s70, 598016
    buffer_load_dwordx4 a[112:115], v8, s[32:35], s52 offen offset:0
    s_waitcnt lgkmcnt(8)
    v_mfma_f32_32x32x16_bf16 a[0:15], v[36:39], a[84:87], a[0:15]
    ds_read_b64_tr_b16 v[16:17], v2 offset:10240
    ds_read_b64_tr_b16 v[18:19], v2 offset:12800
    s_waitcnt lgkmcnt(8)
    v_mfma_f32_32x32x16_bf16 a[16:31], v[40:43], a[84:87], a[16:31]
    ds_read_b64_tr_b16 v[20:21], v2 offset:10304
    ds_read_b64_tr_b16 v[22:23], v2 offset:12864
    s_waitcnt lgkmcnt(8)
    v_mfma_f32_32x32x16_bf16 a[32:47], v[44:47], a[84:87], a[32:47]
    ds_read_b64_tr_b16 v[24:25], v2 offset:10368
    ds_read_b64_tr_b16 v[26:27], v2 offset:12928
    buffer_load_dwordx4 a[116:119], v8, s[32:35], s52 offen offset:1024
    s_waitcnt lgkmcnt(8)
    v_mfma_f32_32x32x16_bf16 a[48:63], v[48:51], a[84:87], a[48:63]
    ds_read_b64_tr_b16 v[28:29], v2 offset:10432
    ds_read_b64_tr_b16 v[30:31], v2 offset:12992
    s_waitcnt lgkmcnt(8)
    v_mfma_f32_32x32x16_bf16 a[64:79], v[52:55], a[84:87], a[64:79]
    ds_read_b64_tr_b16 v[32:33], v2 offset:10496
    ds_read_b64_tr_b16 v[34:35], v2 offset:13056
    s_waitcnt lgkmcnt(8)
    v_mfma_f32_32x32x16_bf16 a[0:15], v[16:19], a[88:91], a[0:15]
    ds_read_b64_tr_b16 v[36:37], v2 offset:15360
    ds_read_b64_tr_b16 v[38:39], v2 offset:17920
    buffer_load_dwordx4 v4, s[44:47], s51 offen offset:1024 lds
    s_waitcnt lgkmcnt(8)
    v_mfma_f32_32x32x16_bf16 a[16:31], v[20:23], a[88:91], a[16:31]
    ds_read_b64_tr_b16 v[40:41], v2 offset:15424
    ds_read_b64_tr_b16 v[42:43], v2 offset:17984
    s_waitcnt lgkmcnt(8)
    v_mfma_f32_32x32x16_bf16 a[32:47], v[24:27], a[88:91], a[32:47]
    ds_read_b64_tr_b16 v[44:45], v2 offset:15488
    ds_read_b64_tr_b16 v[46:47], v2 offset:18048
    s_waitcnt lgkmcnt(8)
    v_mfma_f32_32x32x16_bf16 a[48:63], v[28:31], a[88:91], a[48:63]
    ds_read_b64_tr_b16 v[48:49], v2 offset:15552
    ds_read_b64_tr_b16 v[50:51], v2 offset:18112
    buffer_load_dwordx4 a[120:123], v8, s[32:35], s52 offen offset:2048
    s_waitcnt lgkmcnt(8)
    v_mfma_f32_32x32x16_bf16 a[64:79], v[32:35], a[88:91], a[64:79]
    ds_read_b64_tr_b16 v[52:53], v2 offset:15616
    ds_read_b64_tr_b16 v[54:55], v2 offset:18176
    s_waitcnt lgkmcnt(8)
    v_mfma_f32_32x32x16_bf16 a[0:15], v[36:39], a[92:95], a[0:15]
    ds_read_b64_tr_b16 v[16:17], v2 offset:20480
    ds_read_b64_tr_b16 v[18:19], v2 offset:23040
    s_waitcnt lgkmcnt(8)
    v_mfma_f32_32x32x16_bf16 a[16:31], v[40:43], a[92:95], a[16:31]
    ds_read_b64_tr_b16 v[20:21], v2 offset:20544
    ds_read_b64_tr_b16 v[22:23], v2 offset:23104
    buffer_load_dwordx4 a[124:127], v8, s[32:35], s52 offen offset:3072
    s_waitcnt lgkmcnt(8)
    v_mfma_f32_32x32x16_bf16 a[32:47], v[44:47], a[92:95], a[32:47]
    ds_read_b64_tr_b16 v[24:25], v2 offset:20608
    ds_read_b64_tr_b16 v[26:27], v2 offset:23168
    s_waitcnt lgkmcnt(8)
    v_mfma_f32_32x32x16_bf16 a[48:63], v[48:51], a[92:95], a[48:63]
    ds_read_b64_tr_b16 v[28:29], v2 offset:20672
    ds_read_b64_tr_b16 v[30:31], v2 offset:23232
    s_waitcnt lgkmcnt(8)
    v_mfma_f32_32x32x16_bf16 a[64:79], v[52:55], a[92:95], a[64:79]
    ds_read_b64_tr_b16 v[32:33], v2 offset:20736
    ds_read_b64_tr_b16 v[34:35], v2 offset:23296
    buffer_load_dwordx4 v5, s[44:47], s51 offen offset:2048 lds
    s_waitcnt lgkmcnt(8)
    v_mfma_f32_32x32x16_bf16 a[0:15], v[16:19], a[96:99], a[0:15]
    ds_read_b64_tr_b16 v[36:37], v2 offset:25600
    ds_read_b64_tr_b16 v[38:39], v2 offset:28160
    s_waitcnt lgkmcnt(8)
    v_mfma_f32_32x32x16_bf16 a[16:31], v[20:23], a[96:99], a[16:31]
    ds_read_b64_tr_b16 v[40:41], v2 offset:25664
    ds_read_b64_tr_b16 v[42:43], v2 offset:28224
    s_waitcnt lgkmcnt(8)
    v_mfma_f32_32x32x16_bf16 a[32:47], v[24:27], a[96:99], a[32:47]
    ds_read_b64_tr_b16 v[44:45], v2 offset:25728
    ds_read_b64_tr_b16 v[46:47], v2 offset:28288
    s_add_u32 s52, s70, 638976
    buffer_load_dwordx4 a[128:131], v8, s[32:35], s52 offen offset:0
    s_waitcnt lgkmcnt(8)
    v_mfma_f32_32x32x16_bf16 a[48:63], v[28:31], a[96:99], a[48:63]
    ds_read_b64_tr_b16 v[48:49], v2 offset:25792
    ds_read_b64_tr_b16 v[50:51], v2 offset:28352
    s_waitcnt lgkmcnt(8)
    v_mfma_f32_32x32x16_bf16 a[64:79], v[32:35], a[96:99], a[64:79]
    ds_read_b64_tr_b16 v[52:53], v2 offset:25856
    ds_read_b64_tr_b16 v[54:55], v2 offset:28416
    s_waitcnt lgkmcnt(8)
    v_mfma_f32_32x32x16_bf16 a[0:15], v[36:39], a[100:103], a[0:15]
    ds_read_b64_tr_b16 v[16:17], v2 offset:30720
    ds_read_b64_tr_b16 v[18:19], v2 offset:33280
    buffer_load_dwordx4 a[132:135], v8, s[32:35], s52 offen offset:1024
    s_waitcnt lgkmcnt(8)
    v_mfma_f32_32x32x16_bf16 a[16:31], v[40:43], a[100:103], a[16:31]
    ds_read_b64_tr_b16 v[20:21], v2 offset:30784
    ds_read_b64_tr_b16 v[22:23], v2 offset:33344
    s_waitcnt lgkmcnt(8)
    v_mfma_f32_32x32x16_bf16 a[32:47], v[44:47], a[100:103], a[32:47]
    ds_read_b64_tr_b16 v[24:25], v2 offset:30848
    ds_read_b64_tr_b16 v[26:27], v2 offset:33408
    s_waitcnt lgkmcnt(8)
    v_mfma_f32_32x32x16_bf16 a[48:63], v[48:51], a[100:103], a[48:63]
    ds_read_b64_tr_b16 v[28:29], v2 offset:30912
    ds_read_b64_tr_b16 v[30:31], v2 offset:33472
    buffer_load_dwordx4 v6, s[44:47], s51 offen offset:3072 lds
    s_waitcnt lgkmcnt(8)
    v_mfma_f32_32x32x16_bf16 a[64:79], v[52:55], a[100:103], a[64:79]
    ds_read_b64_tr_b16 v[32:33], v2 offset:30976
    ds_read_b64_tr_b16 v[34:35], v2 offset:33536
    s_waitcnt lgkmcnt(8)
    v_mfma_f32_32x32x16_bf16 a[0:15], v[16:19], a[104:107], a[0:15]
    ds_read_b64_tr_b16 v[36:37], v2 offset:35840
    ds_read_b64_tr_b16 v[38:39], v2 offset:38400
    s_waitcnt lgkmcnt(8)
    v_mfma_f32_32x32x16_bf16 a[16:31], v[20:23], a[104:107], a[16:31]
    ds_read_b64_tr_b16 v[40:41], v2 offset:35904
    ds_read_b64_tr_b16 v[42:43], v2 offset:38464
    buffer_load_dwordx4 a[136:139], v8, s[32:35], s52 offen offset:2048
    s_waitcnt lgkmcnt(8)
    v_mfma_f32_32x32x16_bf16 a[32:47], v[24:27], a[104:107], a[32:47]
    ds_read_b64_tr_b16 v[44:45], v2 offset:35968
    ds_read_b64_tr_b16 v[46:47], v2 offset:38528
    s_waitcnt lgkmcnt(8)
    v_mfma_f32_32x32x16_bf16 a[48:63], v[28:31], a[104:107], a[48:63]
    ds_read_b64_tr_b16 v[48:49], v2 offset:36032
    ds_read_b64_tr_b16 v[50:51], v2 offset:38592
    s_waitcnt lgkmcnt(8)
    v_mfma_f32_32x32x16_bf16 a[64:79], v[32:35], a[104:107], a[64:79]
    ds_read_b64_tr_b16 v[52:53], v2 offset:36096
    ds_read_b64_tr_b16 v[54:55], v2 offset:38656
    buffer_load_dwordx4 a[140:143], v8, s[32:35], s52 offen offset:3072
    s_waitcnt lgkmcnt(8)
    v_mfma_f32_32x32x16_bf16 a[0:15], v[36:39], a[108:111], a[0:15]
    ds_read_b64_tr_b16 v[16:17], v11 offset:0
    ds_read_b64_tr_b16 v[18:19], v11 offset:2560
    s_waitcnt lgkmcnt(8)
    v_mfma_f32_32x32x16_bf16 a[16:31], v[40:43], a[108:111], a[16:31]
    ds_read_b64_tr_b16 v[20:21], v11 offset:64
    ds_read_b64_tr_b16 v[22:23], v11 offset:2624
    s_waitcnt lgkmcnt(8)
    v_mfma_f32_32x32x16_bf16 a[32:47], v[44:47], a[108:111], a[32:47]
    ds_read_b64_tr_b16 v[24:25], v11 offset:128
    ds_read_b64_tr_b16 v[26:27], v11 offset:2688
    s_add_u32 m0, s60, 126976
    s_nop 0
    buffer_load_dwordx4 v7, s[44:47], s51 offen offset:0 lds
    s_waitcnt lgkmcnt(8)
    v_mfma_f32_32x32x16_bf16 a[48:63], v[48:51], a[108:111], a[48:63]
    ds_read_b64_tr_b16 v[28:29], v11 offset:192
    ds_read_b64_tr_b16 v[30:31], v11 offset:2752
    s_waitcnt lgkmcnt(8)
    v_mfma_f32_32x32x16_bf16 a[64:79], v[52:55], a[108:111], a[64:79]
    ds_read_b64_tr_b16 v[32:33], v11 offset:256
    ds_read_b64_tr_b16 v[34:35], v11 offset:2816
    s_waitcnt vmcnt(13)
    s_barrier
    s_waitcnt lgkmcnt(8)
    v_mfma_f32_32x32x16_bf16 a[0:15], v[16:19], v[56:59], a[0:15]
    ds_read_b64_tr_b16 v[36:37], v11 offset:5120
    ds_read_b64_tr_b16 v[38:39], v11 offset:7680
    s_waitcnt lgkmcnt(8)
    v_mfma_f32_32x32x16_bf16 a[16:31], v[20:23], v[56:59], a[16:31]
    ds_read_b64_tr_b16 v[40:41], v11 offset:5184
    ds_read_b64_tr_b16 v[42:43], v11 offset:7744
    s_add_u32 s52, s70, 643072
    buffer_load_dwordx4 a[80:83], v8, s[32:35], s52 offen offset:0
    s_waitcnt lgkmcnt(8)
    v_mfma_f32_32x32x16_bf16 a[32:47], v[24:27], v[56:59], a[32:47]
    ds_read_b64_tr_b16 v[44:45], v11 offset:5248
    ds_read_b64_tr_b16 v[46:47], v11 offset:7808
    s_waitcnt lgkmcnt(8)
    v_mfma_f32_32x32x16_bf16 a[48:63], v[28:31], v[56:59], a[48:63]
    ds_read_b64_tr_b16 v[48:49], v11 offset:5312
    ds_read_b64_tr_b16 v[50:51], v11 offset:7872
    s_waitcnt lgkmcnt(8)
    v_mfma_f32_32x32x16_bf16 a[64:79], v[32:35], v[56:59], a[64:79]
    ds_read_b64_tr_b16 v[52:53], v11 offset:5376
    ds_read_b64_tr_b16 v[54:55], v11 offset:7936
    buffer_load_dwordx4 a[84:87], v8, s[32:35], s52 offen offset:1024
    s_waitcnt lgkmcnt(8)
    v_mfma_f32_32x32x16_bf16 a[0:15], v[36:39], v[60:63], a[0:15]
    ds_read_b64_tr_b16 v[16:17], v11 offset:10240
    ds_read_b64_tr_b16 v[18:19], v11 offset:12800
    s_waitcnt lgkmcnt(8)
    v_mfma_f32_32x32x16_bf16 a[16:31], v[40:43], v[60:63], a[16:31]
    ds_read_b64_tr_b16 v[20:21], v11 offset:10304
    ds_read_b64_tr_b16 v[22:23], v11 offset:12864
    s_waitcnt lgkmcnt(8)
    v_mfma_f32_32x32x16_bf16 a[32:47], v[44:47], v[60:63], a[32:47]
    ds_read_b64_tr_b16 v[24:25], v11 offset:10368
    ds_read_b64_tr_b16 v[26:27], v11 offset:12928
    buffer_load_dwordx4 a[88:91], v8, s[32:35], s52 offen offset:2048
    s_waitcnt lgkmcnt(8)
    v_mfma_f32_32x32x16_bf16 a[48:63], v[48:51], v[60:63], a[48:63]
    ds_read_b64_tr_b16 v[28:29], v11 offset:10432
    ds_read_b64_tr_b16 v[30:31], v11 offset:12992
    s_waitcnt lgkmcnt(8)
    v_mfma_f32_32x32x16_bf16 a[64:79], v[52:55], v[60:63], a[64:79]
    ds_read_b64_tr_b16 v[32:33], v11 offset:10496
    ds_read_b64_tr_b16 v[34:35], v11 offset:13056
    s_waitcnt lgkmcnt(8)
    v_mfma_f32_32x32x16_bf16 a[0:15], v[16:19], v[64:67], a[0:15]
    ds_read_b64_tr_b16 v[36:37], v11 offset:15360
    ds_read_b64_tr_b16 v[38:39], v11 offset:17920
    buffer_load_dwordx4 a[92:95], v8, s[32:35], s52 offen offset:3072
    s_waitcnt lgkmcnt(8)
    v_mfma_f32_32x32x16_bf16 a[16:31], v[20:23], v[64:67], a[16:31]
    ds_read_b64_tr_b16 v[40:41], v11 offset:15424
    ds_read_b64_tr_b16 v[42:43], v11 offset:17984
    s_waitcnt lgkmcnt(8)
    v_mfma_f32_32x32x16_bf16 a[32:47], v[24:27], v[64:67], a[32:47]
    ds_read_b64_tr_b16 v[44:45], v11 offset:15488
    ds_read_b64_tr_b16 v[46:47], v11 offset:18048
    s_waitcnt lgkmcnt(8)
    v_mfma_f32_32x32x16_bf16 a[48:63], v[28:31], v[64:67], a[48:63]
    ds_read_b64_tr_b16 v[48:49], v11 offset:15552
    ds_read_b64_tr_b16 v[50:51], v11 offset:18112
    s_add_u32 s52, s70, 647168
    buffer_load_dwordx4 a[96:99], v8, s[32:35], s52 offen offset:0
    s_waitcnt lgkmcnt(8)
    v_mfma_f32_32x32x16_bf16 a[64:79], v[32:35], v[64:67], a[64:79]
    ds_read_b64_tr_b16 v[52:53], v11 offset:15616
    ds_read_b64_tr_b16 v[54:55], v11 offset:18176
    s_waitcnt lgkmcnt(8)
    v_mfma_f32_32x32x16_bf16 a[0:15], v[36:39], v[68:71], a[0:15]
    ds_read_b64_tr_b16 v[16:17], v11 offset:20480
    ds_read_b64_tr_b16 v[18:19], v11 offset:23040
    s_waitcnt lgkmcnt(8)
    v_mfma_f32_32x32x16_bf16 a[16:31], v[40:43], v[68:71], a[16:31]
    ds_read_b64_tr_b16 v[20:21], v11 offset:20544
    ds_read_b64_tr_b16 v[22:23], v11 offset:23104
    buffer_load_dwordx4 a[100:103], v8, s[32:35], s52 offen offset:1024
    s_waitcnt lgkmcnt(8)
    v_mfma_f32_32x32x16_bf16 a[32:47], v[44:47], v[68:71], a[32:47]
    ds_read_b64_tr_b16 v[24:25], v11 offset:20608
    ds_read_b64_tr_b16 v[26:27], v11 offset:23168
    s_waitcnt lgkmcnt(8)
    v_mfma_f32_32x32x16_bf16 a[48:63], v[48:51], v[68:71], a[48:63]
    ds_read_b64_tr_b16 v[28:29], v11 offset:20672
    ds_read_b64_tr_b16 v[30:31], v11 offset:23232
    s_waitcnt lgkmcnt(8)
    v_mfma_f32_32x32x16_bf16 a[64:79], v[52:55], v[68:71], a[64:79]
    ds_read_b64_tr_b16 v[32:33], v11 offset:20736
    ds_read_b64_tr_b16 v[34:35], v11 offset:23296
    buffer_load_dwordx4 a[104:107], v8, s[32:35], s52 offen offset:2048
    s_waitcnt lgkmcnt(8)
    v_mfma_f32_32x32x16_bf16 a[0:15], v[16:19], v[72:75], a[0:15]
    ds_read_b64_tr_b16 v[36:37], v11 offset:25600
    ds_read_b64_tr_b16 v[38:39], v11 offset:28160
    s_waitcnt lgkmcnt(8)
    v_mfma_f32_32x32x16_bf16 a[16:31], v[20:23], v[72:75], a[16:31]
    ds_read_b64_tr_b16 v[40:41], v11 offset:25664
    ds_read_b64_tr_b16 v[42:43], v11 offset:28224
    s_waitcnt lgkmcnt(8)
    v_mfma_f32_32x32x16_bf16 a[32:47], v[24:27], v[72:75], a[32:47]
    ds_read_b64_tr_b16 v[44:45], v11 offset:25728
    ds_read_b64_tr_b16 v[46:47], v11 offset:28288
    buffer_load_dwordx4 a[108:111], v8, s[32:35], s52 offen offset:3072
    s_waitcnt lgkmcnt(8)
    v_mfma_f32_32x32x16_bf16 a[48:63], v[28:31], v[72:75], a[48:63]
    ds_read_b64_tr_b16 v[48:49], v11 offset:25792
    ds_read_b64_tr_b16 v[50:51], v11 offset:28352
    s_waitcnt lgkmcnt(8)
    v_mfma_f32_32x32x16_bf16 a[64:79], v[32:35], v[72:75], a[64:79]
    ds_read_b64_tr_b16 v[52:53], v11 offset:25856
    ds_read_b64_tr_b16 v[54:55], v11 offset:28416
    s_waitcnt lgkmcnt(8)
    v_mfma_f32_32x32x16_bf16 a[0:15], v[36:39], v[76:79], a[0:15]
    ds_read_b64_tr_b16 v[16:17], v11 offset:30720
    ds_read_b64_tr_b16 v[18:19], v11 offset:33280
    s_waitcnt lgkmcnt(8)
    v_mfma_f32_32x32x16_bf16 a[16:31], v[40:43], v[76:79], a[16:31]
    ds_read_b64_tr_b16 v[20:21], v11 offset:30784
    ds_read_b64_tr_b16 v[22:23], v11 offset:33344
    s_waitcnt lgkmcnt(8)
    v_mfma_f32_32x32x16_bf16 a[32:47], v[44:47], v[76:79], a[32:47]
    ds_read_b64_tr_b16 v[24:25], v11 offset:30848
    ds_read_b64_tr_b16 v[26:27], v11 offset:33408
    s_waitcnt lgkmcnt(8)
    v_mfma_f32_32x32x16_bf16 a[48:63], v[48:51], v[76:79], a[48:63]
    ds_read_b64_tr_b16 v[28:29], v11 offset:30912
    ds_read_b64_tr_b16 v[30:31], v11 offset:33472
    s_waitcnt lgkmcnt(8)
    v_mfma_f32_32x32x16_bf16 a[64:79], v[52:55], v[76:79], a[64:79]
    ds_read_b64_tr_b16 v[32:33], v11 offset:30976
    ds_read_b64_tr_b16 v[34:35], v11 offset:33536
    s_waitcnt lgkmcnt(8)
    v_mfma_f32_32x32x16_bf16 a[0:15], v[16:19], v[80:83], a[0:15]
    ds_read_b64_tr_b16 v[36:37], v11 offset:35840
    ds_read_b64_tr_b16 v[38:39], v11 offset:38400
    s_waitcnt lgkmcnt(8)
    v_mfma_f32_32x32x16_bf16 a[16:31], v[20:23], v[80:83], a[16:31]
    ds_read_b64_tr_b16 v[40:41], v11 offset:35904
    ds_read_b64_tr_b16 v[42:43], v11 offset:38464
    s_waitcnt lgkmcnt(8)
    v_mfma_f32_32x32x16_bf16 a[32:47], v[24:27], v[80:83], a[32:47]
    ds_read_b64_tr_b16 v[44:45], v11 offset:35968
    ds_read_b64_tr_b16 v[46:47], v11 offset:38528
    s_waitcnt lgkmcnt(8)
    v_mfma_f32_32x32x16_bf16 a[48:63], v[28:31], v[80:83], a[48:63]
    ds_read_b64_tr_b16 v[48:49], v11 offset:36032
    ds_read_b64_tr_b16 v[50:51], v11 offset:38592
    s_waitcnt lgkmcnt(8)
    v_mfma_f32_32x32x16_bf16 a[64:79], v[32:35], v[80:83], a[64:79]
    ds_read_b64_tr_b16 v[52:53], v11 offset:36096
    ds_read_b64_tr_b16 v[54:55], v11 offset:38656
    s_waitcnt lgkmcnt(8)
    v_mfma_f32_32x32x16_bf16 a[0:15], v[36:39], v[84:87], a[0:15]
    ds_read_b64_tr_b16 v[16:17], v12 offset:0
    ds_read_b64_tr_b16 v[18:19], v12 offset:2560
    s_waitcnt lgkmcnt(8)
    v_mfma_f32_32x32x16_bf16 a[16:31], v[40:43], v[84:87], a[16:31]
    ds_read_b64_tr_b16 v[20:21], v12 offset:64
    ds_read_b64_tr_b16 v[22:23], v12 offset:2624
    s_waitcnt lgkmcnt(8)
    v_mfma_f32_32x32x16_bf16 a[32:47], v[44:47], v[84:87], a[32:47]
    ds_read_b64_tr_b16 v[24:25], v12 offset:128
    ds_read_b64_tr_b16 v[26:27], v12 offset:2688
    s_waitcnt lgkmcnt(8)
    v_mfma_f32_32x32x16_bf16 a[48:63], v[48:51], v[84:87], a[48:63]
    ds_read_b64_tr_b16 v[28:29], v12 offset:192
    ds_read_b64_tr_b16 v[30:31], v12 offset:2752
    s_waitcnt lgkmcnt(8)
    v_mfma_f32_32x32x16_bf16 a[64:79], v[52:55], v[84:87], a[64:79]
    ds_read_b64_tr_b16 v[32:33], v12 offset:256
    ds_read_b64_tr_b16 v[34:35], v12 offset:2816
    s_waitcnt vmcnt(8)
    s_barrier
    s_waitcnt lgkmcnt(8)
    v_mfma_f32_32x32x16_bf16 a[0:15], v[16:19], a[112:115], a[0:15]
    ds_read_b64_tr_b16 v[36:37], v12 offset:5120
    ds_read_b64_tr_b16 v[38:39], v12 offset:7680
    s_waitcnt lgkmcnt(8)
    v_mfma_f32_32x32x16_bf16 a[16:31], v[20:23], a[112:115], a[16:31]
    ds_read_b64_tr_b16 v[40:41], v12 offset:5184
    ds_read_b64_tr_b16 v[42:43], v12 offset:7744
    s_waitcnt lgkmcnt(8)
    v_mfma_f32_32x32x16_bf16 a[32:47], v[24:27], a[112:115], a[32:47]
    ds_read_b64_tr_b16 v[44:45], v12 offset:5248
    ds_read_b64_tr_b16 v[46:47], v12 offset:7808
    s_waitcnt lgkmcnt(8)
    v_mfma_f32_32x32x16_bf16 a[48:63], v[28:31], a[112:115], a[48:63]
    ds_read_b64_tr_b16 v[48:49], v12 offset:5312
    ds_read_b64_tr_b16 v[50:51], v12 offset:7872
    s_waitcnt lgkmcnt(8)
    v_mfma_f32_32x32x16_bf16 a[64:79], v[32:35], a[112:115], a[64:79]
    ds_read_b64_tr_b16 v[52:53], v12 offset:5376
    ds_read_b64_tr_b16 v[54:55], v12 offset:7936
    s_waitcnt lgkmcnt(8)
    v_mfma_f32_32x32x16_bf16 a[0:15], v[36:39], a[116:119], a[0:15]
    ds_read_b64_tr_b16 v[16:17], v12 offset:10240
    ds_read_b64_tr_b16 v[18:19], v12 offset:12800
    s_waitcnt lgkmcnt(8)
    v_mfma_f32_32x32x16_bf16 a[16:31], v[40:43], a[116:119], a[16:31]
    ds_read_b64_tr_b16 v[20:21], v12 offset:10304
    ds_read_b64_tr_b16 v[22:23], v12 offset:12864
    s_waitcnt lgkmcnt(8)
    v_mfma_f32_32x32x16_bf16 a[32:47], v[44:47], a[116:119], a[32:47]
    ds_read_b64_tr_b16 v[24:25], v12 offset:10368
    ds_read_b64_tr_b16 v[26:27], v12 offset:12928
    s_waitcnt lgkmcnt(8)
    v_mfma_f32_32x32x16_bf16 a[48:63], v[48:51], a[116:119], a[48:63]
    ds_read_b64_tr_b16 v[28:29], v12 offset:10432
    ds_read_b64_tr_b16 v[30:31], v12 offset:12992
    s_waitcnt lgkmcnt(8)
    v_mfma_f32_32x32x16_bf16 a[64:79], v[52:55], a[116:119], a[64:79]
    ds_read_b64_tr_b16 v[32:33], v12 offset:10496
    ds_read_b64_tr_b16 v[34:35], v12 offset:13056
    s_waitcnt lgkmcnt(8)
    v_mfma_f32_32x32x16_bf16 a[0:15], v[16:19], a[120:123], a[0:15]
    ds_read_b64_tr_b16 v[36:37], v12 offset:15360
    ds_read_b64_tr_b16 v[38:39], v12 offset:17920
    s_waitcnt lgkmcnt(8)
    v_mfma_f32_32x32x16_bf16 a[16:31], v[20:23], a[120:123], a[16:31]
    ds_read_b64_tr_b16 v[40:41], v12 offset:15424
    ds_read_b64_tr_b16 v[42:43], v12 offset:17984
    s_waitcnt lgkmcnt(8)
    v_mfma_f32_32x32x16_bf16 a[32:47], v[24:27], a[120:123], a[32:47]
    ds_read_b64_tr_b16 v[44:45], v12 offset:15488
    ds_read_b64_tr_b16 v[46:47], v12 offset:18048
    s_waitcnt lgkmcnt(8)
    v_mfma_f32_32x32x16_bf16 a[48:63], v[28:31], a[120:123], a[48:63]
    ds_read_b64_tr_b16 v[48:49], v12 offset:15552
    ds_read_b64_tr_b16 v[50:51], v12 offset:18112
    s_waitcnt lgkmcnt(8)
    v_mfma_f32_32x32x16_bf16 a[64:79], v[32:35], a[120:123], a[64:79]
    ds_read_b64_tr_b16 v[52:53], v12 offset:15616
    ds_read_b64_tr_b16 v[54:55], v12 offset:18176
    s_waitcnt lgkmcnt(8)
    v_mfma_f32_32x32x16_bf16 a[0:15], v[36:39], a[124:127], a[0:15]
    ds_read_b64_tr_b16 v[16:17], v12 offset:20480
    ds_read_b64_tr_b16 v[18:19], v12 offset:23040
    s_waitcnt lgkmcnt(8)
    v_mfma_f32_32x32x16_bf16 a[16:31], v[40:43], a[124:127], a[16:31]
    ds_read_b64_tr_b16 v[20:21], v12 offset:20544
    ds_read_b64_tr_b16 v[22:23], v12 offset:23104
    s_waitcnt lgkmcnt(8)
    v_mfma_f32_32x32x16_bf16 a[32:47], v[44:47], a[124:127], a[32:47]
    ds_read_b64_tr_b16 v[24:25], v12 offset:20608
    ds_read_b64_tr_b16 v[26:27], v12 offset:23168
    s_waitcnt lgkmcnt(8)
    v_mfma_f32_32x32x16_bf16 a[48:63], v[48:51], a[124:127], a[48:63]
    ds_read_b64_tr_b16 v[28:29], v12 offset:20672
    ds_read_b64_tr_b16 v[30:31], v12 offset:23232
    s_waitcnt lgkmcnt(8)
    v_mfma_f32_32x32x16_bf16 a[64:79], v[52:55], a[124:127], a[64:79]
    ds_read_b64_tr_b16 v[32:33], v12 offset:20736
    ds_read_b64_tr_b16 v[34:35], v12 offset:23296
    s_waitcnt lgkmcnt(8)
    v_mfma_f32_32x32x16_bf16 a[0:15], v[16:19], a[128:131], a[0:15]
    ds_read_b64_tr_b16 v[36:37], v12 offset:25600
    ds_read_b64_tr_b16 v[38:39], v12 offset:28160
    s_waitcnt lgkmcnt(8)
    v_mfma_f32_32x32x16_bf16 a[16:31], v[20:23], a[128:131], a[16:31]
    ds_read_b64_tr_b16 v[40:41], v12 offset:25664
    ds_read_b64_tr_b16 v[42:43], v12 offset:28224
    s_waitcnt lgkmcnt(8)
    v_mfma_f32_32x32x16_bf16 a[32:47], v[24:27], a[128:131], a[32:47]
    ds_read_b64_tr_b16 v[44:45], v12 offset:25728
    ds_read_b64_tr_b16 v[46:47], v12 offset:28288
    s_waitcnt lgkmcnt(8)
    v_mfma_f32_32x32x16_bf16 a[48:63], v[28:31], a[128:131], a[48:63]
    ds_read_b64_tr_b16 v[48:49], v12 offset:25792
    ds_read_b64_tr_b16 v[50:51], v12 offset:28352
    s_waitcnt lgkmcnt(8)
    v_mfma_f32_32x32x16_bf16 a[64:79], v[32:35], a[128:131], a[64:79]
    ds_read_b64_tr_b16 v[52:53], v12 offset:25856
    ds_read_b64_tr_b16 v[54:55], v12 offset:28416
    s_waitcnt lgkmcnt(8)
    v_mfma_f32_32x32x16_bf16 a[0:15], v[36:39], a[132:135], a[0:15]
    ds_read_b64_tr_b16 v[16:17], v12 offset:30720
    ds_read_b64_tr_b16 v[18:19], v12 offset:33280
    s_waitcnt lgkmcnt(8)
    v_mfma_f32_32x32x16_bf16 a[16:31], v[40:43], a[132:135], a[16:31]
    ds_read_b64_tr_b16 v[20:21], v12 offset:30784
    ds_read_b64_tr_b16 v[22:23], v12 offset:33344
    s_waitcnt lgkmcnt(8)
    v_mfma_f32_32x32x16_bf16 a[32:47], v[44:47], a[132:135], a[32:47]
    ds_read_b64_tr_b16 v[24:25], v12 offset:30848
    ds_read_b64_tr_b16 v[26:27], v12 offset:33408
    s_waitcnt lgkmcnt(8)
    v_mfma_f32_32x32x16_bf16 a[48:63], v[48:51], a[132:135], a[48:63]
    ds_read_b64_tr_b16 v[28:29], v12 offset:30912
    ds_read_b64_tr_b16 v[30:31], v12 offset:33472
    s_waitcnt lgkmcnt(8)
    v_mfma_f32_32x32x16_bf16 a[64:79], v[52:55], a[132:135], a[64:79]
    ds_read_b64_tr_b16 v[32:33], v12 offset:30976
    ds_read_b64_tr_b16 v[34:35], v12 offset:33536
    s_waitcnt lgkmcnt(8)
    v_mfma_f32_32x32x16_bf16 a[0:15], v[16:19], a[136:139], a[0:15]
    ds_read_b64_tr_b16 v[36:37], v12 offset:35840
    ds_read_b64_tr_b16 v[38:39], v12 offset:38400
    s_waitcnt lgkmcnt(8)
    v_mfma_f32_32x32x16_bf16 a[16:31], v[20:23], a[136:139], a[16:31]
    ds_read_b64_tr_b16 v[40:41], v12 offset:35904
    ds_read_b64_tr_b16 v[42:43], v12 offset:38464
    s_waitcnt lgkmcnt(8)
    v_mfma_f32_32x32x16_bf16 a[32:47], v[24:27], a[136:139], a[32:47]
    ds_read_b64_tr_b16 v[44:45], v12 offset:35968
    ds_read_b64_tr_b16 v[46:47], v12 offset:38528
    s_waitcnt lgkmcnt(8)
    v_mfma_f32_32x32x16_bf16 a[48:63], v[28:31], a[136:139], a[48:63]
    ds_read_b64_tr_b16 v[48:49], v12 offset:36032
    ds_read_b64_tr_b16 v[50:51], v12 offset:38592
    s_waitcnt lgkmcnt(8)
    v_mfma_f32_32x32x16_bf16 a[64:79], v[32:35], a[136:139], a[64:79]
    ds_read_b64_tr_b16 v[52:53], v12 offset:36096
    ds_read_b64_tr_b16 v[54:55], v12 offset:38656
    s_waitcnt lgkmcnt(8)
    v_mfma_f32_32x32x16_bf16 a[0:15], v[36:39], a[140:143], a[0:15]
    ds_read_b64_tr_b16 v[16:17], v13 offset:0
    ds_read_b64_tr_b16 v[18:19], v13 offset:2560
    s_waitcnt lgkmcnt(8)
    v_mfma_f32_32x32x16_bf16 a[16:31], v[40:43], a[140:143], a[16:31]
    ds_read_b64_tr_b16 v[20:21], v13 offset:64
    ds_read_b64_tr_b16 v[22:23], v13 offset:2624
    s_waitcnt lgkmcnt(8)
    v_mfma_f32_32x32x16_bf16 a[32:47], v[44:47], a[140:143], a[32:47]
    ds_read_b64_tr_b16 v[24:25], v13 offset:128
    ds_read_b64_tr_b16 v[26:27], v13 offset:2688
    s_waitcnt lgkmcnt(8)
    v_mfma_f32_32x32x16_bf16 a[48:63], v[48:51], a[140:143], a[48:63]
    ds_read_b64_tr_b16 v[28:29], v13 offset:192
    ds_read_b64_tr_b16 v[30:31], v13 offset:2752
    s_waitcnt lgkmcnt(8)
    v_mfma_f32_32x32x16_bf16 a[64:79], v[52:55], a[140:143], a[64:79]
    ds_read_b64_tr_b16 v[32:33], v13 offset:256
    ds_read_b64_tr_b16 v[34:35], v13 offset:2816
    s_waitcnt vmcnt(0)
    s_barrier
    s_waitcnt lgkmcnt(8)
    v_mfma_f32_32x32x16_bf16 a[0:15], v[16:19], a[80:83], a[0:15]
    ds_read_b64_tr_b16 v[36:37], v13 offset:5120
    ds_read_b64_tr_b16 v[38:39], v13 offset:7680
    s_waitcnt lgkmcnt(8)
    v_mfma_f32_32x32x16_bf16 a[16:31], v[20:23], a[80:83], a[16:31]
    ds_read_b64_tr_b16 v[40:41], v13 offset:5184
    ds_read_b64_tr_b16 v[42:43], v13 offset:7744
    s_waitcnt lgkmcnt(8)
    v_mfma_f32_32x32x16_bf16 a[32:47], v[24:27], a[80:83], a[32:47]
    ds_read_b64_tr_b16 v[44:45], v13 offset:5248
    ds_read_b64_tr_b16 v[46:47], v13 offset:7808
    s_waitcnt lgkmcnt(8)
    v_mfma_f32_32x32x16_bf16 a[48:63], v[28:31], a[80:83], a[48:63]
    ds_read_b64_tr_b16 v[48:49], v13 offset:5312
    ds_read_b64_tr_b16 v[50:51], v13 offset:7872
    s_waitcnt lgkmcnt(8)
    v_mfma_f32_32x32x16_bf16 a[64:79], v[32:35], a[80:83], a[64:79]
    ds_read_b64_tr_b16 v[52:53], v13 offset:5376
    ds_read_b64_tr_b16 v[54:55], v13 offset:7936
    s_waitcnt lgkmcnt(8)
    v_mfma_f32_32x32x16_bf16 a[0:15], v[36:39], a[84:87], a[0:15]
    ds_read_b64_tr_b16 v[16:17], v13 offset:10240
    ds_read_b64_tr_b16 v[18:19], v13 offset:12800
    s_waitcnt lgkmcnt(8)
    v_mfma_f32_32x32x16_bf16 a[16:31], v[40:43], a[84:87], a[16:31]
    ds_read_b64_tr_b16 v[20:21], v13 offset:10304
    ds_read_b64_tr_b16 v[22:23], v13 offset:12864
    s_waitcnt lgkmcnt(8)
    v_mfma_f32_32x32x16_bf16 a[32:47], v[44:47], a[84:87], a[32:47]
    ds_read_b64_tr_b16 v[24:25], v13 offset:10368
    ds_read_b64_tr_b16 v[26:27], v13 offset:12928
    s_waitcnt lgkmcnt(8)
    v_mfma_f32_32x32x16_bf16 a[48:63], v[48:51], a[84:87], a[48:63]
    ds_read_b64_tr_b16 v[28:29], v13 offset:10432
    ds_read_b64_tr_b16 v[30:31], v13 offset:12992
    s_waitcnt lgkmcnt(8)
    v_mfma_f32_32x32x16_bf16 a[64:79], v[52:55], a[84:87], a[64:79]
    ds_read_b64_tr_b16 v[32:33], v13 offset:10496
    ds_read_b64_tr_b16 v[34:35], v13 offset:13056
    s_waitcnt lgkmcnt(8)
    v_mfma_f32_32x32x16_bf16 a[0:15], v[16:19], a[88:91], a[0:15]
    ds_read_b64_tr_b16 v[36:37], v13 offset:15360
    ds_read_b64_tr_b16 v[38:39], v13 offset:17920
    s_waitcnt lgkmcnt(8)
    v_mfma_f32_32x32x16_bf16 a[16:31], v[20:23], a[88:91], a[16:31]
    ds_read_b64_tr_b16 v[40:41], v13 offset:15424
    ds_read_b64_tr_b16 v[42:43], v13 offset:17984
    s_waitcnt lgkmcnt(8)
    v_mfma_f32_32x32x16_bf16 a[32:47], v[24:27], a[88:91], a[32:47]
    ds_read_b64_tr_b16 v[44:45], v13 offset:15488
    ds_read_b64_tr_b16 v[46:47], v13 offset:18048
    s_waitcnt lgkmcnt(8)
    v_mfma_f32_32x32x16_bf16 a[48:63], v[28:31], a[88:91], a[48:63]
    ds_read_b64_tr_b16 v[48:49], v13 offset:15552
    ds_read_b64_tr_b16 v[50:51], v13 offset:18112
    s_waitcnt lgkmcnt(8)
    v_mfma_f32_32x32x16_bf16 a[64:79], v[32:35], a[88:91], a[64:79]
    ds_read_b64_tr_b16 v[52:53], v13 offset:15616
    ds_read_b64_tr_b16 v[54:55], v13 offset:18176
    s_waitcnt lgkmcnt(8)
    v_mfma_f32_32x32x16_bf16 a[0:15], v[36:39], a[92:95], a[0:15]
    ds_read_b64_tr_b16 v[16:17], v13 offset:20480
    ds_read_b64_tr_b16 v[18:19], v13 offset:23040
    s_waitcnt lgkmcnt(8)
    v_mfma_f32_32x32x16_bf16 a[16:31], v[40:43], a[92:95], a[16:31]
    ds_read_b64_tr_b16 v[20:21], v13 offset:20544
    ds_read_b64_tr_b16 v[22:23], v13 offset:23104
    s_waitcnt lgkmcnt(8)
    v_mfma_f32_32x32x16_bf16 a[32:47], v[44:47], a[92:95], a[32:47]
    ds_read_b64_tr_b16 v[24:25], v13 offset:20608
    ds_read_b64_tr_b16 v[26:27], v13 offset:23168
    s_waitcnt lgkmcnt(8)
    v_mfma_f32_32x32x16_bf16 a[48:63], v[48:51], a[92:95], a[48:63]
    ds_read_b64_tr_b16 v[28:29], v13 offset:20672
    ds_read_b64_tr_b16 v[30:31], v13 offset:23232
    s_waitcnt lgkmcnt(8)
    v_mfma_f32_32x32x16_bf16 a[64:79], v[52:55], a[92:95], a[64:79]
    ds_read_b64_tr_b16 v[32:33], v13 offset:20736
    ds_read_b64_tr_b16 v[34:35], v13 offset:23296
    s_waitcnt lgkmcnt(8)
    v_mfma_f32_32x32x16_bf16 a[0:15], v[16:19], a[96:99], a[0:15]
    ds_read_b64_tr_b16 v[36:37], v13 offset:25600
    ds_read_b64_tr_b16 v[38:39], v13 offset:28160
    s_waitcnt lgkmcnt(8)
    v_mfma_f32_32x32x16_bf16 a[16:31], v[20:23], a[96:99], a[16:31]
    ds_read_b64_tr_b16 v[40:41], v13 offset:25664
    ds_read_b64_tr_b16 v[42:43], v13 offset:28224
    s_waitcnt lgkmcnt(8)
    v_mfma_f32_32x32x16_bf16 a[32:47], v[24:27], a[96:99], a[32:47]
    ds_read_b64_tr_b16 v[44:45], v13 offset:25728
    ds_read_b64_tr_b16 v[46:47], v13 offset:28288
    s_waitcnt lgkmcnt(8)
    v_mfma_f32_32x32x16_bf16 a[48:63], v[28:31], a[96:99], a[48:63]
    ds_read_b64_tr_b16 v[48:49], v13 offset:25792
    ds_read_b64_tr_b16 v[50:51], v13 offset:28352
    s_waitcnt lgkmcnt(8)
    v_mfma_f32_32x32x16_bf16 a[64:79], v[32:35], a[96:99], a[64:79]
    ds_read_b64_tr_b16 v[52:53], v13 offset:25856
    ds_read_b64_tr_b16 v[54:55], v13 offset:28416
    s_waitcnt lgkmcnt(8)
    v_mfma_f32_32x32x16_bf16 a[0:15], v[36:39], a[100:103], a[0:15]
    ds_read_b64_tr_b16 v[16:17], v13 offset:30720
    ds_read_b64_tr_b16 v[18:19], v13 offset:33280
    s_waitcnt lgkmcnt(8)
    v_mfma_f32_32x32x16_bf16 a[16:31], v[40:43], a[100:103], a[16:31]
    ds_read_b64_tr_b16 v[20:21], v13 offset:30784
    ds_read_b64_tr_b16 v[22:23], v13 offset:33344
    s_waitcnt lgkmcnt(8)
    v_mfma_f32_32x32x16_bf16 a[32:47], v[44:47], a[100:103], a[32:47]
    ds_read_b64_tr_b16 v[24:25], v13 offset:30848
    ds_read_b64_tr_b16 v[26:27], v13 offset:33408
    s_waitcnt lgkmcnt(8)
    v_mfma_f32_32x32x16_bf16 a[48:63], v[48:51], a[100:103], a[48:63]
    ds_read_b64_tr_b16 v[28:29], v13 offset:30912
    ds_read_b64_tr_b16 v[30:31], v13 offset:33472
    s_waitcnt lgkmcnt(8)
    v_mfma_f32_32x32x16_bf16 a[64:79], v[52:55], a[100:103], a[64:79]
    ds_read_b64_tr_b16 v[32:33], v13 offset:30976
    ds_read_b64_tr_b16 v[34:35], v13 offset:33536
    s_waitcnt lgkmcnt(8)
    v_mfma_f32_32x32x16_bf16 a[0:15], v[16:19], a[104:107], a[0:15]
    ds_read_b64_tr_b16 v[36:37], v13 offset:35840
    ds_read_b64_tr_b16 v[38:39], v13 offset:38400
    s_waitcnt lgkmcnt(8)
    v_mfma_f32_32x32x16_bf16 a[16:31], v[20:23], a[104:107], a[16:31]
    ds_read_b64_tr_b16 v[40:41], v13 offset:35904
    ds_read_b64_tr_b16 v[42:43], v13 offset:38464
    s_waitcnt lgkmcnt(8)
    v_mfma_f32_32x32x16_bf16 a[32:47], v[24:27], a[104:107], a[32:47]
    ds_read_b64_tr_b16 v[44:45], v13 offset:35968
    ds_read_b64_tr_b16 v[46:47], v13 offset:38528
    s_waitcnt lgkmcnt(8)
    v_mfma_f32_32x32x16_bf16 a[48:63], v[28:31], a[104:107], a[48:63]
    ds_read_b64_tr_b16 v[48:49], v13 offset:36032
    ds_read_b64_tr_b16 v[50:51], v13 offset:38592
    s_waitcnt lgkmcnt(8)
    v_mfma_f32_32x32x16_bf16 a[64:79], v[32:35], a[104:107], a[64:79]
    ds_read_b64_tr_b16 v[52:53], v13 offset:36096
    ds_read_b64_tr_b16 v[54:55], v13 offset:38656
    s_waitcnt lgkmcnt(8)
    v_mfma_f32_32x32x16_bf16 a[0:15], v[36:39], a[108:111], a[0:15]
    s_waitcnt lgkmcnt(6)
    v_mfma_f32_32x32x16_bf16 a[16:31], v[40:43], a[108:111], a[16:31]
    s_waitcnt lgkmcnt(4)
    v_mfma_f32_32x32x16_bf16 a[32:47], v[44:47], a[108:111], a[32:47]
    s_waitcnt lgkmcnt(2)
    v_mfma_f32_32x32x16_bf16 a[48:63], v[48:51], a[108:111], a[48:63]
    s_waitcnt lgkmcnt(0)
    v_mfma_f32_32x32x16_bf16 a[64:79], v[52:55], a[108:111], a[64:79]
    s_nop 7
    s_nop 7
    s_mov_b32 s32, s20
    s_mov_b32 s33, s21
    s_add_u32 s32, s32, 134217728
    s_addc_u32 s33, s33, 0
    s_mov_b32 s34, 31457280
    s_mov_b32 s35, 0x00020000
    s_cmp_lg_u32 s72, 0
    s_cbranch_scc1 oproj_RED1
    v_lshlrev_b32 v4, 3, v0
    v_sub_u32 v3, v10, v4
    s_mov_b32 s51, 122880
    v_accvgpr_read_b32 v16, a20
    v_accvgpr_read_b32 v17, a21
    v_accvgpr_read_b32 v18, a22
    v_accvgpr_read_b32 v19, a23
    v_cvt_pk_bf16_f32 v40, v16, v17
    v_cvt_pk_bf16_f32 v41, v18, v19
    v_accvgpr_read_b32 v20, a24
    v_accvgpr_read_b32 v21, a25
    v_accvgpr_read_b32 v22, a26
    v_accvgpr_read_b32 v23, a27
    v_cvt_pk_bf16_f32 v42, v20, v21
    v_cvt_pk_bf16_f32 v43, v22, v23
    buffer_store_dwordx4 v[40:43], v10, s[32:35], s51 offen offset:0 sc1
    v_accvgpr_read_b32 v24, a28
    v_accvgpr_read_b32 v25, a29
    v_accvgpr_read_b32 v26, a30
    v_accvgpr_read_b32 v27, a31
    v_cvt_pk_bf16_f32 v44, v24, v25
    v_cvt_pk_bf16_f32 v45, v26, v27
    v_accvgpr_read_b32 v28, a32
    v_accvgpr_read_b32 v29, a33
    v_accvgpr_read_b32 v30, a34
    v_accvgpr_read_b32 v31, a35
    v_cvt_pk_bf16_f32 v46, v28, v29
    v_cvt_pk_bf16_f32 v47, v30, v31
    buffer_store_dwordx4 v[44:47], v10, s[32:35], s51 offen offset:1024 sc1
    v_accvgpr_read_b32 v32, a36
    v_accvgpr_read_b32 v33, a37
    v_accvgpr_read_b32 v34, a38
    v_accvgpr_read_b32 v35, a39
    v_cvt_pk_bf16_f32 v48, v32, v33
    v_cvt_pk_bf16_f32 v49, v34, v35
    buffer_store_dwordx2 v[48:49], v3, s[32:35], s51 offen offset:2048 sc1
    s_mov_b32 s51, 245760
    v_accvgpr_read_b32 v16, a40
    v_accvgpr_read_b32 v17, a41
    v_accvgpr_read_b32 v18, a42
    v_accvgpr_read_b32 v19, a43
    v_cvt_pk_bf16_f32 v52, v16, v17
    v_cvt_pk_bf16_f32 v53, v18, v19
    v_accvgpr_read_b32 v20, a44
    v_accvgpr_read_b32 v21, a45
    v_accvgpr_read_b32 v22, a46
    v_accvgpr_read_b32 v23, a47
    v_cvt_pk_bf16_f32 v54, v20, v21
    v_cvt_pk_bf16_f32 v55, v22, v23
    buffer_store_dwordx4 v[52:55], v10, s[32:35], s51 offen offset:0 sc1
    v_accvgpr_read_b32 v24, a48
    v_accvgpr_read_b32 v25, a49
    v_accvgpr_read_b32 v26, a50
    v_accvgpr_read_b32 v27, a51
    v_cvt_pk_bf16_f32 v56, v24, v25
    v_cvt_pk_bf16_f32 v57, v26, v27
    v_accvgpr_read_b32 v28, a52
    v_accvgpr_read_b32 v29, a53
    v_accvgpr_read_b32 v30, a54
    v_accvgpr_read_b32 v31, a55
    v_cvt_pk_bf16_f32 v58, v28, v29
    v_cvt_pk_bf16_f32 v59, v30, v31
    buffer_store_dwordx4 v[56:59], v10, s[32:35], s51 offen offset:1024 sc1
    v_accvgpr_read_b32 v32, a56
    v_accvgpr_read_b32 v33, a57
    v_accvgpr_read_b32 v34, a58
    v_accvgpr_read_b32 v35, a59
    v_cvt_pk_bf16_f32 v60, v32, v33
    v_cvt_pk_bf16_f32 v61, v34, v35
    buffer_store_dwordx2 v[60:61], v3, s[32:35], s51 offen offset:2048 sc1
    s_mov_b32 s51, 368640
    v_accvgpr_read_b32 v16, a60
    v_accvgpr_read_b32 v17, a61
    v_accvgpr_read_b32 v18, a62
    v_accvgpr_read_b32 v19, a63
    v_cvt_pk_bf16_f32 v64, v16, v17
    v_cvt_pk_bf16_f32 v65, v18, v19
    v_accvgpr_read_b32 v20, a64
    v_accvgpr_read_b32 v21, a65
    v_accvgpr_read_b32 v22, a66
    v_accvgpr_read_b32 v23, a67
    v_cvt_pk_bf16_f32 v66, v20, v21
    v_cvt_pk_bf16_f32 v67, v22, v23
    buffer_store_dwordx4 v[64:67], v10, s[32:35], s51 offen offset:0 sc1
    v_accvgpr_read_b32 v24, a68
    v_accvgpr_read_b32 v25, a69
    v_accvgpr_read_b32 v26, a70
    v_accvgpr_read_b32 v27, a71
    v_cvt_pk_bf16_f32 v68, v24, v25
    v_cvt_pk_bf16_f32 v69, v26, v27
    v_accvgpr_read_b32 v28, a72
    v_accvgpr_read_b32 v29, a73
    v_accvgpr_read_b32 v30, a74
    v_accvgpr_read_b32 v31, a75
    v_cvt_pk_bf16_f32 v70, v28, v29
    v_cvt_pk_bf16_f32 v71, v30, v31
    buffer_store_dwordx4 v[68:71], v10, s[32:35], s51 offen offset:1024 sc1
    v_accvgpr_read_b32 v32, a76
    v_accvgpr_read_b32 v33, a77
    v_accvgpr_read_b32 v34, a78
    v_accvgpr_read_b32 v35, a79
    v_cvt_pk_bf16_f32 v72, v32, v33
    v_cvt_pk_bf16_f32 v73, v34, v35
    buffer_store_dwordx2 v[72:73], v3, s[32:35], s51 offen offset:2048 sc1
    s_waitcnt vmcnt(0)
    s_barrier
    s_cmp_lg_u32 s75, 0
    s_cbranch_scc1 oproj_P0_W
    s_lshl_b32 s51, s74, 2
    v_mov_b32 v56, s51
    v_mov_b32 v57, 1
    s_mov_b64 exec, 1
    buffer_atomic_add v57, v56, s[84:87], 0 offen
oproj_P0:
    buffer_load_dword v58, v56, s[84:87], 0 offen sc1
    s_waitcnt vmcnt(0)
    v_readfirstlane_b32 s52, v58
    s_nop 3
    s_and_b32 s52, s52, 0xff
    s_cmp_ge_u32 s52, 4
    s_cbranch_scc1 oproj_P0_D
    s_sleep 4
    s_branch oproj_P0
oproj_P0_D:
    s_mov_b64 exec, -1
oproj_P0_W:
    s_nop 7
    s_nop 7
    s_barrier
    s_mov_b32 s51, 0
    buffer_load_dwordx4 v[16:19], v10, s[32:35], s51 offen offset:0 sc1
    s_mov_b32 s51, 40960
    buffer_load_dwordx4 v[28:31], v10, s[32:35], s51 offen offset:0 sc1
    s_mov_b32 s51, 81920
    buffer_load_dwordx4 v[40:43], v10, s[32:35], s51 offen offset:0 sc1
    s_mov_b32 s51, 0
    buffer_load_dwordx4 v[20:23], v10, s[32:35], s51 offen offset:1024 sc1
    s_mov_b32 s51, 40960
    buffer_load_dwordx4 v[32:35], v10, s[32:35], s51 offen offset:1024 sc1
    s_mov_b32 s51, 81920
    buffer_load_dwordx4 v[44:47], v10, s[32:35], s51 offen offset:1024 sc1
    s_mov_b32 s51, 0
    buffer_load_dwordx2 v[24:25], v3, s[32:35], s51 offen offset:2048 sc1
    s_mov_b32 s51, 40960
    buffer_load_dwordx2 v[36:37], v3, s[32:35], s51 offen offset:2048 sc1
    s_mov_b32 s51, 81920
    buffer_load_dwordx2 v[48:49], v3, s[32:35], s51 offen offset:2048 sc1
    v_accvgpr_read_b32 v76, a0
    v_accvgpr_read_b32 v77, a1
    v_accvgpr_read_b32 v78, a2
    v_accvgpr_read_b32 v79, a3
    s_waitcnt vmcnt(8)
    v_lshlrev_b32 v56, 16, v16
    v_and_b32 v57, 0xffff0000, v16
    v_lshlrev_b32 v58, 16, v17
    v_and_b32 v59, 0xffff0000, v17
    v_add_f32 v76, v76, v56
    v_add_f32 v77, v77, v57
    v_add_f32 v78, v78, v58
    v_add_f32 v79, v79, v59
    s_waitcnt vmcnt(7)
    v_lshlrev_b32 v60, 16, v28
    v_and_b32 v61, 0xffff0000, v28
    v_lshlrev_b32 v62, 16, v29
    v_and_b32 v63, 0xffff0000, v29
    v_add_f32 v76, v76, v60
    v_add_f32 v77, v77, v61
    v_add_f32 v78, v78, v62
    v_add_f32 v79, v79, v63
    s_waitcnt vmcnt(6)
    v_lshlrev_b32 v56, 16, v40
    v_and_b32 v57, 0xffff0000, v40
    v_lshlrev_b32 v58, 16, v41
    v_and_b32 v59, 0xffff0000, v41
    v_add_f32 v76, v76, v56
    v_add_f32 v77, v77, v57
    v_add_f32 v78, v78, v58
    v_add_f32 v79, v79, v59
    v_cvt_pk_bf16_f32 v84, v76, v77
    v_cvt_pk_bf16_f32 v85, v78, v79
    buffer_store_dwordx2 v[84:85], v9, s[36:39], 0 offen offset:0
    v_accvgpr_read_b32 v80, a4
    v_accvgpr_read_b32 v81, a5
    v_accvgpr_read_b32 v82, a6
    v_accvgpr_read_b32 v83, a7
    v_lshlrev_b32 v56, 16, v18
    v_and_b32 v57, 0xffff0000, v18
    v_lshlrev_b32 v58, 16, v19
    v_and_b32 v59, 0xffff0000, v19
    v_add_f32 v80, v80, v56
    v_add_f32 v81, v81, v57
    v_add_f32 v82, v82, v58
    v_add_f32 v83, v83, v59
    v_lshlrev_b32 v60, 16, v30
    v_and_b32 v61, 0xffff0000, v30
    v_lshlrev_b32 v62, 16, v31
    v_and_b32 v63, 0xffff0000, v31
    v_add_f32 v80, v80, v60
    v_add_f32 v81, v81, v61
    v_add_f32 v82, v82, v62
    v_add_f32 v83, v83, v63
    v_lshlrev_b32 v56, 16, v42
    v_and_b32 v57, 0xffff0000, v42
    v_lshlrev_b32 v58, 16, v43
    v_and_b32 v59, 0xffff0000, v43
    v_add_f32 v80, v80, v56
    v_add_f32 v81, v81, v57
    v_add_f32 v82, v82, v58
    v_add_f32 v83, v83, v59
    v_cvt_pk_bf16_f32 v86, v80, v81
    v_cvt_pk_bf16_f32 v87, v82, v83
    buffer_store_dwordx2 v[86:87], v9, s[36:39], 0 offen offset:16
    v_accvgpr_read_b32 v76, a8
    v_accvgpr_read_b32 v77, a9
    v_accvgpr_read_b32 v78, a10
    v_accvgpr_read_b32 v79, a11
    s_waitcnt vmcnt(7)
    v_lshlrev_b32 v56, 16, v20
    v_and_b32 v57, 0xffff0000, v20
    v_lshlrev_b32 v58, 16, v21
    v_and_b32 v59, 0xffff0000, v21
    v_add_f32 v76, v76, v56
    v_add_f32 v77, v77, v57
    v_add_f32 v78, v78, v58
    v_add_f32 v79, v79, v59
    s_waitcnt vmcnt(6)
    v_lshlrev_b32 v60, 16, v32
    v_and_b32 v61, 0xffff0000, v32
    v_lshlrev_b32 v62, 16, v33
    v_and_b32 v63, 0xffff0000, v33
    v_add_f32 v76, v76, v60
    v_add_f32 v77, v77, v61
    v_add_f32 v78, v78, v62
    v_add_f32 v79, v79, v63
    s_waitcnt vmcnt(5)
    v_lshlrev_b32 v56, 16, v44
    v_and_b32 v57, 0xffff0000, v44
    v_lshlrev_b32 v58, 16, v45
    v_and_b32 v59, 0xffff0000, v45
    v_add_f32 v76, v76, v56
    v_add_f32 v77, v77, v57
    v_add_f32 v78, v78, v58
    v_add_f32 v79, v79, v59
    v_cvt_pk_bf16_f32 v84, v76, v77
    v_cvt_pk_bf16_f32 v85, v78, v79
    buffer_store_dwordx2 v[84:85], v9, s[36:39], 0 offen offset:32
    v_accvgpr_read_b32 v80, a12
    v_accvgpr_read_b32 v81, a13
    v_accvgpr_read_b32 v82, a14
    v_accvgpr_read_b32 v83, a15
    v_lshlrev_b32 v56, 16, v22
    v_and_b32 v57, 0xffff0000, v22
    v_lshlrev_b32 v58, 16, v23
    v_and_b32 v59, 0xffff0000, v23
    v_add_f32 v80, v80, v56
    v_add_f32 v81, v81, v57
    v_add_f32 v82, v82, v58
    v_add_f32 v83, v83, v59
    v_lshlrev_b32 v60, 16, v34
    v_and_b32 v61, 0xffff0000, v34
    v_lshlrev_b32 v62, 16, v35
    v_and_b32 v63, 0xffff0000, v35
    v_add_f32 v80, v80, v60
    v_add_f32 v81, v81, v61
    v_add_f32 v82, v82, v62
    v_add_f32 v83, v83, v63
    v_lshlrev_b32 v56, 16, v46
    v_and_b32 v57, 0xffff0000, v46
    v_lshlrev_b32 v58, 16, v47
    v_and_b32 v59, 0xffff0000, v47
    v_add_f32 v80, v80, v56
    v_add_f32 v81, v81, v57
    v_add_f32 v82, v82, v58
    v_add_f32 v83, v83, v59
    v_cvt_pk_bf16_f32 v86, v80, v81
    v_cvt_pk_bf16_f32 v87, v82, v83
    buffer_store_dwordx2 v[86:87], v9, s[36:39], 0 offen offset:48
    v_accvgpr_read_b32 v76, a16
    v_accvgpr_read_b32 v77, a17
    v_accvgpr_read_b32 v78, a18
    v_accvgpr_read_b32 v79, a19
    s_waitcnt vmcnt(6)
    v_lshlrev_b32 v56, 16, v24
    v_and_b32 v57, 0xffff0000, v24
    v_lshlrev_b32 v58, 16, v25
    v_and_b32 v59, 0xffff0000, v25
    v_add_f32 v76, v76, v56
    v_add_f32 v77, v77, v57
    v_add_f32 v78, v78, v58
    v_add_f32 v79, v79, v59
    s_waitcnt vmcnt(5)
    v_lshlrev_b32 v60, 16, v36
    v_and_b32 v61, 0xffff0000, v36
    v_lshlrev_b32 v62, 16, v37
    v_and_b32 v63, 0xffff0000, v37
    v_add_f32 v76, v76, v60
    v_add_f32 v77, v77, v61
    v_add_f32 v78, v78, v62
    v_add_f32 v79, v79, v63
    s_waitcnt vmcnt(4)
    v_lshlrev_b32 v56, 16, v48
    v_and_b32 v57, 0xffff0000, v48
    v_lshlrev_b32 v58, 16, v49
    v_and_b32 v59, 0xffff0000, v49
    v_add_f32 v76, v76, v56
    v_add_f32 v77, v77, v57
    v_add_f32 v78, v78, v58
    v_add_f32 v79, v79, v59
    v_cvt_pk_bf16_f32 v84, v76, v77
    v_cvt_pk_bf16_f32 v85, v78, v79
    buffer_store_dwordx2 v[84:85], v9, s[36:39], 0 offen offset:64
    s_waitcnt vmcnt(0)
    s_endpgm
oproj_RED1:
    s_nop 7
    s_nop 7
    s_cmp_lg_u32 s72, 1
    s_cbranch_scc1 oproj_RED2
    v_lshlrev_b32 v4, 3, v0
    v_sub_u32 v3, v10, v4
    s_mov_b32 s51, 0
    v_accvgpr_read_b32 v16, a0
    v_accvgpr_read_b32 v17, a1
    v_accvgpr_read_b32 v18, a2
    v_accvgpr_read_b32 v19, a3
    v_cvt_pk_bf16_f32 v40, v16, v17
    v_cvt_pk_bf16_f32 v41, v18, v19
    v_accvgpr_read_b32 v20, a4
    v_accvgpr_read_b32 v21, a5
    v_accvgpr_read_b32 v22, a6
    v_accvgpr_read_b32 v23, a7
    v_cvt_pk_bf16_f32 v42, v20, v21
    v_cvt_pk_bf16_f32 v43, v22, v23
    buffer_store_dwordx4 v[40:43], v10, s[32:35], s51 offen offset:0 sc1
    v_accvgpr_read_b32 v24, a8
    v_accvgpr_read_b32 v25, a9
    v_accvgpr_read_b32 v26, a10
    v_accvgpr_read_b32 v27, a11
    v_cvt_pk_bf16_f32 v44, v24, v25
    v_cvt_pk_bf16_f32 v45, v26, v27
    v_accvgpr_read_b32 v28, a12
    v_accvgpr_read_b32 v29, a13
    v_accvgpr_read_b32 v30, a14
    v_accvgpr_read_b32 v31, a15
    v_cvt_pk_bf16_f32 v46, v28, v29
    v_cvt_pk_bf16_f32 v47, v30, v31
    buffer_store_dwordx4 v[44:47], v10, s[32:35], s51 offen offset:1024 sc1
    v_accvgpr_read_b32 v32, a16
    v_accvgpr_read_b32 v33, a17
    v_accvgpr_read_b32 v34, a18
    v_accvgpr_read_b32 v35, a19
    v_cvt_pk_bf16_f32 v48, v32, v33
    v_cvt_pk_bf16_f32 v49, v34, v35
    buffer_store_dwordx2 v[48:49], v3, s[32:35], s51 offen offset:2048 sc1
    s_mov_b32 s51, 286720
    v_accvgpr_read_b32 v16, a40
    v_accvgpr_read_b32 v17, a41
    v_accvgpr_read_b32 v18, a42
    v_accvgpr_read_b32 v19, a43
    v_cvt_pk_bf16_f32 v52, v16, v17
    v_cvt_pk_bf16_f32 v53, v18, v19
    v_accvgpr_read_b32 v20, a44
    v_accvgpr_read_b32 v21, a45
    v_accvgpr_read_b32 v22, a46
    v_accvgpr_read_b32 v23, a47
    v_cvt_pk_bf16_f32 v54, v20, v21
    v_cvt_pk_bf16_f32 v55, v22, v23
    buffer_store_dwordx4 v[52:55], v10, s[32:35], s51 offen offset:0 sc1
    v_accvgpr_read_b32 v24, a48
    v_accvgpr_read_b32 v25, a49
    v_accvgpr_read_b32 v26, a50
    v_accvgpr_read_b32 v27, a51
    v_cvt_pk_bf16_f32 v56, v24, v25
    v_cvt_pk_bf16_f32 v57, v26, v27
    v_accvgpr_read_b32 v28, a52
    v_accvgpr_read_b32 v29, a53
    v_accvgpr_read_b32 v30, a54
    v_accvgpr_read_b32 v31, a55
    v_cvt_pk_bf16_f32 v58, v28, v29
    v_cvt_pk_bf16_f32 v59, v30, v31
    buffer_store_dwordx4 v[56:59], v10, s[32:35], s51 offen offset:1024 sc1
    v_accvgpr_read_b32 v32, a56
    v_accvgpr_read_b32 v33, a57
    v_accvgpr_read_b32 v34, a58
    v_accvgpr_read_b32 v35, a59
    v_cvt_pk_bf16_f32 v60, v32, v33
    v_cvt_pk_bf16_f32 v61, v34, v35
    buffer_store_dwordx2 v[60:61], v3, s[32:35], s51 offen offset:2048 sc1
    s_mov_b32 s51, 409600
    v_accvgpr_read_b32 v16, a60
    v_accvgpr_read_b32 v17, a61
    v_accvgpr_read_b32 v18, a62
    v_accvgpr_read_b32 v19, a63
    v_cvt_pk_bf16_f32 v64, v16, v17
    v_cvt_pk_bf16_f32 v65, v18, v19
    v_accvgpr_read_b32 v20, a64
    v_accvgpr_read_b32 v21, a65
    v_accvgpr_read_b32 v22, a66
    v_accvgpr_read_b32 v23, a67
    v_cvt_pk_bf16_f32 v66, v20, v21
    v_cvt_pk_bf16_f32 v67, v22, v23
    buffer_store_dwordx4 v[64:67], v10, s[32:35], s51 offen offset:0 sc1
    v_accvgpr_read_b32 v24, a68
    v_accvgpr_read_b32 v25, a69
    v_accvgpr_read_b32 v26, a70
    v_accvgpr_read_b32 v27, a71
    v_cvt_pk_bf16_f32 v68, v24, v25
    v_cvt_pk_bf16_f32 v69, v26, v27
    v_accvgpr_read_b32 v28, a72
    v_accvgpr_read_b32 v29, a73
    v_accvgpr_read_b32 v30, a74
    v_accvgpr_read_b32 v31, a75
    v_cvt_pk_bf16_f32 v70, v28, v29
    v_cvt_pk_bf16_f32 v71, v30, v31
    buffer_store_dwordx4 v[68:71], v10, s[32:35], s51 offen offset:1024 sc1
    v_accvgpr_read_b32 v32, a76
    v_accvgpr_read_b32 v33, a77
    v_accvgpr_read_b32 v34, a78
    v_accvgpr_read_b32 v35, a79
    v_cvt_pk_bf16_f32 v72, v32, v33
    v_cvt_pk_bf16_f32 v73, v34, v35
    buffer_store_dwordx2 v[72:73], v3, s[32:35], s51 offen offset:2048 sc1
    s_waitcnt vmcnt(0)
    s_barrier
    s_cmp_lg_u32 s75, 0
    s_cbranch_scc1 oproj_P1_W
    s_lshl_b32 s51, s74, 2
    v_mov_b32 v56, s51
    v_mov_b32 v57, 1
    s_mov_b64 exec, 1
    buffer_atomic_add v57, v56, s[84:87], 0 offen
oproj_P1:
    buffer_load_dword v58, v56, s[84:87], 0 offen sc1
    s_waitcnt vmcnt(0)
    v_readfirstlane_b32 s52, v58
    s_nop 3
    s_and_b32 s52, s52, 0xff
    s_cmp_ge_u32 s52, 4
    s_cbranch_scc1 oproj_P1_D
    s_sleep 4
    s_branch oproj_P1
oproj_P1_D:
    s_mov_b64 exec, -1
oproj_P1_W:
    s_nop 7
    s_nop 7
    s_barrier
    s_mov_b32 s51, 122880
    buffer_load_dwordx4 v[16:19], v10, s[32:35], s51 offen offset:0 sc1
    s_mov_b32 s51, 163840
    buffer_load_dwordx4 v[28:31], v10, s[32:35], s51 offen offset:0 sc1
    s_mov_b32 s51, 204800
    buffer_load_dwordx4 v[40:43], v10, s[32:35], s51 offen offset:0 sc1
    s_mov_b32 s51, 122880
    buffer_load_dwordx4 v[20:23], v10, s[32:35], s51 offen offset:1024 sc1
    s_mov_b32 s51, 163840
    buffer_load_dwordx4 v[32:35], v10, s[32:35], s51 offen offset:1024 sc1
    s_mov_b32 s51, 204800
    buffer_load_dwordx4 v[44:47], v10, s[32:35], s51 offen offset:1024 sc1
    s_mov_b32 s51, 122880
    buffer_load_dwordx2 v[24:25], v3, s[32:35], s51 offen offset:2048 sc1
    s_mov_b32 s51, 163840
    buffer_load_dwordx2 v[36:37], v3, s[32:35], s51 offen offset:2048 sc1
    s_mov_b32 s51, 204800
    buffer_load_dwordx2 v[48:49], v3, s[32:35], s51 offen offset:2048 sc1
    v_accvgpr_read_b32 v76, a20
    v_accvgpr_read_b32 v77, a21
    v_accvgpr_read_b32 v78, a22
    v_accvgpr_read_b32 v79, a23
    s_waitcnt vmcnt(8)
    v_lshlrev_b32 v56, 16, v16
    v_and_b32 v57, 0xffff0000, v16
    v_lshlrev_b32 v58, 16, v17
    v_and_b32 v59, 0xffff0000, v17
    v_add_f32 v76, v76, v56
    v_add_f32 v77, v77, v57
    v_add_f32 v78, v78, v58
    v_add_f32 v79, v79, v59
    s_waitcnt vmcnt(7)
    v_lshlrev_b32 v60, 16, v28
    v_and_b32 v61, 0xffff0000, v28
    v_lshlrev_b32 v62, 16, v29
    v_and_b32 v63, 0xffff0000, v29
    v_add_f32 v76, v76, v60
    v_add_f32 v77, v77, v61
    v_add_f32 v78, v78, v62
    v_add_f32 v79, v79, v63
    s_waitcnt vmcnt(6)
    v_lshlrev_b32 v56, 16, v40
    v_and_b32 v57, 0xffff0000, v40
    v_lshlrev_b32 v58, 16, v41
    v_and_b32 v59, 0xffff0000, v41
    v_add_f32 v76, v76, v56
    v_add_f32 v77, v77, v57
    v_add_f32 v78, v78, v58
    v_add_f32 v79, v79, v59
    v_cvt_pk_bf16_f32 v84, v76, v77
    v_cvt_pk_bf16_f32 v85, v78, v79
    buffer_store_dwordx2 v[84:85], v9, s[36:39], 0 offen offset:80
    v_accvgpr_read_b32 v80, a24
    v_accvgpr_read_b32 v81, a25
    v_accvgpr_read_b32 v82, a26
    v_accvgpr_read_b32 v83, a27
    v_lshlrev_b32 v56, 16, v18
    v_and_b32 v57, 0xffff0000, v18
    v_lshlrev_b32 v58, 16, v19
    v_and_b32 v59, 0xffff0000, v19
    v_add_f32 v80, v80, v56
    v_add_f32 v81, v81, v57
    v_add_f32 v82, v82, v58
    v_add_f32 v83, v83, v59
    v_lshlrev_b32 v60, 16, v30
    v_and_b32 v61, 0xffff0000, v30
    v_lshlrev_b32 v62, 16, v31
    v_and_b32 v63, 0xffff0000, v31
    v_add_f32 v80, v80, v60
    v_add_f32 v81, v81, v61
    v_add_f32 v82, v82, v62
    v_add_f32 v83, v83, v63
    v_lshlrev_b32 v56, 16, v42
    v_and_b32 v57, 0xffff0000, v42
    v_lshlrev_b32 v58, 16, v43
    v_and_b32 v59, 0xffff0000, v43
    v_add_f32 v80, v80, v56
    v_add_f32 v81, v81, v57
    v_add_f32 v82, v82, v58
    v_add_f32 v83, v83, v59
    v_cvt_pk_bf16_f32 v86, v80, v81
    v_cvt_pk_bf16_f32 v87, v82, v83
    buffer_store_dwordx2 v[86:87], v9, s[36:39], 0 offen offset:96
    v_accvgpr_read_b32 v76, a28
    v_accvgpr_read_b32 v77, a29
    v_accvgpr_read_b32 v78, a30
    v_accvgpr_read_b32 v79, a31
    s_waitcnt vmcnt(7)
    v_lshlrev_b32 v56, 16, v20
    v_and_b32 v57, 0xffff0000, v20
    v_lshlrev_b32 v58, 16, v21
    v_and_b32 v59, 0xffff0000, v21
    v_add_f32 v76, v76, v56
    v_add_f32 v77, v77, v57
    v_add_f32 v78, v78, v58
    v_add_f32 v79, v79, v59
    s_waitcnt vmcnt(6)
    v_lshlrev_b32 v60, 16, v32
    v_and_b32 v61, 0xffff0000, v32
    v_lshlrev_b32 v62, 16, v33
    v_and_b32 v63, 0xffff0000, v33
    v_add_f32 v76, v76, v60
    v_add_f32 v77, v77, v61
    v_add_f32 v78, v78, v62
    v_add_f32 v79, v79, v63
    s_waitcnt vmcnt(5)
    v_lshlrev_b32 v56, 16, v44
    v_and_b32 v57, 0xffff0000, v44
    v_lshlrev_b32 v58, 16, v45
    v_and_b32 v59, 0xffff0000, v45
    v_add_f32 v76, v76, v56
    v_add_f32 v77, v77, v57
    v_add_f32 v78, v78, v58
    v_add_f32 v79, v79, v59
    v_cvt_pk_bf16_f32 v84, v76, v77
    v_cvt_pk_bf16_f32 v85, v78, v79
    buffer_store_dwordx2 v[84:85], v9, s[36:39], 0 offen offset:112
    v_accvgpr_read_b32 v80, a32
    v_accvgpr_read_b32 v81, a33
    v_accvgpr_read_b32 v82, a34
    v_accvgpr_read_b32 v83, a35
    v_lshlrev_b32 v56, 16, v22
    v_and_b32 v57, 0xffff0000, v22
    v_lshlrev_b32 v58, 16, v23
    v_and_b32 v59, 0xffff0000, v23
    v_add_f32 v80, v80, v56
    v_add_f32 v81, v81, v57
    v_add_f32 v82, v82, v58
    v_add_f32 v83, v83, v59
    v_lshlrev_b32 v60, 16, v34
    v_and_b32 v61, 0xffff0000, v34
    v_lshlrev_b32 v62, 16, v35
    v_and_b32 v63, 0xffff0000, v35
    v_add_f32 v80, v80, v60
    v_add_f32 v81, v81, v61
    v_add_f32 v82, v82, v62
    v_add_f32 v83, v83, v63
    v_lshlrev_b32 v56, 16, v46
    v_and_b32 v57, 0xffff0000, v46
    v_lshlrev_b32 v58, 16, v47
    v_and_b32 v59, 0xffff0000, v47
    v_add_f32 v80, v80, v56
    v_add_f32 v81, v81, v57
    v_add_f32 v82, v82, v58
    v_add_f32 v83, v83, v59
    v_cvt_pk_bf16_f32 v86, v80, v81
    v_cvt_pk_bf16_f32 v87, v82, v83
    buffer_store_dwordx2 v[86:87], v9, s[36:39], 0 offen offset:128
    v_accvgpr_read_b32 v76, a36
    v_accvgpr_read_b32 v77, a37
    v_accvgpr_read_b32 v78, a38
    v_accvgpr_read_b32 v79, a39
    s_waitcnt vmcnt(6)
    v_lshlrev_b32 v56, 16, v24
    v_and_b32 v57, 0xffff0000, v24
    v_lshlrev_b32 v58, 16, v25
    v_and_b32 v59, 0xffff0000, v25
    v_add_f32 v76, v76, v56
    v_add_f32 v77, v77, v57
    v_add_f32 v78, v78, v58
    v_add_f32 v79, v79, v59
    s_waitcnt vmcnt(5)
    v_lshlrev_b32 v60, 16, v36
    v_and_b32 v61, 0xffff0000, v36
    v_lshlrev_b32 v62, 16, v37
    v_and_b32 v63, 0xffff0000, v37
    v_add_f32 v76, v76, v60
    v_add_f32 v77, v77, v61
    v_add_f32 v78, v78, v62
    v_add_f32 v79, v79, v63
    s_waitcnt vmcnt(4)
    v_lshlrev_b32 v56, 16, v48
    v_and_b32 v57, 0xffff0000, v48
    v_lshlrev_b32 v58, 16, v49
    v_and_b32 v59, 0xffff0000, v49
    v_add_f32 v76, v76, v56
    v_add_f32 v77, v77, v57
    v_add_f32 v78, v78, v58
    v_add_f32 v79, v79, v59
    v_cvt_pk_bf16_f32 v84, v76, v77
    v_cvt_pk_bf16_f32 v85, v78, v79
    buffer_store_dwordx2 v[84:85], v9, s[36:39], 0 offen offset:144
    s_waitcnt vmcnt(0)
    s_endpgm
oproj_RED2:
    s_nop 7
    s_nop 7
    s_cmp_lg_u32 s72, 2
    s_cbranch_scc1 oproj_RED3
    v_lshlrev_b32 v4, 3, v0
    v_sub_u32 v3, v10, v4
    s_mov_b32 s51, 40960
    v_accvgpr_read_b32 v16, a0
    v_accvgpr_read_b32 v17, a1
    v_accvgpr_read_b32 v18, a2
    v_accvgpr_read_b32 v19, a3
    v_cvt_pk_bf16_f32 v40, v16, v17
    v_cvt_pk_bf16_f32 v41, v18, v19
    v_accvgpr_read_b32 v20, a4
    v_accvgpr_read_b32 v21, a5
    v_accvgpr_read_b32 v22, a6
    v_accvgpr_read_b32 v23, a7
    v_cvt_pk_bf16_f32 v42, v20, v21
    v_cvt_pk_bf16_f32 v43, v22, v23
    buffer_store_dwordx4 v[40:43], v10, s[32:35], s51 offen offset:0 sc1
    v_accvgpr_read_b32 v24, a8
    v_accvgpr_read_b32 v25, a9
    v_accvgpr_read_b32 v26, a10
    v_accvgpr_read_b32 v27, a11
    v_cvt_pk_bf16_f32 v44, v24, v25
    v_cvt_pk_bf16_f32 v45, v26, v27
    v_accvgpr_read_b32 v28, a12
    v_accvgpr_read_b32 v29, a13
    v_accvgpr_read_b32 v30, a14
    v_accvgpr_read_b32 v31, a15
    v_cvt_pk_bf16_f32 v46, v28, v29
    v_cvt_pk_bf16_f32 v47, v30, v31
    buffer_store_dwordx4 v[44:47], v10, s[32:35], s51 offen offset:1024 sc1
    v_accvgpr_read_b32 v32, a16
    v_accvgpr_read_b32 v33, a17
    v_accvgpr_read_b32 v34, a18
    v_accvgpr_read_b32 v35, a19
    v_cvt_pk_bf16_f32 v48, v32, v33
    v_cvt_pk_bf16_f32 v49, v34, v35
    buffer_store_dwordx2 v[48:49], v3, s[32:35], s51 offen offset:2048 sc1
    s_mov_b32 s51, 163840
    v_accvgpr_read_b32 v16, a20
    v_accvgpr_read_b32 v17, a21
    v_accvgpr_read_b32 v18, a22
    v_accvgpr_read_b32 v19, a23
    v_cvt_pk_bf16_f32 v52, v16, v17
    v_cvt_pk_bf16_f32 v53, v18, v19
    v_accvgpr_read_b32 v20, a24
    v_accvgpr_read_b32 v21, a25
    v_accvgpr_read_b32 v22, a26
    v_accvgpr_read_b32 v23, a27
    v_cvt_pk_bf16_f32 v54, v20, v21
    v_cvt_pk_bf16_f32 v55, v22, v23
    buffer_store_dwordx4 v[52:55], v10, s[32:35], s51 offen offset:0 sc1
    v_accvgpr_read_b32 v24, a28
    v_accvgpr_read_b32 v25, a29
    v_accvgpr_read_b32 v26, a30
    v_accvgpr_read_b32 v27, a31
    v_cvt_pk_bf16_f32 v56, v24, v25
    v_cvt_pk_bf16_f32 v57, v26, v27
    v_accvgpr_read_b32 v28, a32
    v_accvgpr_read_b32 v29, a33
    v_accvgpr_read_b32 v30, a34
    v_accvgpr_read_b32 v31, a35
    v_cvt_pk_bf16_f32 v58, v28, v29
    v_cvt_pk_bf16_f32 v59, v30, v31
    buffer_store_dwordx4 v[56:59], v10, s[32:35], s51 offen offset:1024 sc1
    v_accvgpr_read_b32 v32, a36
    v_accvgpr_read_b32 v33, a37
    v_accvgpr_read_b32 v34, a38
    v_accvgpr_read_b32 v35, a39
    v_cvt_pk_bf16_f32 v60, v32, v33
    v_cvt_pk_bf16_f32 v61, v34, v35
    buffer_store_dwordx2 v[60:61], v3, s[32:35], s51 offen offset:2048 sc1
    s_mov_b32 s51, 450560
    v_accvgpr_read_b32 v16, a60
    v_accvgpr_read_b32 v17, a61
    v_accvgpr_read_b32 v18, a62
    v_accvgpr_read_b32 v19, a63
    v_cvt_pk_bf16_f32 v64, v16, v17
    v_cvt_pk_bf16_f32 v65, v18, v19
    v_accvgpr_read_b32 v20, a64
    v_accvgpr_read_b32 v21, a65
    v_accvgpr_read_b32 v22, a66
    v_accvgpr_read_b32 v23, a67
    v_cvt_pk_bf16_f32 v66, v20, v21
    v_cvt_pk_bf16_f32 v67, v22, v23
    buffer_store_dwordx4 v[64:67], v10, s[32:35], s51 offen offset:0 sc1
    v_accvgpr_read_b32 v24, a68
    v_accvgpr_read_b32 v25, a69
    v_accvgpr_read_b32 v26, a70
    v_accvgpr_read_b32 v27, a71
    v_cvt_pk_bf16_f32 v68, v24, v25
    v_cvt_pk_bf16_f32 v69, v26, v27
    v_accvgpr_read_b32 v28, a72
    v_accvgpr_read_b32 v29, a73
    v_accvgpr_read_b32 v30, a74
    v_accvgpr_read_b32 v31, a75
    v_cvt_pk_bf16_f32 v70, v28, v29
    v_cvt_pk_bf16_f32 v71, v30, v31
    buffer_store_dwordx4 v[68:71], v10, s[32:35], s51 offen offset:1024 sc1
    v_accvgpr_read_b32 v32, a76
    v_accvgpr_read_b32 v33, a77
    v_accvgpr_read_b32 v34, a78
    v_accvgpr_read_b32 v35, a79
    v_cvt_pk_bf16_f32 v72, v32, v33
    v_cvt_pk_bf16_f32 v73, v34, v35
    buffer_store_dwordx2 v[72:73], v3, s[32:35], s51 offen offset:2048 sc1
    s_waitcnt vmcnt(0)
    s_barrier
    s_cmp_lg_u32 s75, 0
    s_cbranch_scc1 oproj_P2_W
    s_lshl_b32 s51, s74, 2
    v_mov_b32 v56, s51
    v_mov_b32 v57, 1
    s_mov_b64 exec, 1
    buffer_atomic_add v57, v56, s[84:87], 0 offen
oproj_P2:
    buffer_load_dword v58, v56, s[84:87], 0 offen sc1
    s_waitcnt vmcnt(0)
    v_readfirstlane_b32 s52, v58
    s_nop 3
    s_and_b32 s52, s52, 0xff
    s_cmp_ge_u32 s52, 4
    s_cbranch_scc1 oproj_P2_D
    s_sleep 4
    s_branch oproj_P2
oproj_P2_D:
    s_mov_b64 exec, -1
oproj_P2_W:
    s_nop 7
    s_nop 7
    s_barrier
    s_mov_b32 s51, 245760
    buffer_load_dwordx4 v[16:19], v10, s[32:35], s51 offen offset:0 sc1
    s_mov_b32 s51, 286720
    buffer_load_dwordx4 v[28:31], v10, s[32:35], s51 offen offset:0 sc1
    s_mov_b32 s51, 327680
    buffer_load_dwordx4 v[40:43], v10, s[32:35], s51 offen offset:0 sc1
    s_mov_b32 s51, 245760
    buffer_load_dwordx4 v[20:23], v10, s[32:35], s51 offen offset:1024 sc1
    s_mov_b32 s51, 286720
    buffer_load_dwordx4 v[32:35], v10, s[32:35], s51 offen offset:1024 sc1
    s_mov_b32 s51, 327680
    buffer_load_dwordx4 v[44:47], v10, s[32:35], s51 offen offset:1024 sc1
    s_mov_b32 s51, 245760
    buffer_load_dwordx2 v[24:25], v3, s[32:35], s51 offen offset:2048 sc1
    s_mov_b32 s51, 286720
    buffer_load_dwordx2 v[36:37], v3, s[32:35], s51 offen offset:2048 sc1
    s_mov_b32 s51, 327680
    buffer_load_dwordx2 v[48:49], v3, s[32:35], s51 offen offset:2048 sc1
    v_accvgpr_read_b32 v76, a40
    v_accvgpr_read_b32 v77, a41
    v_accvgpr_read_b32 v78, a42
    v_accvgpr_read_b32 v79, a43
    s_waitcnt vmcnt(8)
    v_lshlrev_b32 v56, 16, v16
    v_and_b32 v57, 0xffff0000, v16
    v_lshlrev_b32 v58, 16, v17
    v_and_b32 v59, 0xffff0000, v17
    v_add_f32 v76, v76, v56
    v_add_f32 v77, v77, v57
    v_add_f32 v78, v78, v58
    v_add_f32 v79, v79, v59
    s_waitcnt vmcnt(7)
    v_lshlrev_b32 v60, 16, v28
    v_and_b32 v61, 0xffff0000, v28
    v_lshlrev_b32 v62, 16, v29
    v_and_b32 v63, 0xffff0000, v29
    v_add_f32 v76, v76, v60
    v_add_f32 v77, v77, v61
    v_add_f32 v78, v78, v62
    v_add_f32 v79, v79, v63
    s_waitcnt vmcnt(6)
    v_lshlrev_b32 v56, 16, v40
    v_and_b32 v57, 0xffff0000, v40
    v_lshlrev_b32 v58, 16, v41
    v_and_b32 v59, 0xffff0000, v41
    v_add_f32 v76, v76, v56
    v_add_f32 v77, v77, v57
    v_add_f32 v78, v78, v58
    v_add_f32 v79, v79, v59
    v_cvt_pk_bf16_f32 v84, v76, v77
    v_cvt_pk_bf16_f32 v85, v78, v79
    buffer_store_dwordx2 v[84:85], v9, s[36:39], 0 offen offset:160
    v_accvgpr_read_b32 v80, a44
    v_accvgpr_read_b32 v81, a45
    v_accvgpr_read_b32 v82, a46
    v_accvgpr_read_b32 v83, a47
    v_lshlrev_b32 v56, 16, v18
    v_and_b32 v57, 0xffff0000, v18
    v_lshlrev_b32 v58, 16, v19
    v_and_b32 v59, 0xffff0000, v19
    v_add_f32 v80, v80, v56
    v_add_f32 v81, v81, v57
    v_add_f32 v82, v82, v58
    v_add_f32 v83, v83, v59
    v_lshlrev_b32 v60, 16, v30
    v_and_b32 v61, 0xffff0000, v30
    v_lshlrev_b32 v62, 16, v31
    v_and_b32 v63, 0xffff0000, v31
    v_add_f32 v80, v80, v60
    v_add_f32 v81, v81, v61
    v_add_f32 v82, v82, v62
    v_add_f32 v83, v83, v63
    v_lshlrev_b32 v56, 16, v42
    v_and_b32 v57, 0xffff0000, v42
    v_lshlrev_b32 v58, 16, v43
    v_and_b32 v59, 0xffff0000, v43
    v_add_f32 v80, v80, v56
    v_add_f32 v81, v81, v57
    v_add_f32 v82, v82, v58
    v_add_f32 v83, v83, v59
    v_cvt_pk_bf16_f32 v86, v80, v81
    v_cvt_pk_bf16_f32 v87, v82, v83
    buffer_store_dwordx2 v[86:87], v9, s[36:39], 0 offen offset:176
    v_accvgpr_read_b32 v76, a48
    v_accvgpr_read_b32 v77, a49
    v_accvgpr_read_b32 v78, a50
    v_accvgpr_read_b32 v79, a51
    s_waitcnt vmcnt(7)
    v_lshlrev_b32 v56, 16, v20
    v_and_b32 v57, 0xffff0000, v20
    v_lshlrev_b32 v58, 16, v21
    v_and_b32 v59, 0xffff0000, v21
    v_add_f32 v76, v76, v56
    v_add_f32 v77, v77, v57
    v_add_f32 v78, v78, v58
    v_add_f32 v79, v79, v59
    s_waitcnt vmcnt(6)
    v_lshlrev_b32 v60, 16, v32
    v_and_b32 v61, 0xffff0000, v32
    v_lshlrev_b32 v62, 16, v33
    v_and_b32 v63, 0xffff0000, v33
    v_add_f32 v76, v76, v60
    v_add_f32 v77, v77, v61
    v_add_f32 v78, v78, v62
    v_add_f32 v79, v79, v63
    s_waitcnt vmcnt(5)
    v_lshlrev_b32 v56, 16, v44
    v_and_b32 v57, 0xffff0000, v44
    v_lshlrev_b32 v58, 16, v45
    v_and_b32 v59, 0xffff0000, v45
    v_add_f32 v76, v76, v56
    v_add_f32 v77, v77, v57
    v_add_f32 v78, v78, v58
    v_add_f32 v79, v79, v59
    v_cvt_pk_bf16_f32 v84, v76, v77
    v_cvt_pk_bf16_f32 v85, v78, v79
    buffer_store_dwordx2 v[84:85], v9, s[36:39], 0 offen offset:192
    v_accvgpr_read_b32 v80, a52
    v_accvgpr_read_b32 v81, a53
    v_accvgpr_read_b32 v82, a54
    v_accvgpr_read_b32 v83, a55
    v_lshlrev_b32 v56, 16, v22
    v_and_b32 v57, 0xffff0000, v22
    v_lshlrev_b32 v58, 16, v23
    v_and_b32 v59, 0xffff0000, v23
    v_add_f32 v80, v80, v56
    v_add_f32 v81, v81, v57
    v_add_f32 v82, v82, v58
    v_add_f32 v83, v83, v59
    v_lshlrev_b32 v60, 16, v34
    v_and_b32 v61, 0xffff0000, v34
    v_lshlrev_b32 v62, 16, v35
    v_and_b32 v63, 0xffff0000, v35
    v_add_f32 v80, v80, v60
    v_add_f32 v81, v81, v61
    v_add_f32 v82, v82, v62
    v_add_f32 v83, v83, v63
    v_lshlrev_b32 v56, 16, v46
    v_and_b32 v57, 0xffff0000, v46
    v_lshlrev_b32 v58, 16, v47
    v_and_b32 v59, 0xffff0000, v47
    v_add_f32 v80, v80, v56
    v_add_f32 v81, v81, v57
    v_add_f32 v82, v82, v58
    v_add_f32 v83, v83, v59
    v_cvt_pk_bf16_f32 v86, v80, v81
    v_cvt_pk_bf16_f32 v87, v82, v83
    buffer_store_dwordx2 v[86:87], v9, s[36:39], 0 offen offset:208
    v_accvgpr_read_b32 v76, a56
    v_accvgpr_read_b32 v77, a57
    v_accvgpr_read_b32 v78, a58
    v_accvgpr_read_b32 v79, a59
    s_waitcnt vmcnt(6)
    v_lshlrev_b32 v56, 16, v24
    v_and_b32 v57, 0xffff0000, v24
    v_lshlrev_b32 v58, 16, v25
    v_and_b32 v59, 0xffff0000, v25
    v_add_f32 v76, v76, v56
    v_add_f32 v77, v77, v57
    v_add_f32 v78, v78, v58
    v_add_f32 v79, v79, v59
    s_waitcnt vmcnt(5)
    v_lshlrev_b32 v60, 16, v36
    v_and_b32 v61, 0xffff0000, v36
    v_lshlrev_b32 v62, 16, v37
    v_and_b32 v63, 0xffff0000, v37
    v_add_f32 v76, v76, v60
    v_add_f32 v77, v77, v61
    v_add_f32 v78, v78, v62
    v_add_f32 v79, v79, v63
    s_waitcnt vmcnt(4)
    v_lshlrev_b32 v56, 16, v48
    v_and_b32 v57, 0xffff0000, v48
    v_lshlrev_b32 v58, 16, v49
    v_and_b32 v59, 0xffff0000, v49
    v_add_f32 v76, v76, v56
    v_add_f32 v77, v77, v57
    v_add_f32 v78, v78, v58
    v_add_f32 v79, v79, v59
    v_cvt_pk_bf16_f32 v84, v76, v77
    v_cvt_pk_bf16_f32 v85, v78, v79
    buffer_store_dwordx2 v[84:85], v9, s[36:39], 0 offen offset:224
    s_waitcnt vmcnt(0)
    s_endpgm
oproj_RED3:
    s_nop 7
    s_nop 7
    v_lshlrev_b32 v4, 3, v0
    v_sub_u32 v3, v10, v4
    s_mov_b32 s51, 81920
    v_accvgpr_read_b32 v16, a0
    v_accvgpr_read_b32 v17, a1
    v_accvgpr_read_b32 v18, a2
    v_accvgpr_read_b32 v19, a3
    v_cvt_pk_bf16_f32 v40, v16, v17
    v_cvt_pk_bf16_f32 v41, v18, v19
    v_accvgpr_read_b32 v20, a4
    v_accvgpr_read_b32 v21, a5
    v_accvgpr_read_b32 v22, a6
    v_accvgpr_read_b32 v23, a7
    v_cvt_pk_bf16_f32 v42, v20, v21
    v_cvt_pk_bf16_f32 v43, v22, v23
    buffer_store_dwordx4 v[40:43], v10, s[32:35], s51 offen offset:0 sc1
    v_accvgpr_read_b32 v24, a8
    v_accvgpr_read_b32 v25, a9
    v_accvgpr_read_b32 v26, a10
    v_accvgpr_read_b32 v27, a11
    v_cvt_pk_bf16_f32 v44, v24, v25
    v_cvt_pk_bf16_f32 v45, v26, v27
    v_accvgpr_read_b32 v28, a12
    v_accvgpr_read_b32 v29, a13
    v_accvgpr_read_b32 v30, a14
    v_accvgpr_read_b32 v31, a15
    v_cvt_pk_bf16_f32 v46, v28, v29
    v_cvt_pk_bf16_f32 v47, v30, v31
    buffer_store_dwordx4 v[44:47], v10, s[32:35], s51 offen offset:1024 sc1
    v_accvgpr_read_b32 v32, a16
    v_accvgpr_read_b32 v33, a17
    v_accvgpr_read_b32 v34, a18
    v_accvgpr_read_b32 v35, a19
    v_cvt_pk_bf16_f32 v48, v32, v33
    v_cvt_pk_bf16_f32 v49, v34, v35
    buffer_store_dwordx2 v[48:49], v3, s[32:35], s51 offen offset:2048 sc1
    s_mov_b32 s51, 204800
    v_accvgpr_read_b32 v16, a20
    v_accvgpr_read_b32 v17, a21
    v_accvgpr_read_b32 v18, a22
    v_accvgpr_read_b32 v19, a23
    v_cvt_pk_bf16_f32 v52, v16, v17
    v_cvt_pk_bf16_f32 v53, v18, v19
    v_accvgpr_read_b32 v20, a24
    v_accvgpr_read_b32 v21, a25
    v_accvgpr_read_b32 v22, a26
    v_accvgpr_read_b32 v23, a27
    v_cvt_pk_bf16_f32 v54, v20, v21
    v_cvt_pk_bf16_f32 v55, v22, v23
    buffer_store_dwordx4 v[52:55], v10, s[32:35], s51 offen offset:0 sc1
    v_accvgpr_read_b32 v24, a28
    v_accvgpr_read_b32 v25, a29
    v_accvgpr_read_b32 v26, a30
    v_accvgpr_read_b32 v27, a31
    v_cvt_pk_bf16_f32 v56, v24, v25
    v_cvt_pk_bf16_f32 v57, v26, v27
    v_accvgpr_read_b32 v28, a32
    v_accvgpr_read_b32 v29, a33
    v_accvgpr_read_b32 v30, a34
    v_accvgpr_read_b32 v31, a35
    v_cvt_pk_bf16_f32 v58, v28, v29
    v_cvt_pk_bf16_f32 v59, v30, v31
    buffer_store_dwordx4 v[56:59], v10, s[32:35], s51 offen offset:1024 sc1
    v_accvgpr_read_b32 v32, a36
    v_accvgpr_read_b32 v33, a37
    v_accvgpr_read_b32 v34, a38
    v_accvgpr_read_b32 v35, a39
    v_cvt_pk_bf16_f32 v60, v32, v33
    v_cvt_pk_bf16_f32 v61, v34, v35
    buffer_store_dwordx2 v[60:61], v3, s[32:35], s51 offen offset:2048 sc1
    s_mov_b32 s51, 327680
    v_accvgpr_read_b32 v16, a40
    v_accvgpr_read_b32 v17, a41
    v_accvgpr_read_b32 v18, a42
    v_accvgpr_read_b32 v19, a43
    v_cvt_pk_bf16_f32 v64, v16, v17
    v_cvt_pk_bf16_f32 v65, v18, v19
    v_accvgpr_read_b32 v20, a44
    v_accvgpr_read_b32 v21, a45
    v_accvgpr_read_b32 v22, a46
    v_accvgpr_read_b32 v23, a47
    v_cvt_pk_bf16_f32 v66, v20, v21
    v_cvt_pk_bf16_f32 v67, v22, v23
    buffer_store_dwordx4 v[64:67], v10, s[32:35], s51 offen offset:0 sc1
    v_accvgpr_read_b32 v24, a48
    v_accvgpr_read_b32 v25, a49
    v_accvgpr_read_b32 v26, a50
    v_accvgpr_read_b32 v27, a51
    v_cvt_pk_bf16_f32 v68, v24, v25
    v_cvt_pk_bf16_f32 v69, v26, v27
    v_accvgpr_read_b32 v28, a52
    v_accvgpr_read_b32 v29, a53
    v_accvgpr_read_b32 v30, a54
    v_accvgpr_read_b32 v31, a55
    v_cvt_pk_bf16_f32 v70, v28, v29
    v_cvt_pk_bf16_f32 v71, v30, v31
    buffer_store_dwordx4 v[68:71], v10, s[32:35], s51 offen offset:1024 sc1
    v_accvgpr_read_b32 v32, a56
    v_accvgpr_read_b32 v33, a57
    v_accvgpr_read_b32 v34, a58
    v_accvgpr_read_b32 v35, a59
    v_cvt_pk_bf16_f32 v72, v32, v33
    v_cvt_pk_bf16_f32 v73, v34, v35
    buffer_store_dwordx2 v[72:73], v3, s[32:35], s51 offen offset:2048 sc1
    s_waitcnt vmcnt(0)
    s_barrier
    s_cmp_lg_u32 s75, 0
    s_cbranch_scc1 oproj_P3_W
    s_lshl_b32 s51, s74, 2
    v_mov_b32 v56, s51
    v_mov_b32 v57, 1
    s_mov_b64 exec, 1
    buffer_atomic_add v57, v56, s[84:87], 0 offen
oproj_P3:
    buffer_load_dword v58, v56, s[84:87], 0 offen sc1
    s_waitcnt vmcnt(0)
    v_readfirstlane_b32 s52, v58
    s_nop 3
    s_and_b32 s52, s52, 0xff
    s_cmp_ge_u32 s52, 4
    s_cbranch_scc1 oproj_P3_D
    s_sleep 4
    s_branch oproj_P3
oproj_P3_D:
    s_mov_b64 exec, -1
oproj_P3_W:
    s_nop 7
    s_nop 7
    s_barrier
    s_mov_b32 s51, 368640
    buffer_load_dwordx4 v[16:19], v10, s[32:35], s51 offen offset:0 sc1
    s_mov_b32 s51, 409600
    buffer_load_dwordx4 v[28:31], v10, s[32:35], s51 offen offset:0 sc1
    s_mov_b32 s51, 450560
    buffer_load_dwordx4 v[40:43], v10, s[32:35], s51 offen offset:0 sc1
    s_mov_b32 s51, 368640
    buffer_load_dwordx4 v[20:23], v10, s[32:35], s51 offen offset:1024 sc1
    s_mov_b32 s51, 409600
    buffer_load_dwordx4 v[32:35], v10, s[32:35], s51 offen offset:1024 sc1
    s_mov_b32 s51, 450560
    buffer_load_dwordx4 v[44:47], v10, s[32:35], s51 offen offset:1024 sc1
    s_mov_b32 s51, 368640
    buffer_load_dwordx2 v[24:25], v3, s[32:35], s51 offen offset:2048 sc1
    s_mov_b32 s51, 409600
    buffer_load_dwordx2 v[36:37], v3, s[32:35], s51 offen offset:2048 sc1
    s_mov_b32 s51, 450560
    buffer_load_dwordx2 v[48:49], v3, s[32:35], s51 offen offset:2048 sc1
    v_accvgpr_read_b32 v76, a60
    v_accvgpr_read_b32 v77, a61
    v_accvgpr_read_b32 v78, a62
    v_accvgpr_read_b32 v79, a63
    s_waitcnt vmcnt(8)
    v_lshlrev_b32 v56, 16, v16
    v_and_b32 v57, 0xffff0000, v16
    v_lshlrev_b32 v58, 16, v17
    v_and_b32 v59, 0xffff0000, v17
    v_add_f32 v76, v76, v56
    v_add_f32 v77, v77, v57
    v_add_f32 v78, v78, v58
    v_add_f32 v79, v79, v59
    s_waitcnt vmcnt(7)
    v_lshlrev_b32 v60, 16, v28
    v_and_b32 v61, 0xffff0000, v28
    v_lshlrev_b32 v62, 16, v29
    v_and_b32 v63, 0xffff0000, v29
    v_add_f32 v76, v76, v60
    v_add_f32 v77, v77, v61
    v_add_f32 v78, v78, v62
    v_add_f32 v79, v79, v63
    s_waitcnt vmcnt(6)
    v_lshlrev_b32 v56, 16, v40
    v_and_b32 v57, 0xffff0000, v40
    v_lshlrev_b32 v58, 16, v41
    v_and_b32 v59, 0xffff0000, v41
    v_add_f32 v76, v76, v56
    v_add_f32 v77, v77, v57
    v_add_f32 v78, v78, v58
    v_add_f32 v79, v79, v59
    v_cvt_pk_bf16_f32 v84, v76, v77
    v_cvt_pk_bf16_f32 v85, v78, v79
    buffer_store_dwordx2 v[84:85], v9, s[36:39], 0 offen offset:240
    v_accvgpr_read_b32 v80, a64
    v_accvgpr_read_b32 v81, a65
    v_accvgpr_read_b32 v82, a66
    v_accvgpr_read_b32 v83, a67
    v_lshlrev_b32 v56, 16, v18
    v_and_b32 v57, 0xffff0000, v18
    v_lshlrev_b32 v58, 16, v19
    v_and_b32 v59, 0xffff0000, v19
    v_add_f32 v80, v80, v56
    v_add_f32 v81, v81, v57
    v_add_f32 v82, v82, v58
    v_add_f32 v83, v83, v59
    v_lshlrev_b32 v60, 16, v30
    v_and_b32 v61, 0xffff0000, v30
    v_lshlrev_b32 v62, 16, v31
    v_and_b32 v63, 0xffff0000, v31
    v_add_f32 v80, v80, v60
    v_add_f32 v81, v81, v61
    v_add_f32 v82, v82, v62
    v_add_f32 v83, v83, v63
    v_lshlrev_b32 v56, 16, v42
    v_and_b32 v57, 0xffff0000, v42
    v_lshlrev_b32 v58, 16, v43
    v_and_b32 v59, 0xffff0000, v43
    v_add_f32 v80, v80, v56
    v_add_f32 v81, v81, v57
    v_add_f32 v82, v82, v58
    v_add_f32 v83, v83, v59
    v_cvt_pk_bf16_f32 v86, v80, v81
    v_cvt_pk_bf16_f32 v87, v82, v83
    buffer_store_dwordx2 v[86:87], v9, s[36:39], 0 offen offset:256
    v_accvgpr_read_b32 v76, a68
    v_accvgpr_read_b32 v77, a69
    v_accvgpr_read_b32 v78, a70
    v_accvgpr_read_b32 v79, a71
    s_waitcnt vmcnt(7)
    v_lshlrev_b32 v56, 16, v20
    v_and_b32 v57, 0xffff0000, v20
    v_lshlrev_b32 v58, 16, v21
    v_and_b32 v59, 0xffff0000, v21
    v_add_f32 v76, v76, v56
    v_add_f32 v77, v77, v57
    v_add_f32 v78, v78, v58
    v_add_f32 v79, v79, v59
    s_waitcnt vmcnt(6)
    v_lshlrev_b32 v60, 16, v32
    v_and_b32 v61, 0xffff0000, v32
    v_lshlrev_b32 v62, 16, v33
    v_and_b32 v63, 0xffff0000, v33
    v_add_f32 v76, v76, v60
    v_add_f32 v77, v77, v61
    v_add_f32 v78, v78, v62
    v_add_f32 v79, v79, v63
    s_waitcnt vmcnt(5)
    v_lshlrev_b32 v56, 16, v44
    v_and_b32 v57, 0xffff0000, v44
    v_lshlrev_b32 v58, 16, v45
    v_and_b32 v59, 0xffff0000, v45
    v_add_f32 v76, v76, v56
    v_add_f32 v77, v77, v57
    v_add_f32 v78, v78, v58
    v_add_f32 v79, v79, v59
    v_cvt_pk_bf16_f32 v84, v76, v77
    v_cvt_pk_bf16_f32 v85, v78, v79
    buffer_store_dwordx2 v[84:85], v9, s[36:39], 0 offen offset:272
    v_accvgpr_read_b32 v80, a72
    v_accvgpr_read_b32 v81, a73
    v_accvgpr_read_b32 v82, a74
    v_accvgpr_read_b32 v83, a75
    v_lshlrev_b32 v56, 16, v22
    v_and_b32 v57, 0xffff0000, v22
    v_lshlrev_b32 v58, 16, v23
    v_and_b32 v59, 0xffff0000, v23
    v_add_f32 v80, v80, v56
    v_add_f32 v81, v81, v57
    v_add_f32 v82, v82, v58
    v_add_f32 v83, v83, v59
    v_lshlrev_b32 v60, 16, v34
    v_and_b32 v61, 0xffff0000, v34
    v_lshlrev_b32 v62, 16, v35
    v_and_b32 v63, 0xffff0000, v35
    v_add_f32 v80, v80, v60
    v_add_f32 v81, v81, v61
    v_add_f32 v82, v82, v62
    v_add_f32 v83, v83, v63
    v_lshlrev_b32 v56, 16, v46
    v_and_b32 v57, 0xffff0000, v46
    v_lshlrev_b32 v58, 16, v47
    v_and_b32 v59, 0xffff0000, v47
    v_add_f32 v80, v80, v56
    v_add_f32 v81, v81, v57
    v_add_f32 v82, v82, v58
    v_add_f32 v83, v83, v59
    v_cvt_pk_bf16_f32 v86, v80, v81
    v_cvt_pk_bf16_f32 v87, v82, v83
    buffer_store_dwordx2 v[86:87], v9, s[36:39], 0 offen offset:288
    v_accvgpr_read_b32 v76, a76
    v_accvgpr_read_b32 v77, a77
    v_accvgpr_read_b32 v78, a78
    v_accvgpr_read_b32 v79, a79
    s_waitcnt vmcnt(6)
    v_lshlrev_b32 v56, 16, v24
    v_and_b32 v57, 0xffff0000, v24
    v_lshlrev_b32 v58, 16, v25
    v_and_b32 v59, 0xffff0000, v25
    v_add_f32 v76, v76, v56
    v_add_f32 v77, v77, v57
    v_add_f32 v78, v78, v58
    v_add_f32 v79, v79, v59
    s_waitcnt vmcnt(5)
    v_lshlrev_b32 v60, 16, v36
    v_and_b32 v61, 0xffff0000, v36
    v_lshlrev_b32 v62, 16, v37
    v_and_b32 v63, 0xffff0000, v37
    v_add_f32 v76, v76, v60
    v_add_f32 v77, v77, v61
    v_add_f32 v78, v78, v62
    v_add_f32 v79, v79, v63
    s_waitcnt vmcnt(4)
    v_lshlrev_b32 v56, 16, v48
    v_and_b32 v57, 0xffff0000, v48
    v_lshlrev_b32 v58, 16, v49
    v_and_b32 v59, 0xffff0000, v49
    v_add_f32 v76, v76, v56
    v_add_f32 v77, v77, v57
    v_add_f32 v78, v78, v58
    v_add_f32 v79, v79, v59
    v_cvt_pk_bf16_f32 v84, v76, v77
    v_cvt_pk_bf16_f32 v85, v78, v79
    buffer_store_dwordx2 v[84:85], v9, s[36:39], 0 offen offset:304
    s_waitcnt vmcnt(0)
    s_endpgm
oproj_SPIN1:
    s_sleep 1
    buffer_load_dwordx4 a[144:147], v1, s[24:27], 0 offen sc1
    s_waitcnt vmcnt(0)
    v_accvgpr_read_b32 v15, a144
    s_nop 1
    v_readfirstlane_b32 s52, v15
    s_nop 3
    v_accvgpr_read_b32 v15, a145
    s_nop 1
    v_readfirstlane_b32 s53, v15
    s_nop 3
    s_min_u32 s52, s52, s53
    v_accvgpr_read_b32 v15, a146
    s_nop 1
    v_readfirstlane_b32 s53, v15
    s_nop 3
    s_min_u32 s52, s52, s53
    v_accvgpr_read_b32 v15, a147
    s_nop 1
    v_readfirstlane_b32 s53, v15
    s_nop 3
    s_min_u32 s52, s52, s53
    s_cmp_lt_u32 s52, 4
    s_cbranch_scc1 oproj_SPIN1
    s_branch oproj_RET1
attn_END:
    s_endpgm
.section .rodata,"a"
.p2align 6
.amdhsa_kernel attn_kernel
  .amdhsa_next_free_vgpr 256
  .amdhsa_next_free_sgpr 102
  .amdhsa_accum_offset 88
  .amdhsa_group_segment_fixed_size 0
  .amdhsa_kernarg_size 104
  .amdhsa_user_sgpr_count 2
  .amdhsa_user_sgpr_kernarg_segment_ptr 1
  .amdhsa_system_sgpr_workgroup_id_x 1
.end_amdhsa_kernel
```
